```python
import torch

def _softmax(x, axis=-1):
    return torch.softmax(x, dim=axis)
def _gelu(x):
    return torch.nn.functional.gelu(x, approximate="tanh")
def _silu(x):
    return torch.nn.functional.silu(x)
def _sigmoid(x):
    return torch.sigmoid(x)
def _layernorm(x, axis=-1, eps=1e-5):
    m = x.mean(dim=axis, keepdim=True)
    v = x.var(dim=axis, keepdim=True, unbiased=False)
    return (x - m) / torch.sqrt(v + eps)
def _scatter_add(tgt, idx, src, axis=0):
    return tgt.clone().index_add_(axis, idx, src)
def _segment_sum(src, seg, n):
    out = torch.zeros((n,) + src.shape[1:], dtype=src.dtype)
    return out.index_add_(0, seg, src)
def _pad(x, pw):
    flat = tuple(v for pair in reversed(pw) for v in pair)
    return torch.nn.functional.pad(x, flat)

kernel_name = 'sequential_preLN__mha_block__dense_activation_silu__prompt'

def setup_inputs():

    _w = (lambda a: (lambda t: t.to(torch.bfloat16) if t.is_floating_point() else t)(torch.as_tensor(a)))
    def _A_setup():
        B, S, D, H = 1, 2048, 640, 32
        return {
            "x": _w((lambda *s: torch.randn(*s, dtype=torch.bfloat16) * 0.05)(B, S, D)),
            "wqkv": _w((lambda *s: torch.randn(*s, dtype=torch.bfloat16) * 0.05)(D, 3 * D)),
            "wo": _w((lambda *s: torch.randn(*s, dtype=torch.bfloat16) * 0.05)(D, D)),
        }
    _A_in = _A_setup()

    def _B_setup():
        B, S, D, F = 1, 2048, 640, 1728
        return {
            "x": _w((lambda *s: torch.randn(*s, dtype=torch.bfloat16) * 0.05)(B, S, D)),
            "w1": _w((lambda *s: torch.randn(*s, dtype=torch.bfloat16) * 1.6)(D, F) * (D ** -0.5)),
            "w2": _w((lambda *s: torch.randn(*s, dtype=torch.bfloat16) * 0.2)(F, D) * (F ** -0.5)),
        }
    _B_in = _B_setup()

    return {
        "A_x": _A_in["x"],
        "A_wqkv": _A_in["wqkv"],
        "A_wo": _A_in["wo"],
        "B_x": _B_in["x"],
        "B_w1": _B_in["w1"],
        "B_w2": _B_in["w2"],
    }

def reference(A_x, A_wqkv, A_wo, B_x, B_w1, B_w2):
    def _A_ref(x, wqkv, wo):
        B, S, D = x.shape
        H = 32
        Dh = D // H
        qkv = (lambda x, *d: x.permute(*d))((x @ wqkv).reshape(B, S, 3, H, Dh), 2, 0, 3, 1, 4)
        q, k, v = qkv[0], qkv[1], qkv[2]
        scores = torch.einsum("bhqd,bhkd->bhqk", q, k) * (Dh ** -0.5)
        p = _softmax(scores, axis=-1)
        o = torch.einsum("bhqk,bhkd->bhqd", p, v)
        return (lambda x, *d: x.permute(*d))(o, 0, 2, 1, 3).reshape(B, S, D) @ wo

    def _B_ref(x, w1, w2):
        h = torch.einsum("bsd,df->bsf", x, w1)
        h = _silu(h)
        out = torch.einsum("bsf,fd->bsd", h, w2)
        return out

    x = A_x
    h = x + _A_ref(_layernorm(x, axis=-1), A_wqkv, A_wo)
    h2 = h + _B_ref(_layernorm(h, axis=-1), B_w1, B_w2)
    return h2
```

```asm
; @launch grid=(256,1,1) block=(512,1,1) lds=163840
.amdgcn_target "amdgcn-amd-amdhsa--gfx950"
.text
.globl sequential_preLN__mha_block__dense_activation_silu__prompt_kernel
.p2align 8
.type sequential_preLN__mha_block__dense_activation_silu__prompt_kernel,@function
sequential_preLN__mha_block__dense_activation_silu__prompt_kernel:
    s_cmp_ge_u32 s2, 256
    s_cbranch_scc1 L_end
    s_load_dwordx4 s[4:7], s[0:1], 0
    s_load_dwordx2 s[10:11], s[0:1], 64
    s_load_dwordx2 s[8:9], s[0:1], 16
    s_load_dwordx4 s[12:15], s[0:1], 32
    s_load_dwordx4 s[16:19], s[0:1], 48
    v_lshrrev_b32 v1, 6, v0
    v_and_b32 v2, 63, v0
    v_readfirstlane_b32 s22, v1
    v_and_b32 v3, 31, v2
    v_lshrrev_b32 v4, 5, v2
    s_and_b32 s20, s2, 7
    s_lshr_b32 s21, s2, 3
    s_and_b32 s26, s20, 3
    s_lshl_b32 s26, s26, 2
    s_and_b32 s55, s21, 3
    s_add_u32 s26, s26, s55
    s_lshr_b32 s27, s20, 2
    s_lshl_b32 s27, s27, 3
    s_lshr_b32 s55, s21, 2
    s_add_u32 s27, s27, s55
    s_cmp_ge_u32 s21, 30
    s_cselect_b32 s55, 1, 0
    s_lshl_b32 s55, s55, 3
    s_xor_b32 s27, s27, s55
    s_and_b32 s23, s22, 3
    s_lshr_b32 s24, s22, 2
    s_cmp_ge_u32 s27, 15
    s_cbranch_scc1 L1_stats
    s_cmp_lt_u32 s22, 4
    s_cbranch_scc1 L1_compute
L1_loader:
    v_lshrrev_b32 v5, 3, v2
    v_and_b32 v6, 7, v2
    s_lshl_b32 s55, s23, 5
    v_add_u32 v7, s55, v5
    v_mul_u32_u24 v7, 1280, v7
    v_lshrrev_b32 v12, 4, v2
    v_xor_b32 v12, v12, v6
    v_lshl_add_u32 v16, v12, 4, v7
    v_xor_b32 v12, 4, v12
    v_lshl_add_u32 v17, v12, 4, v7
    v_add_u32 v17, 9216, v17
    v_add_u32 v18, 18432, v16
    v_add_u32 v19, 18432, v17
    s_lshr_b32 s55, s23, 1
    s_lshl_b32 s55, s55, 5
    v_add_u32 v7, s55, v5
    v_mul_u32_u24 v7, 3840, v7
    v_bfe_u32 v12, v2, 4, 1
    v_lshlrev_b32 v12, 2, v12
    v_xor_b32 v12, v12, v6
    v_lshl_add_u32 v20, v12, 4, v7
    s_and_b32 s56, s23, 1
    s_lshl_b32 s57, s56, 7
    v_add_u32 v20, s57, v20
    v_add_u32 v21, 29696, v20
    v_add_u32 v22, 59392, v20
    v_add_u32 v23, 89088, v20
    s_lshl_b32 s48, s23, 12
    s_lshl_b32 s49, s56, 13
    s_lshl_b32 s55, s55, 7
    s_add_u32 s49, s49, s55
    s_add_u32 s49, s49, 16384
    s_mul_i32 s55, s26, 163840
    s_lshl_b32 s56, s27, 8
    s_sub_u32 s34, 2457600, s56
    s_mov_b32 s30, 163840
    s_mov_b32 s31, 0x00020000
    s_mov_b32 s35, 0x00020000
    s_and_b32 s54, s21, 3
    s_mul_i32 s54, s54, 8
    s_lshr_b32 s57, s21, 2
    s_mul_i32 s57, s57, 2
    s_add_u32 s54, s54, s57
    s_lshr_b32 s54, s54, 2
    s_cmp_ge_u32 s54, 8
    s_cselect_b32 s57, 8, 0
    s_sub_u32 s54, s54, s57
    s_cmp_ge_u32 s54, 8
    s_cselect_b32 s57, 8, 0
    s_sub_u32 s54, s54, s57
    s_add_u32 s53, s54, 2
    s_mov_b32 s54, 0
    s_waitcnt lgkmcnt(0)
    s_add_u32 s28, s4, s55
    s_addc_u32 s29, s5, 0
    s_add_u32 s32, s6, s56
    s_addc_u32 s33, s7, 0
    s_add_u32 m0, s48, 0
    s_lshl_b32 s50, s54, 7
    buffer_load_dwordx4 v16, s[28:31], s50 offen offset:0 lds
    buffer_load_dwordx4 v17, s[28:31], s50 offen offset:1024 lds
    buffer_load_dwordx4 v18, s[28:31], s50 offen offset:2048 lds
    buffer_load_dwordx4 v19, s[28:31], s50 offen offset:3072 lds
    s_add_u32 m0, s49, 0
    s_mul_i32 s51, s54, 245760
    buffer_load_dwordx4 v20, s[32:35], s51 offen offset:0 lds
    buffer_load_dwordx4 v21, s[32:35], s51 offen offset:1024 lds
    buffer_load_dwordx4 v22, s[32:35], s51 offen offset:2048 lds
    buffer_load_dwordx4 v23, s[32:35], s51 offen offset:3072 lds
    s_add_u32 s54, s54, 1
    s_cmp_eq_u32 s54, 10
    s_cselect_b32 s54, 2, s54
    s_add_u32 m0, s48, 32768
    s_lshl_b32 s50, s54, 7
    buffer_load_dwordx4 v16, s[28:31], s50 offen offset:0 lds
    buffer_load_dwordx4 v17, s[28:31], s50 offen offset:1024 lds
    buffer_load_dwordx4 v18, s[28:31], s50 offen offset:2048 lds
    buffer_load_dwordx4 v19, s[28:31], s50 offen offset:3072 lds
    s_add_u32 m0, s49, 32768
    s_mul_i32 s51, s54, 245760
    buffer_load_dwordx4 v20, s[32:35], s51 offen offset:0 lds
    buffer_load_dwordx4 v21, s[32:35], s51 offen offset:1024 lds
    buffer_load_dwordx4 v22, s[32:35], s51 offen offset:2048 lds
    buffer_load_dwordx4 v23, s[32:35], s51 offen offset:3072 lds
    s_mov_b32 s54, s53
    s_waitcnt vmcnt(8)
    s_barrier
    s_add_u32 m0, s48, 65536
    s_lshl_b32 s50, s54, 7
    buffer_load_dwordx4 v16, s[28:31], s50 offen offset:0 lds
    buffer_load_dwordx4 v17, s[28:31], s50 offen offset:1024 lds
    buffer_load_dwordx4 v18, s[28:31], s50 offen offset:2048 lds
    buffer_load_dwordx4 v19, s[28:31], s50 offen offset:3072 lds
    s_add_u32 m0, s49, 65536
    s_mul_i32 s51, s54, 245760
    buffer_load_dwordx4 v20, s[32:35], s51 offen offset:0 lds
    buffer_load_dwordx4 v21, s[32:35], s51 offen offset:1024 lds
    buffer_load_dwordx4 v22, s[32:35], s51 offen offset:2048 lds
    buffer_load_dwordx4 v23, s[32:35], s51 offen offset:3072 lds
    s_add_u32 s54, s54, 1
    s_cmp_eq_u32 s54, 10
    s_cselect_b32 s54, 2, s54
    s_add_u32 s44, s10, 25952256
    s_addc_u32 s45, s11, 0
    s_mov_b32 s46, 131072
    s_mov_b32 s47, 0x00020000
    s_mov_b32 s40, s18
    s_mov_b32 s41, s19
    s_mov_b32 s42, 256
    s_mov_b32 s43, 0x00020000
    v_lshlrev_b32 v12, 2, v3
    s_lshl_b32 s55, s23, 9
    s_add_u32 s55, s55, 159744
    v_lshl_add_u32 v11, v2, 3, s55
    s_lshl_b32 s55, s23, 7
    s_add_u32 s55, s55, 162304
    v_lshl_add_u32 v14, v3, 2, s55
    s_waitcnt vmcnt(8)
    s_barrier
    s_add_u32 m0, s48, 98304
    s_lshl_b32 s50, s54, 7
    buffer_load_dwordx4 v16, s[28:31], s50 offen offset:0 lds
    buffer_load_dwordx4 v17, s[28:31], s50 offen offset:1024 lds
    buffer_load_dwordx4 v18, s[28:31], s50 offen offset:2048 lds
    buffer_load_dwordx4 v19, s[28:31], s50 offen offset:3072 lds
    s_add_u32 m0, s49, 98304
    s_mul_i32 s51, s54, 245760
    buffer_load_dwordx4 v20, s[32:35], s51 offen offset:0 lds
    buffer_load_dwordx4 v21, s[32:35], s51 offen offset:1024 lds
    buffer_load_dwordx4 v22, s[32:35], s51 offen offset:2048 lds
    buffer_load_dwordx4 v23, s[32:35], s51 offen offset:3072 lds
    s_add_u32 s54, s54, 1
    s_cmp_eq_u32 s54, 10
    s_cselect_b32 s54, 2, s54
    s_waitcnt vmcnt(8)
    s_barrier
    s_add_u32 m0, s48, 0
    s_lshl_b32 s50, s54, 7
    buffer_load_dwordx4 v16, s[28:31], s50 offen offset:0 lds
    buffer_load_dwordx4 v17, s[28:31], s50 offen offset:1024 lds
    buffer_load_dwordx4 v18, s[28:31], s50 offen offset:2048 lds
    buffer_load_dwordx4 v19, s[28:31], s50 offen offset:3072 lds
    s_add_u32 m0, s49, 0
    s_mul_i32 s51, s54, 245760
    buffer_load_dwordx4 v20, s[32:35], s51 offen offset:0 lds
    buffer_load_dwordx4 v21, s[32:35], s51 offen offset:1024 lds
    buffer_load_dwordx4 v22, s[32:35], s51 offen offset:2048 lds
    buffer_load_dwordx4 v23, s[32:35], s51 offen offset:3072 lds
    s_add_u32 s54, s54, 1
    s_cmp_eq_u32 s54, 10
    s_cselect_b32 s54, 2, s54
    s_waitcnt vmcnt(8)
    s_barrier
    s_add_u32 m0, s48, 32768
    s_lshl_b32 s50, s54, 7
    buffer_load_dwordx4 v16, s[28:31], s50 offen offset:0 lds
    buffer_load_dwordx4 v17, s[28:31], s50 offen offset:1024 lds
    buffer_load_dwordx4 v18, s[28:31], s50 offen offset:2048 lds
    buffer_load_dwordx4 v19, s[28:31], s50 offen offset:3072 lds
    s_add_u32 m0, s49, 32768
    s_mul_i32 s51, s54, 245760
    buffer_load_dwordx4 v20, s[32:35], s51 offen offset:0 lds
    buffer_load_dwordx4 v21, s[32:35], s51 offen offset:1024 lds
    buffer_load_dwordx4 v22, s[32:35], s51 offen offset:2048 lds
    buffer_load_dwordx4 v23, s[32:35], s51 offen offset:3072 lds
    s_add_u32 s54, s54, 1
    s_cmp_eq_u32 s54, 10
    s_cselect_b32 s54, 2, s54
    s_waitcnt vmcnt(8)
    s_barrier
    s_add_u32 m0, s48, 65536
    s_lshl_b32 s50, s54, 7
    buffer_load_dwordx4 v16, s[28:31], s50 offen offset:0 lds
    buffer_load_dwordx4 v17, s[28:31], s50 offen offset:1024 lds
    buffer_load_dwordx4 v18, s[28:31], s50 offen offset:2048 lds
    buffer_load_dwordx4 v19, s[28:31], s50 offen offset:3072 lds
    s_add_u32 m0, s49, 65536
    s_mul_i32 s51, s54, 245760
    buffer_load_dwordx4 v20, s[32:35], s51 offen offset:0 lds
    buffer_load_dwordx4 v21, s[32:35], s51 offen offset:1024 lds
    buffer_load_dwordx4 v22, s[32:35], s51 offen offset:2048 lds
    buffer_load_dwordx4 v23, s[32:35], s51 offen offset:3072 lds
    s_add_u32 s54, s54, 1
    s_cmp_eq_u32 s54, 10
    s_cselect_b32 s54, 2, s54
    buffer_load_dword v15, v12, s[40:43], 0 offen offset:128 sc1
    s_waitcnt vmcnt(9)
    s_barrier
    s_add_u32 m0, s48, 98304
    s_lshl_b32 s50, s54, 7
    buffer_load_dwordx4 v16, s[28:31], s50 offen offset:0 lds
    buffer_load_dwordx4 v17, s[28:31], s50 offen offset:1024 lds
    buffer_load_dwordx4 v18, s[28:31], s50 offen offset:2048 lds
    buffer_load_dwordx4 v19, s[28:31], s50 offen offset:3072 lds
    s_add_u32 m0, s49, 98304
    s_mul_i32 s51, s54, 245760
    buffer_load_dwordx4 v20, s[32:35], s51 offen offset:0 lds
    buffer_load_dwordx4 v21, s[32:35], s51 offen offset:1024 lds
    buffer_load_dwordx4 v22, s[32:35], s51 offen offset:2048 lds
    buffer_load_dwordx4 v23, s[32:35], s51 offen offset:3072 lds
    s_add_u32 s54, s54, 1
    s_cmp_eq_u32 s54, 10
    s_cselect_b32 s54, 2, s54
    s_waitcnt vmcnt(9)
    s_barrier
    s_add_u32 m0, s48, 0
    s_lshl_b32 s50, s54, 7
    buffer_load_dwordx4 v16, s[28:31], s50 offen offset:0 lds
    buffer_load_dwordx4 v17, s[28:31], s50 offen offset:1024 lds
    buffer_load_dwordx4 v18, s[28:31], s50 offen offset:2048 lds
    buffer_load_dwordx4 v19, s[28:31], s50 offen offset:3072 lds
    s_add_u32 m0, s49, 0
    s_mul_i32 s51, s54, 245760
    buffer_load_dwordx4 v20, s[32:35], s51 offen offset:0 lds
    buffer_load_dwordx4 v21, s[32:35], s51 offen offset:1024 lds
    buffer_load_dwordx4 v22, s[32:35], s51 offen offset:2048 lds
    buffer_load_dwordx4 v23, s[32:35], s51 offen offset:3072 lds
    s_add_u32 s54, s54, 1
    s_cmp_eq_u32 s54, 10
    s_cselect_b32 s54, 2, s54
    s_waitcnt vmcnt(8)
    s_barrier
    s_add_u32 m0, s48, 32768
    s_lshl_b32 s50, s54, 7
    buffer_load_dwordx4 v16, s[28:31], s50 offen offset:0 lds
    buffer_load_dwordx4 v17, s[28:31], s50 offen offset:1024 lds
    buffer_load_dwordx4 v18, s[28:31], s50 offen offset:2048 lds
    buffer_load_dwordx4 v19, s[28:31], s50 offen offset:3072 lds
    s_add_u32 m0, s49, 32768
    s_mul_i32 s51, s54, 245760
    buffer_load_dwordx4 v20, s[32:35], s51 offen offset:0 lds
    buffer_load_dwordx4 v21, s[32:35], s51 offen offset:1024 lds
    buffer_load_dwordx4 v22, s[32:35], s51 offen offset:2048 lds
    buffer_load_dwordx4 v23, s[32:35], s51 offen offset:3072 lds
    s_add_u32 s54, s54, 1
    s_cmp_eq_u32 s54, 10
    s_cselect_b32 s54, 2, s54
    s_waitcnt vmcnt(8)
    s_barrier
    s_waitcnt vmcnt(24)
    v_cmp_eq_u32 vcc, 0, v15
    s_cbranch_vccnz L1_golate
L1_goret:
    s_lshl_b32 s55, s26, 10
    s_lshl_b32 s56, s23, 8
    s_add_u32 s55, s55, s56
    s_add_u32 s60, s55, 49152
    s_mov_b32 s59, 1.0
    s_cmp_lt_u32 s27, 5
    s_cselect_b32 s59, 0x3ea52b5c, s59
    v_lshlrev_b32 v13, 3, v3
    buffer_load_dwordx2 v[24:25], v13, s[44:47], s60 offen sc1
    s_waitcnt vmcnt(1)
    s_barrier
    s_waitcnt vmcnt(0)
    v_cmp_eq_u32 vcc, 0, v25
    s_cbranch_vccnz L1_stlate
L1_stret:
    v_cvt_pk_bf16_f32 v26, v24, v24
    v_and_b32 v27, 0xffff0000, v26
    v_sub_f32 v27, v24, v27
    v_cvt_pk_bf16_f32 v27, v27, v27
    v_cmp_gt_u32 vcc, 32, v2
    v_mul_f32 v25, s59, v25
    s_nop 0
    v_cndmask_b32 v26, 0, v26, vcc
    v_cndmask_b32 v27, 0, v27, vcc
    ds_write_b32 v14, v25
    ds_write_b64 v11, v[26:27]
    s_waitcnt lgkmcnt(0)
    s_barrier
L1_ljob:
    s_mov_b32 s85, 1
    s_branch L2_nsig
L1_golate:
    s_mov_b64 s[70:71], -1
    s_mov_b32 s3, 400000
Lp1:
    s_sleep 4
    buffer_load_dword v15, v12, s[40:43], 0 offen offset:128 sc1
Lp1_c:
    s_waitcnt vmcnt(0)
    v_cmp_eq_u32 vcc, 0, v15
    s_and_b64 s[72:73], vcc, s[70:71]
    s_sub_u32 s3, s3, 1
    s_cselect_b64 s[72:73], 0, s[72:73]
    s_cmp_lg_u64 s[72:73], 0
    s_cbranch_scc1 Lp1
    s_branch L1_goret
L1_stlate:
    s_mov_b64 s[70:71], -1
    s_mov_b32 s3, 400000
Lp2:
    s_sleep 4
    buffer_load_dwordx2 v[24:25], v13, s[44:47], s60 offen sc1
Lp2_c:
    s_waitcnt vmcnt(0)
    v_cmp_eq_u32 vcc, 0, v25
    s_and_b64 s[72:73], vcc, s[70:71]
    s_sub_u32 s3, s3, 1
    s_cselect_b64 s[72:73], 0, s[72:73]
    s_cmp_lg_u64 s[72:73], 0
    s_cbranch_scc1 Lp2
    s_branch L1_stret
L1_compute:
    s_waitcnt lgkmcnt(0)
    s_add_u32 s44, s10, 25952256
    s_addc_u32 s45, s11, 0
    s_mov_b32 s46, 131072
    s_mov_b32 s47, 0x00020000
    s_mov_b32 s40, s18
    s_mov_b32 s41, s19
    s_mov_b32 s42, 256
    s_mov_b32 s43, 0x00020000
    s_cmp_ge_u32 s2, 8
    s_cbranch_scc1 L1_noinit
    v_mov_b32 v140, 0
    v_mov_b32 v141, 0
    v_mov_b32 v142, 0
    v_mov_b32 v143, 0
    s_lshl_b32 s56, s2, 2
    s_add_u32 s56, s56, s23
    s_lshl_b32 s55, s56, 12
    v_lshl_add_u32 v7, v2, 4, s55
    buffer_store_dwordx4 v[140:143], v7, s[44:47], 0 offen sc1
    buffer_store_dwordx4 v[140:143], v7, s[44:47], 0 offen offset:1024 sc1
    buffer_store_dwordx4 v[140:143], v7, s[44:47], 0 offen offset:2048 sc1
    buffer_store_dwordx4 v[140:143], v7, s[44:47], 0 offen offset:3072 sc1
    s_lshl_b32 s56, s56, 2
    v_mov_b32 v140, 1
    s_mov_b64 exec, 1
    s_waitcnt vmcnt(0)
    buffer_store_dword v140, off, s[40:43], s56 offset:128 sc1
    s_mov_b64 exec, -1
L1_noinit:
    s_lshr_b32 s48, s23, 1
    s_and_b32 s49, s23, 1
    s_lshl_b32 s50, s49, 1
    s_add_u32 s51, s50, 1
    s_add_u32 s50, s50, s48
    s_sub_u32 s51, s51, s48
    s_lshl_b32 s55, s48, 6
    v_add_u32 v5, s55, v3
    v_bfe_u32 v6, v5, 1, 3
    v_xor_b32 v6, v6, v4
    v_lshlrev_b32 v7, 7, v5
    v_xor_b32 v12, 0, v6
    v_lshl_add_u32 v8, v12, 4, v7
    v_xor_b32 v12, 2, v6
    v_lshl_add_u32 v9, v12, 4, v7
    v_xor_b32 v12, 4, v6
    v_lshl_add_u32 v10, v12, 4, v7
    v_xor_b32 v12, 6, v6
    v_lshl_add_u32 v11, v12, 4, v7
    v_bfe_u32 v5, v2, 2, 2
    v_lshl_add_u32 v6, v4, 3, v5
    v_lshlrev_b32 v6, 7, v6
    v_bfe_u32 v7, v2, 4, 1
    v_lshl_add_u32 v6, v7, 5, v6
    v_and_b32 v7, 3, v2
    v_lshl_add_u32 v6, v7, 3, v6
    v_lshrrev_b32 v5, 1, v5
    s_lshl_b32 s55, s49, 13
    s_add_u32 s55, s55, 16384
    v_xor_b32 v7, s48, v5
    v_lshl_add_u32 v7, v7, 6, v6
    v_add_u32 v48, s55, v7
    v_xor_b32 v49, 64, v48
    v_and_b32 v5, 15, v2
    v_bfe_u32 v6, v2, 4, 1
    v_cmp_eq_u32 vcc, v5, v6
    v_mov_b32 v7, 0x3f803f80
    s_mov_b32 s61, 0xffff0000
    v_cndmask_b32 v56, 0, v7, vcc
    v_cndmask_b32 v57, 0, v7, vcc
    v_cndmask_b32 v58, 0, v7, vcc
    v_cndmask_b32 v59, 0, v7, vcc
    v_mov_b32 v64, 0
    v_mov_b32 v65, 0
    v_mov_b32 v66, 0
    v_mov_b32 v67, 0
    v_mov_b32 v68, 0
    v_mov_b32 v69, 0
    v_mov_b32 v70, 0
    v_mov_b32 v71, 0
    v_mov_b32 v72, 0
    v_mov_b32 v73, 0
    v_mov_b32 v74, 0
    v_mov_b32 v75, 0
    v_mov_b32 v76, 0
    v_mov_b32 v77, 0
    v_mov_b32 v78, 0
    v_mov_b32 v79, 0
    v_mov_b32 v80, 0
    v_mov_b32 v81, 0
    v_mov_b32 v82, 0
    v_mov_b32 v83, 0
    v_mov_b32 v84, 0
    v_mov_b32 v85, 0
    v_mov_b32 v86, 0
    v_mov_b32 v87, 0
    v_mov_b32 v88, 0
    v_mov_b32 v89, 0
    v_mov_b32 v90, 0
    v_mov_b32 v91, 0
    v_mov_b32 v92, 0
    v_mov_b32 v93, 0
    v_mov_b32 v94, 0
    v_mov_b32 v95, 0
    v_mov_b32 v96, 0
    v_mov_b32 v97, 0
    v_mov_b32 v98, 0
    v_mov_b32 v99, 0
    v_mov_b32 v100, 0
    v_mov_b32 v101, 0
    v_mov_b32 v102, 0
    v_mov_b32 v103, 0
    v_mov_b32 v104, 0
    v_mov_b32 v105, 0
    v_mov_b32 v106, 0
    v_mov_b32 v107, 0
    v_mov_b32 v108, 0
    v_mov_b32 v109, 0
    v_mov_b32 v110, 0
    v_mov_b32 v111, 0
    v_mov_b32 v112, 0
    v_mov_b32 v113, 0
    v_mov_b32 v114, 0
    v_mov_b32 v115, 0
    v_mov_b32 v116, 0
    v_mov_b32 v117, 0
    v_mov_b32 v118, 0
    v_mov_b32 v119, 0
    v_mov_b32 v120, 0
    v_mov_b32 v121, 0
    v_mov_b32 v122, 0
    v_mov_b32 v123, 0
    v_mov_b32 v124, 0
    v_mov_b32 v125, 0
    v_mov_b32 v126, 0
    v_mov_b32 v127, 0
    v_mov_b32 v60, 0
    v_mov_b32 v61, 0
    v_mov_b32 v62, 0
    v_mov_b32 v63, 0
    v_mov_b32 v24, 0
    v_mov_b32 v40, 0
    v_mov_b32 v25, 0
    v_mov_b32 v41, 0
    v_mov_b32 v26, 0
    v_mov_b32 v42, 0
    v_mov_b32 v27, 0
    v_mov_b32 v43, 0
    v_mov_b32 v28, 0
    v_mov_b32 v44, 0
    v_mov_b32 v29, 0
    v_mov_b32 v45, 0
    v_mov_b32 v30, 0
    v_mov_b32 v46, 0
    v_mov_b32 v31, 0
    v_mov_b32 v47, 0
    s_lshl_b32 s55, s50, 7
    s_add_u32 s55, s55, 161792
    v_lshl_add_u32 v128, v2, 2, s55
    v_lshl_add_u32 v130, v3, 2, s55
    v_xor_b32 v131, 128, v130
    s_lshl_b32 s55, s48, 10
    s_add_u32 s55, s55, 159744
    v_lshl_add_u32 v129, v2, 3, s55
    s_lshl_b32 s55, s48, 8
    s_add_u32 s55, s55, 162304
    v_lshl_add_u32 v136, v3, 2, s55
    v_lshl_add_u32 v135, v4, 4, s55
    s_mov_b32 s85, 0
    s_mov_b32 s52, 5
    s_mov_b32 s53, 0x10000
    s_cmp_ge_u32 s27, 10
    s_cbranch_scc1 L1_vpre
    s_add_u32 s28, s10, 0
    s_addc_u32 s29, s11, 0
    s_mov_b32 s30, 5242880
    s_mov_b32 s31, 0x00020000
    s_lshl_b32 s55, s26, 7
    s_lshl_b32 s56, s48, 6
    s_add_u32 s55, s55, s56
    v_add_u32 v7, s55, v3
    v_lshlrev_b32 v7, 4, v7
    v_lshl_add_u32 v134, v4, 15, v7
    s_lshl_b32 s57, s27, 19
    s_lshl_b32 s55, s50, 17
    s_add_u32 s62, s55, s57
    s_add_u32 s63, s62, 65536
    s_lshl_b32 s55, s51, 17
    s_add_u32 s64, s55, s57
    s_add_u32 s65, s64, 65536
.p2align 3
L1_qloop:
    s_waitcnt lgkmcnt(0)
    s_barrier
    v_mfma_f32_32x32x16_bf16 v[64:79], v[40:43], v[24:27], v[64:79]
    ds_read_b128 v[16:19], v8 offset:0
    ds_read_b64_tr_b16 v[32:33], v48 offset:0
    ds_read_b64_tr_b16 v[34:35], v48 offset:512
    v_mfma_f32_32x32x16_bf16 v[80:95], v[44:47], v[24:27], v[80:95]
    ds_read_b64_tr_b16 v[36:37], v49 offset:0
    ds_read_b64_tr_b16 v[38:39], v49 offset:512
    ds_read_b128 v[20:23], v8 offset:4096
    v_mfma_f32_32x32x16_bf16 v[96:111], v[40:43], v[28:31], v[96:111]
    v_mfma_f32_16x16x32_bf16 v[60:63], v[56:59], v[40:43], v[60:63]
    v_mfma_f32_32x32x16_bf16 v[112:127], v[44:47], v[28:31], v[112:127]
    s_waitcnt lgkmcnt(0)
    v_mfma_f32_32x32x16_bf16 v[64:79], v[32:35], v[16:19], v[64:79]
    ds_read_b128 v[24:27], v9 offset:0
    ds_read_b64_tr_b16 v[40:41], v48 offset:2048
    ds_read_b64_tr_b16 v[42:43], v48 offset:2560
    v_mfma_f32_32x32x16_bf16 v[80:95], v[36:39], v[16:19], v[80:95]
    ds_read_b64_tr_b16 v[44:45], v49 offset:2048
    ds_read_b64_tr_b16 v[46:47], v49 offset:2560
    ds_read_b128 v[28:31], v9 offset:4096
    v_mfma_f32_32x32x16_bf16 v[96:111], v[32:35], v[20:23], v[96:111]
    v_mfma_f32_16x16x32_bf16 v[60:63], v[56:59], v[32:35], v[60:63]
    v_mfma_f32_32x32x16_bf16 v[112:127], v[36:39], v[20:23], v[112:127]
    s_waitcnt lgkmcnt(0)
    v_mfma_f32_32x32x16_bf16 v[64:79], v[40:43], v[24:27], v[64:79]
    ds_read_b128 v[16:19], v10 offset:0
    ds_read_b64_tr_b16 v[32:33], v48 offset:4096
    ds_read_b64_tr_b16 v[34:35], v48 offset:4608
    v_mfma_f32_32x32x16_bf16 v[80:95], v[44:47], v[24:27], v[80:95]
    ds_read_b64_tr_b16 v[36:37], v49 offset:4096
    ds_read_b64_tr_b16 v[38:39], v49 offset:4608
    ds_read_b128 v[20:23], v10 offset:4096
    v_mfma_f32_32x32x16_bf16 v[96:111], v[40:43], v[28:31], v[96:111]
    v_mfma_f32_16x16x32_bf16 v[60:63], v[56:59], v[40:43], v[60:63]
    v_mfma_f32_32x32x16_bf16 v[112:127], v[44:47], v[28:31], v[112:127]
    s_waitcnt lgkmcnt(0)
    v_mfma_f32_32x32x16_bf16 v[64:79], v[32:35], v[16:19], v[64:79]
    ds_read_b128 v[24:27], v11 offset:0
    ds_read_b64_tr_b16 v[40:41], v48 offset:6144
    ds_read_b64_tr_b16 v[42:43], v48 offset:6656
    v_mfma_f32_32x32x16_bf16 v[80:95], v[36:39], v[16:19], v[80:95]
    ds_read_b64_tr_b16 v[44:45], v49 offset:6144
    ds_read_b64_tr_b16 v[46:47], v49 offset:6656
    ds_read_b128 v[28:31], v11 offset:4096
    v_mfma_f32_32x32x16_bf16 v[96:111], v[32:35], v[20:23], v[96:111]
    v_mfma_f32_16x16x32_bf16 v[60:63], v[56:59], v[32:35], v[60:63]
    v_mfma_f32_32x32x16_bf16 v[112:127], v[36:39], v[20:23], v[112:127]
    s_waitcnt lgkmcnt(0)
    s_barrier
    v_mfma_f32_32x32x16_bf16 v[64:79], v[40:43], v[24:27], v[64:79]
    ds_read_b128 v[16:19], v8 offset:32768
    ds_read_b64_tr_b16 v[32:33], v48 offset:32768
    ds_read_b64_tr_b16 v[34:35], v48 offset:33280
    v_mfma_f32_32x32x16_bf16 v[80:95], v[44:47], v[24:27], v[80:95]
    ds_read_b64_tr_b16 v[36:37], v49 offset:32768
    ds_read_b64_tr_b16 v[38:39], v49 offset:33280
    ds_read_b128 v[20:23], v8 offset:36864
    v_mfma_f32_32x32x16_bf16 v[96:111], v[40:43], v[28:31], v[96:111]
    v_mfma_f32_16x16x32_bf16 v[60:63], v[56:59], v[40:43], v[60:63]
    v_mfma_f32_32x32x16_bf16 v[112:127], v[44:47], v[28:31], v[112:127]
    s_waitcnt lgkmcnt(0)
    v_mfma_f32_32x32x16_bf16 v[64:79], v[32:35], v[16:19], v[64:79]
    ds_read_b128 v[24:27], v9 offset:32768
    ds_read_b64_tr_b16 v[40:41], v48 offset:34816
    ds_read_b64_tr_b16 v[42:43], v48 offset:35328
    v_mfma_f32_32x32x16_bf16 v[80:95], v[36:39], v[16:19], v[80:95]
    ds_read_b64_tr_b16 v[44:45], v49 offset:34816
    ds_read_b64_tr_b16 v[46:47], v49 offset:35328
    ds_read_b128 v[28:31], v9 offset:36864
    v_mfma_f32_32x32x16_bf16 v[96:111], v[32:35], v[20:23], v[96:111]
    v_mfma_f32_16x16x32_bf16 v[60:63], v[56:59], v[32:35], v[60:63]
    v_mfma_f32_32x32x16_bf16 v[112:127], v[36:39], v[20:23], v[112:127]
    s_waitcnt lgkmcnt(0)
    v_mfma_f32_32x32x16_bf16 v[64:79], v[40:43], v[24:27], v[64:79]
    ds_read_b128 v[16:19], v10 offset:32768
    ds_read_b64_tr_b16 v[32:33], v48 offset:36864
    ds_read_b64_tr_b16 v[34:35], v48 offset:37376
    v_mfma_f32_32x32x16_bf16 v[80:95], v[44:47], v[24:27], v[80:95]
    ds_read_b64_tr_b16 v[36:37], v49 offset:36864
    ds_read_b64_tr_b16 v[38:39], v49 offset:37376
    ds_read_b128 v[20:23], v10 offset:36864
    v_mfma_f32_32x32x16_bf16 v[96:111], v[40:43], v[28:31], v[96:111]
    v_mfma_f32_16x16x32_bf16 v[60:63], v[56:59], v[40:43], v[60:63]
    v_mfma_f32_32x32x16_bf16 v[112:127], v[44:47], v[28:31], v[112:127]
    s_waitcnt lgkmcnt(0)
    v_mfma_f32_32x32x16_bf16 v[64:79], v[32:35], v[16:19], v[64:79]
    ds_read_b128 v[24:27], v11 offset:32768
    ds_read_b64_tr_b16 v[40:41], v48 offset:38912
    ds_read_b64_tr_b16 v[42:43], v48 offset:39424
    v_mfma_f32_32x32x16_bf16 v[80:95], v[36:39], v[16:19], v[80:95]
    ds_read_b64_tr_b16 v[44:45], v49 offset:38912
    ds_read_b64_tr_b16 v[46:47], v49 offset:39424
    ds_read_b128 v[28:31], v11 offset:36864
    v_mfma_f32_32x32x16_bf16 v[96:111], v[32:35], v[20:23], v[96:111]
    v_xor_b32 v8, s53, v8
    v_xor_b32 v9, s53, v9
    v_xor_b32 v10, s53, v10
    v_xor_b32 v11, s53, v11
    v_mfma_f32_16x16x32_bf16 v[60:63], v[56:59], v[32:35], v[60:63]
    v_xor_b32 v48, s53, v48
    v_xor_b32 v49, s53, v49
    s_sub_u32 s52, s52, 1
    s_cmp_lg_u32 s52, 0
    v_mfma_f32_32x32x16_bf16 v[112:127], v[36:39], v[20:23], v[112:127]
    s_cbranch_scc1 L1_qloop
    s_waitcnt lgkmcnt(0)
    v_mfma_f32_16x16x32_bf16 v[60:63], v[56:59], v[40:43], v[60:63]
    v_mfma_f32_32x32x16_bf16 v[64:79], v[40:43], v[24:27], v[64:79]
    v_mfma_f32_32x32x16_bf16 v[80:95], v[44:47], v[24:27], v[80:95]
    v_mfma_f32_32x32x16_bf16 v[96:111], v[40:43], v[28:31], v[96:111]
    v_mfma_f32_32x32x16_bf16 v[112:127], v[44:47], v[28:31], v[112:127]
    s_nop 3
    v_cvt_pk_bf16_f32 v5, v60, v61
    v_lshlrev_b32 v6, 16, v5
    v_and_b32 v7, s61, v5
    v_sub_f32 v16, v60, v6
    v_sub_f32 v17, v61, v7
    v_cvt_pk_bf16_f32 v5, v6, v16
    v_cvt_pk_bf16_f32 v6, v7, v17
    s_mov_b64 exec, 0xffff
    ds_write2_b32 v128, v5, v6 offset1:16
    s_mov_b64 exec, -1
    s_waitcnt lgkmcnt(0)
    s_barrier
    ds_read_b64 v[20:21], v129
    ds_read2_b32 v[28:29], v130
    ds_read2_b32 v[30:31], v131
    ds_read_b64 v[22:23], v129 offset:512
    ds_read_b32 v16, v136
    ds_read_b32 v18, v136 offset:128
    s_waitcnt lgkmcnt(4)
    v_mfma_f32_32x32x8_bf16 v[64:79], v[28:29], v[20:21], v[64:79]
    s_waitcnt lgkmcnt(3)
    v_mfma_f32_32x32x8_bf16 v[80:95], v[30:31], v[20:21], v[80:95]
    s_waitcnt lgkmcnt(2)
    v_mfma_f32_32x32x8_bf16 v[96:111], v[28:29], v[22:23], v[96:111]
    v_mfma_f32_32x32x8_bf16 v[112:127], v[30:31], v[22:23], v[112:127]
    s_waitcnt lgkmcnt(0)
    s_nop 5
    v_pk_mul_f32 v[64:65], v[64:65], v[16:17] op_sel_hi:[1,0]
    v_pk_mul_f32 v[66:67], v[66:67], v[16:17] op_sel_hi:[1,0]
    v_pk_mul_f32 v[68:69], v[68:69], v[16:17] op_sel_hi:[1,0]
    v_pk_mul_f32 v[70:71], v[70:71], v[16:17] op_sel_hi:[1,0]
    v_pk_mul_f32 v[72:73], v[72:73], v[16:17] op_sel_hi:[1,0]
    v_pk_mul_f32 v[74:75], v[74:75], v[16:17] op_sel_hi:[1,0]
    v_pk_mul_f32 v[76:77], v[76:77], v[16:17] op_sel_hi:[1,0]
    v_pk_mul_f32 v[78:79], v[78:79], v[16:17] op_sel_hi:[1,0]
    v_cvt_pk_bf16_f32 v32, v64, v65
    v_cvt_pk_bf16_f32 v34, v68, v69
    v_cvt_pk_bf16_f32 v33, v66, v67
    v_cvt_pk_bf16_f32 v35, v70, v71
    v_cvt_pk_bf16_f32 v36, v72, v73
    v_cvt_pk_bf16_f32 v38, v76, v77
    v_cvt_pk_bf16_f32 v37, v74, v75
    v_cvt_pk_bf16_f32 v39, v78, v79
    v_permlane32_swap_b32 v32, v34
    v_permlane32_swap_b32 v33, v35
    v_permlane32_swap_b32 v36, v38
    v_permlane32_swap_b32 v37, v39
    buffer_store_dwordx4 v[32:35], v134, s[28:31], s62 offen offset:0 sc1
    buffer_store_dwordx4 v[36:39], v134, s[28:31], s63 offen offset:0 sc1
    v_pk_mul_f32 v[80:81], v[80:81], v[16:17] op_sel_hi:[1,0]
    v_pk_mul_f32 v[82:83], v[82:83], v[16:17] op_sel_hi:[1,0]
    v_pk_mul_f32 v[84:85], v[84:85], v[16:17] op_sel_hi:[1,0]
    v_pk_mul_f32 v[86:87], v[86:87], v[16:17] op_sel_hi:[1,0]
    v_pk_mul_f32 v[88:89], v[88:89], v[16:17] op_sel_hi:[1,0]
    v_pk_mul_f32 v[90:91], v[90:91], v[16:17] op_sel_hi:[1,0]
    v_pk_mul_f32 v[92:93], v[92:93], v[16:17] op_sel_hi:[1,0]
    v_pk_mul_f32 v[94:95], v[94:95], v[16:17] op_sel_hi:[1,0]
    v_cvt_pk_bf16_f32 v40, v80, v81
    v_cvt_pk_bf16_f32 v42, v84, v85
    v_cvt_pk_bf16_f32 v41, v82, v83
    v_cvt_pk_bf16_f32 v43, v86, v87
    v_cvt_pk_bf16_f32 v44, v88, v89
    v_cvt_pk_bf16_f32 v46, v92, v93
    v_cvt_pk_bf16_f32 v45, v90, v91
    v_cvt_pk_bf16_f32 v47, v94, v95
    v_permlane32_swap_b32 v40, v42
    v_permlane32_swap_b32 v41, v43
    v_permlane32_swap_b32 v44, v46
    v_permlane32_swap_b32 v45, v47
    buffer_store_dwordx4 v[40:43], v134, s[28:31], s64 offen offset:0 sc1
    buffer_store_dwordx4 v[44:47], v134, s[28:31], s65 offen offset:0 sc1
    v_pk_mul_f32 v[96:97], v[96:97], v[18:19] op_sel_hi:[1,0]
    v_pk_mul_f32 v[98:99], v[98:99], v[18:19] op_sel_hi:[1,0]
    v_pk_mul_f32 v[100:101], v[100:101], v[18:19] op_sel_hi:[1,0]
    v_pk_mul_f32 v[102:103], v[102:103], v[18:19] op_sel_hi:[1,0]
    v_pk_mul_f32 v[104:105], v[104:105], v[18:19] op_sel_hi:[1,0]
    v_pk_mul_f32 v[106:107], v[106:107], v[18:19] op_sel_hi:[1,0]
    v_pk_mul_f32 v[108:109], v[108:109], v[18:19] op_sel_hi:[1,0]
    v_pk_mul_f32 v[110:111], v[110:111], v[18:19] op_sel_hi:[1,0]
    v_cvt_pk_bf16_f32 v32, v96, v97
    v_cvt_pk_bf16_f32 v34, v100, v101
    v_cvt_pk_bf16_f32 v33, v98, v99
    v_cvt_pk_bf16_f32 v35, v102, v103
    v_cvt_pk_bf16_f32 v36, v104, v105
    v_cvt_pk_bf16_f32 v38, v108, v109
    v_cvt_pk_bf16_f32 v37, v106, v107
    v_cvt_pk_bf16_f32 v39, v110, v111
    v_permlane32_swap_b32 v32, v34
    v_permlane32_swap_b32 v33, v35
    v_permlane32_swap_b32 v36, v38
    v_permlane32_swap_b32 v37, v39
    buffer_store_dwordx4 v[32:35], v134, s[28:31], s62 offen offset:512 sc1
    buffer_store_dwordx4 v[36:39], v134, s[28:31], s63 offen offset:512 sc1
    v_pk_mul_f32 v[112:113], v[112:113], v[18:19] op_sel_hi:[1,0]
    v_pk_mul_f32 v[114:115], v[114:115], v[18:19] op_sel_hi:[1,0]
    v_pk_mul_f32 v[116:117], v[116:117], v[18:19] op_sel_hi:[1,0]
    v_pk_mul_f32 v[118:119], v[118:119], v[18:19] op_sel_hi:[1,0]
    v_pk_mul_f32 v[120:121], v[120:121], v[18:19] op_sel_hi:[1,0]
    v_pk_mul_f32 v[122:123], v[122:123], v[18:19] op_sel_hi:[1,0]
    v_pk_mul_f32 v[124:125], v[124:125], v[18:19] op_sel_hi:[1,0]
    v_pk_mul_f32 v[126:127], v[126:127], v[18:19] op_sel_hi:[1,0]
    v_cvt_pk_bf16_f32 v40, v112, v113
    v_cvt_pk_bf16_f32 v42, v116, v117
    v_cvt_pk_bf16_f32 v41, v114, v115
    v_cvt_pk_bf16_f32 v43, v118, v119
    v_cvt_pk_bf16_f32 v44, v120, v121
    v_cvt_pk_bf16_f32 v46, v124, v125
    v_cvt_pk_bf16_f32 v45, v122, v123
    v_cvt_pk_bf16_f32 v47, v126, v127
    v_permlane32_swap_b32 v40, v42
    v_permlane32_swap_b32 v41, v43
    v_permlane32_swap_b32 v44, v46
    v_permlane32_swap_b32 v45, v47
    buffer_store_dwordx4 v[40:43], v134, s[28:31], s64 offen offset:512 sc1
    buffer_store_dwordx4 v[44:47], v134, s[28:31], s65 offen offset:512 sc1
    s_branch L1_done
L1_vpre:
    v_mov_b32 v7, 1280
    s_add_u32 s28, s10, 5242880
    s_addc_u32 s29, s11, 0
    s_mov_b32 s30, 2621440
    s_mov_b32 s31, 0x00020000
    s_lshl_b32 s55, s26, 4
    s_lshl_b32 s56, s48, 3
    s_add_u32 s55, s55, s56
    s_mul_i32 s62, s55, 1280
    s_add_u32 s63, s62, 2560
    s_add_u32 s64, s62, 5120
    s_add_u32 s65, s62, 7680
    s_sub_u32 s56, s27, 10
    s_lshl_b32 s56, s56, 7
    s_mov_b32 s57, 326400
    s_lshl_b32 s55, s50, 5
    s_add_u32 s55, s55, s56
    v_add_u32 v5, s55, v3
    v_mul_u32_u24 v6, 52429, v5
    v_lshrrev_b32 v6, 22, v6
    v_mul_lo_u32 v6, v6, s57
    v_lshl_add_u32 v6, v5, 4, v6
    v_mad_u32_u24 v144, v4, v7, v6
    s_lshl_b32 s55, s51, 5
    s_add_u32 s55, s55, s56
    v_add_u32 v5, s55, v3
    v_mul_u32_u24 v6, 52429, v5
    v_lshrrev_b32 v6, 22, v6
    v_mul_lo_u32 v6, v6, s57
    v_lshl_add_u32 v6, v5, 4, v6
    v_mad_u32_u24 v145, v4, v7, v6
.p2align 3
L1_vloop:
    s_waitcnt lgkmcnt(0)
    s_barrier
    v_mfma_f32_32x32x16_bf16 v[64:79], v[24:27], v[40:43], v[64:79]
    ds_read_b128 v[16:19], v8 offset:0
    ds_read_b64_tr_b16 v[32:33], v48 offset:0
    ds_read_b64_tr_b16 v[34:35], v48 offset:512
    v_mfma_f32_32x32x16_bf16 v[80:95], v[24:27], v[44:47], v[80:95]
    ds_read_b64_tr_b16 v[36:37], v49 offset:0
    ds_read_b64_tr_b16 v[38:39], v49 offset:512
    ds_read_b128 v[20:23], v8 offset:4096
    v_mfma_f32_32x32x16_bf16 v[96:111], v[28:31], v[40:43], v[96:111]
    v_mfma_f32_16x16x32_bf16 v[60:63], v[56:59], v[40:43], v[60:63]
    v_mfma_f32_32x32x16_bf16 v[112:127], v[28:31], v[44:47], v[112:127]
    s_waitcnt lgkmcnt(0)
    v_mfma_f32_32x32x16_bf16 v[64:79], v[16:19], v[32:35], v[64:79]
    ds_read_b128 v[24:27], v9 offset:0
    ds_read_b64_tr_b16 v[40:41], v48 offset:2048
    ds_read_b64_tr_b16 v[42:43], v48 offset:2560
    v_mfma_f32_32x32x16_bf16 v[80:95], v[16:19], v[36:39], v[80:95]
    ds_read_b64_tr_b16 v[44:45], v49 offset:2048
    ds_read_b64_tr_b16 v[46:47], v49 offset:2560
    ds_read_b128 v[28:31], v9 offset:4096
    v_mfma_f32_32x32x16_bf16 v[96:111], v[20:23], v[32:35], v[96:111]
    v_mfma_f32_16x16x32_bf16 v[60:63], v[56:59], v[32:35], v[60:63]
    v_mfma_f32_32x32x16_bf16 v[112:127], v[20:23], v[36:39], v[112:127]
    s_waitcnt lgkmcnt(0)
    v_mfma_f32_32x32x16_bf16 v[64:79], v[24:27], v[40:43], v[64:79]
    ds_read_b128 v[16:19], v10 offset:0
    ds_read_b64_tr_b16 v[32:33], v48 offset:4096
    ds_read_b64_tr_b16 v[34:35], v48 offset:4608
    v_mfma_f32_32x32x16_bf16 v[80:95], v[24:27], v[44:47], v[80:95]
    ds_read_b64_tr_b16 v[36:37], v49 offset:4096
    ds_read_b64_tr_b16 v[38:39], v49 offset:4608
    ds_read_b128 v[20:23], v10 offset:4096
    v_mfma_f32_32x32x16_bf16 v[96:111], v[28:31], v[40:43], v[96:111]
    v_mfma_f32_16x16x32_bf16 v[60:63], v[56:59], v[40:43], v[60:63]
    v_mfma_f32_32x32x16_bf16 v[112:127], v[28:31], v[44:47], v[112:127]
    s_waitcnt lgkmcnt(0)
    v_mfma_f32_32x32x16_bf16 v[64:79], v[16:19], v[32:35], v[64:79]
    ds_read_b128 v[24:27], v11 offset:0
    ds_read_b64_tr_b16 v[40:41], v48 offset:6144
    ds_read_b64_tr_b16 v[42:43], v48 offset:6656
    v_mfma_f32_32x32x16_bf16 v[80:95], v[16:19], v[36:39], v[80:95]
    ds_read_b64_tr_b16 v[44:45], v49 offset:6144
    ds_read_b64_tr_b16 v[46:47], v49 offset:6656
    ds_read_b128 v[28:31], v11 offset:4096
    v_mfma_f32_32x32x16_bf16 v[96:111], v[20:23], v[32:35], v[96:111]
    v_mfma_f32_16x16x32_bf16 v[60:63], v[56:59], v[32:35], v[60:63]
    v_mfma_f32_32x32x16_bf16 v[112:127], v[20:23], v[36:39], v[112:127]
    s_waitcnt lgkmcnt(0)
    s_barrier
    v_mfma_f32_32x32x16_bf16 v[64:79], v[24:27], v[40:43], v[64:79]
    ds_read_b128 v[16:19], v8 offset:32768
    ds_read_b64_tr_b16 v[32:33], v48 offset:32768
    ds_read_b64_tr_b16 v[34:35], v48 offset:33280
    v_mfma_f32_32x32x16_bf16 v[80:95], v[24:27], v[44:47], v[80:95]
    ds_read_b64_tr_b16 v[36:37], v49 offset:32768
    ds_read_b64_tr_b16 v[38:39], v49 offset:33280
    ds_read_b128 v[20:23], v8 offset:36864
    v_mfma_f32_32x32x16_bf16 v[96:111], v[28:31], v[40:43], v[96:111]
    v_mfma_f32_16x16x32_bf16 v[60:63], v[56:59], v[40:43], v[60:63]
    v_mfma_f32_32x32x16_bf16 v[112:127], v[28:31], v[44:47], v[112:127]
    s_waitcnt lgkmcnt(0)
    v_mfma_f32_32x32x16_bf16 v[64:79], v[16:19], v[32:35], v[64:79]
    ds_read_b128 v[24:27], v9 offset:32768
    ds_read_b64_tr_b16 v[40:41], v48 offset:34816
    ds_read_b64_tr_b16 v[42:43], v48 offset:35328
    v_mfma_f32_32x32x16_bf16 v[80:95], v[16:19], v[36:39], v[80:95]
    ds_read_b64_tr_b16 v[44:45], v49 offset:34816
    ds_read_b64_tr_b16 v[46:47], v49 offset:35328
    ds_read_b128 v[28:31], v9 offset:36864
    v_mfma_f32_32x32x16_bf16 v[96:111], v[20:23], v[32:35], v[96:111]
    v_mfma_f32_16x16x32_bf16 v[60:63], v[56:59], v[32:35], v[60:63]
    v_mfma_f32_32x32x16_bf16 v[112:127], v[20:23], v[36:39], v[112:127]
    s_waitcnt lgkmcnt(0)
    v_mfma_f32_32x32x16_bf16 v[64:79], v[24:27], v[40:43], v[64:79]
    ds_read_b128 v[16:19], v10 offset:32768
    ds_read_b64_tr_b16 v[32:33], v48 offset:36864
    ds_read_b64_tr_b16 v[34:35], v48 offset:37376
    v_mfma_f32_32x32x16_bf16 v[80:95], v[24:27], v[44:47], v[80:95]
    ds_read_b64_tr_b16 v[36:37], v49 offset:36864
    ds_read_b64_tr_b16 v[38:39], v49 offset:37376
    ds_read_b128 v[20:23], v10 offset:36864
    v_mfma_f32_32x32x16_bf16 v[96:111], v[28:31], v[40:43], v[96:111]
    v_mfma_f32_16x16x32_bf16 v[60:63], v[56:59], v[40:43], v[60:63]
    v_mfma_f32_32x32x16_bf16 v[112:127], v[28:31], v[44:47], v[112:127]
    s_waitcnt lgkmcnt(0)
    v_mfma_f32_32x32x16_bf16 v[64:79], v[16:19], v[32:35], v[64:79]
    ds_read_b128 v[24:27], v11 offset:32768
    ds_read_b64_tr_b16 v[40:41], v48 offset:38912
    ds_read_b64_tr_b16 v[42:43], v48 offset:39424
    v_mfma_f32_32x32x16_bf16 v[80:95], v[16:19], v[36:39], v[80:95]
    ds_read_b64_tr_b16 v[44:45], v49 offset:38912
    ds_read_b64_tr_b16 v[46:47], v49 offset:39424
    ds_read_b128 v[28:31], v11 offset:36864
    v_mfma_f32_32x32x16_bf16 v[96:111], v[20:23], v[32:35], v[96:111]
    v_xor_b32 v8, s53, v8
    v_xor_b32 v9, s53, v9
    v_xor_b32 v10, s53, v10
    v_xor_b32 v11, s53, v11
    v_mfma_f32_16x16x32_bf16 v[60:63], v[56:59], v[32:35], v[60:63]
    v_xor_b32 v48, s53, v48
    v_xor_b32 v49, s53, v49
    s_sub_u32 s52, s52, 1
    s_cmp_lg_u32 s52, 0
    v_mfma_f32_32x32x16_bf16 v[112:127], v[20:23], v[36:39], v[112:127]
    s_cbranch_scc1 L1_vloop
    s_waitcnt lgkmcnt(0)
    v_mfma_f32_16x16x32_bf16 v[60:63], v[56:59], v[40:43], v[60:63]
    v_mfma_f32_32x32x16_bf16 v[64:79], v[24:27], v[40:43], v[64:79]
    v_mfma_f32_32x32x16_bf16 v[80:95], v[24:27], v[44:47], v[80:95]
    v_mfma_f32_32x32x16_bf16 v[96:111], v[28:31], v[40:43], v[96:111]
    v_mfma_f32_32x32x16_bf16 v[112:127], v[28:31], v[44:47], v[112:127]
    s_nop 3
    v_cvt_pk_bf16_f32 v5, v60, v61
    v_lshlrev_b32 v6, 16, v5
    v_and_b32 v7, s61, v5
    v_sub_f32 v16, v60, v6
    v_sub_f32 v17, v61, v7
    v_cvt_pk_bf16_f32 v5, v6, v16
    v_cvt_pk_bf16_f32 v6, v7, v17
    s_mov_b64 exec, 0xffff
    ds_write2_b32 v128, v5, v6 offset1:16
    s_mov_b64 exec, -1
    s_waitcnt lgkmcnt(0)
    s_barrier
    ds_read_b64 v[20:21], v129
    ds_read2_b32 v[28:29], v130
    ds_read2_b32 v[30:31], v131
    ds_read_b64 v[22:23], v129 offset:512
    ds_read_b128 v[148:151], v135 offset:0
    ds_read_b128 v[152:155], v135 offset:32
    ds_read_b128 v[156:159], v135 offset:64
    ds_read_b128 v[160:163], v135 offset:96
    ds_read_b128 v[164:167], v135 offset:128
    ds_read_b128 v[168:171], v135 offset:160
    ds_read_b128 v[172:175], v135 offset:192
    ds_read_b128 v[176:179], v135 offset:224
    s_waitcnt lgkmcnt(10)
    v_mfma_f32_32x32x8_bf16 v[64:79], v[20:21], v[28:29], v[64:79]
    s_waitcnt lgkmcnt(9)
    v_mfma_f32_32x32x8_bf16 v[80:95], v[20:21], v[30:31], v[80:95]
    s_waitcnt lgkmcnt(8)
    v_mfma_f32_32x32x8_bf16 v[96:111], v[22:23], v[28:29], v[96:111]
    v_mfma_f32_32x32x8_bf16 v[112:127], v[22:23], v[30:31], v[112:127]
    s_waitcnt lgkmcnt(0)
    s_nop 5
    v_pk_mul_f32 v[64:65], v[64:65], v[148:149]
    v_pk_mul_f32 v[66:67], v[66:67], v[150:151]
    v_pk_mul_f32 v[68:69], v[68:69], v[152:153]
    v_pk_mul_f32 v[70:71], v[70:71], v[154:155]
    v_pk_mul_f32 v[72:73], v[72:73], v[156:157]
    v_pk_mul_f32 v[74:75], v[74:75], v[158:159]
    v_pk_mul_f32 v[76:77], v[76:77], v[160:161]
    v_pk_mul_f32 v[78:79], v[78:79], v[162:163]
    v_cvt_pk_bf16_f32 v32, v64, v65
    v_cvt_pk_bf16_f32 v34, v68, v69
    v_cvt_pk_bf16_f32 v33, v66, v67
    v_cvt_pk_bf16_f32 v35, v70, v71
    v_cvt_pk_bf16_f32 v36, v72, v73
    v_cvt_pk_bf16_f32 v38, v76, v77
    v_cvt_pk_bf16_f32 v37, v74, v75
    v_cvt_pk_bf16_f32 v39, v78, v79
    v_permlane32_swap_b32 v32, v34
    v_permlane32_swap_b32 v33, v35
    v_permlane32_swap_b32 v36, v38
    v_permlane32_swap_b32 v37, v39
    buffer_store_dwordx4 v[32:35], v144, s[28:31], s62 offen sc1
    buffer_store_dwordx4 v[36:39], v144, s[28:31], s63 offen sc1
    v_pk_mul_f32 v[80:81], v[80:81], v[148:149]
    v_pk_mul_f32 v[82:83], v[82:83], v[150:151]
    v_pk_mul_f32 v[84:85], v[84:85], v[152:153]
    v_pk_mul_f32 v[86:87], v[86:87], v[154:155]
    v_pk_mul_f32 v[88:89], v[88:89], v[156:157]
    v_pk_mul_f32 v[90:91], v[90:91], v[158:159]
    v_pk_mul_f32 v[92:93], v[92:93], v[160:161]
    v_pk_mul_f32 v[94:95], v[94:95], v[162:163]
    v_cvt_pk_bf16_f32 v40, v80, v81
    v_cvt_pk_bf16_f32 v42, v84, v85
    v_cvt_pk_bf16_f32 v41, v82, v83
    v_cvt_pk_bf16_f32 v43, v86, v87
    v_cvt_pk_bf16_f32 v44, v88, v89
    v_cvt_pk_bf16_f32 v46, v92, v93
    v_cvt_pk_bf16_f32 v45, v90, v91
    v_cvt_pk_bf16_f32 v47, v94, v95
    v_permlane32_swap_b32 v40, v42
    v_permlane32_swap_b32 v41, v43
    v_permlane32_swap_b32 v44, v46
    v_permlane32_swap_b32 v45, v47
    buffer_store_dwordx4 v[40:43], v145, s[28:31], s62 offen sc1
    buffer_store_dwordx4 v[44:47], v145, s[28:31], s63 offen sc1
    v_pk_mul_f32 v[96:97], v[96:97], v[164:165]
    v_pk_mul_f32 v[98:99], v[98:99], v[166:167]
    v_pk_mul_f32 v[100:101], v[100:101], v[168:169]
    v_pk_mul_f32 v[102:103], v[102:103], v[170:171]
    v_pk_mul_f32 v[104:105], v[104:105], v[172:173]
    v_pk_mul_f32 v[106:107], v[106:107], v[174:175]
    v_pk_mul_f32 v[108:109], v[108:109], v[176:177]
    v_pk_mul_f32 v[110:111], v[110:111], v[178:179]
    v_cvt_pk_bf16_f32 v32, v96, v97
    v_cvt_pk_bf16_f32 v34, v100, v101
    v_cvt_pk_bf16_f32 v33, v98, v99
    v_cvt_pk_bf16_f32 v35, v102, v103
    v_cvt_pk_bf16_f32 v36, v104, v105
    v_cvt_pk_bf16_f32 v38, v108, v109
    v_cvt_pk_bf16_f32 v37, v106, v107
    v_cvt_pk_bf16_f32 v39, v110, v111
    v_permlane32_swap_b32 v32, v34
    v_permlane32_swap_b32 v33, v35
    v_permlane32_swap_b32 v36, v38
    v_permlane32_swap_b32 v37, v39
    buffer_store_dwordx4 v[32:35], v144, s[28:31], s64 offen sc1
    buffer_store_dwordx4 v[36:39], v144, s[28:31], s65 offen sc1
    v_pk_mul_f32 v[112:113], v[112:113], v[164:165]
    v_pk_mul_f32 v[114:115], v[114:115], v[166:167]
    v_pk_mul_f32 v[116:117], v[116:117], v[168:169]
    v_pk_mul_f32 v[118:119], v[118:119], v[170:171]
    v_pk_mul_f32 v[120:121], v[120:121], v[172:173]
    v_pk_mul_f32 v[122:123], v[122:123], v[174:175]
    v_pk_mul_f32 v[124:125], v[124:125], v[176:177]
    v_pk_mul_f32 v[126:127], v[126:127], v[178:179]
    v_cvt_pk_bf16_f32 v40, v112, v113
    v_cvt_pk_bf16_f32 v42, v116, v117
    v_cvt_pk_bf16_f32 v41, v114, v115
    v_cvt_pk_bf16_f32 v43, v118, v119
    v_cvt_pk_bf16_f32 v44, v120, v121
    v_cvt_pk_bf16_f32 v46, v124, v125
    v_cvt_pk_bf16_f32 v45, v122, v123
    v_cvt_pk_bf16_f32 v47, v126, v127
    v_permlane32_swap_b32 v40, v42
    v_permlane32_swap_b32 v41, v43
    v_permlane32_swap_b32 v44, v46
    v_permlane32_swap_b32 v45, v47
    buffer_store_dwordx4 v[40:43], v145, s[28:31], s64 offen sc1
    buffer_store_dwordx4 v[44:47], v145, s[28:31], s65 offen sc1
L1_done:
    s_lshl_b32 s55, s27, 10
    s_lshr_b32 s56, s26, 2
    s_lshl_b32 s56, s56, 8
    s_add_u32 s55, s55, s56
    s_and_b32 s56, s26, 3
    s_lshl_b32 s56, s56, 2
    s_add_u32 s57, s55, s56
    s_add_u32 s57, s57, 16512
    s_lshl_b32 s55, s20, 8
    s_lshl_b32 s56, s21, 2
    s_add_u32 s55, s55, s56
    s_add_u32 s55, s55, 4096
    s_getreg_b32 s58, hwreg(HW_REG_XCC_ID, 0, 4)
    s_add_u32 s58, s58, 1
    s_cmp_eq_u32 s22, 0
    s_cselect_b32 s70, s57, s55
    s_cselect_b32 s71, 1, s58
    s_cselect_b32 s56, s27, 0
    s_and_b32 s57, s22, 1
    s_mul_i32 s57, s57, 15
    s_max_u32 s56, s56, s57
    s_cmp_lt_u32 s56, 15
    s_cselect_b32 s46, s46, 0
    v_mov_b32 v1, s71
    s_mov_b64 exec, 1
    s_waitcnt vmcnt(0)
    s_barrier
    buffer_store_dword v1, off, s[44:47], s70 sc1
    s_mov_b64 exec, -1
    s_mov_b32 s46, 131072
L2_nsig:
    s_mov_b32 s36, s10
    s_mov_b32 s37, s11
    s_mov_b32 s38, 0
    s_mov_b32 s39, 0x00020000
    s_mov_b32 s86, 0
    s_mov_b32 s87, 0
    s_mov_b32 s88, 0
    s_mul_i32 s90, s23, 39936
    s_add_u32 s90, s90, 8192
    v_mov_b32 v224, 0
    v_mov_b32 v225, 0
    v_mov_b32 v226, 0
    v_mov_b32 v227, 0
    v_mov_b32 v228, 0
    v_mov_b32 v229, 0
    v_mov_b32 v230, 0
    v_mov_b32 v231, 0
    s_lshl_b32 s26, s20, 2
    s_lshr_b32 s55, s21, 3
    s_add_u32 s26, s26, s55
    s_and_b32 s27, s21, 7
    s_lshr_b32 s55, s26, 1
    s_mul_i32 s55, s55, 5
    s_and_b32 s48, s26, 1
    s_mul_i32 s56, s48, 3
    s_add_u32 s56, s56, s55
    s_lshl_b32 s56, s56, 15
    s_add_u32 s55, s55, 2
    s_lshl_b32 s55, s55, 15
    s_lshl_b32 s57, s48, 3
    s_add_u32 s55, s55, s57
    v_lshlrev_b32 v7, 4, v3
    v_lshl_add_u32 v7, v4, 15, v7
    s_lshl_b32 s57, s23, 9
    s_add_u32 s58, s57, s56
    s_add_u32 s58, s58, 2621440
    v_add_u32 v24, s58, v7
    v_lshrrev_b32 v5, 1, v2
    v_and_b32 v6, 1, v2
    v_lshlrev_b32 v5, 4, v5
    v_lshl_add_u32 v5, v6, 2, v5
    s_add_u32 s58, s57, s55
    s_add_u32 s58, s58, 2621440
    v_add_u32 v25, s58, v5
    v_mul_u32_u24 v5, 1280, v4
    v_lshl_add_u32 v5, v3, 4, v5
    s_mul_i32 s58, s23, 5120
    s_mul_i32 s59, s26, 320
    s_add_u32 s58, s58, s59
    s_lshr_b32 s59, s26, 2
    s_mul_i32 s59, s59, 326400
    s_add_u32 s58, s58, s59
    v_add_u32 v26, s58, v5
    v_add_u32 v27, 1536, v26
    s_lshl_b32 s58, s27, 12
    s_lshl_b32 s59, s23, 10
    s_add_u32 s58, s58, s59
    s_lshl_b32 s59, s24, 9
    s_add_u32 s58, s58, s59
    s_add_u32 s59, s58, s56
    v_add_u32 v28, s59, v7
    s_add_u32 s59, s58, s55
    v_lshl_add_u32 v29, v3, 4, s59
    v_xor_b32 v245, 512, v28
    v_xor_b32 v246, 512, v29
    s_mul_i32 s60, s24, 79872
    s_add_u32 s60, s60, 25600
    v_lshl_add_u32 v30, v2, 4, s60
    v_lshl_add_u32 v31, v2, 3, s60
    v_min_u32 v5, 20, v3
    v_cmp_lt_u32 vcc, 27, v3
    s_nop 1
    v_cndmask_b32 v5, v5, 16, vcc
    v_lshl_add_u32 v5, v4, 5, v5
    v_lshl_add_u32 v247, v5, 4, s60
    s_lshl_b32 s55, s23, 10
    s_add_u32 s49, s60, s55
    s_lshl_b32 s55, s23, 8
    s_add_u32 s50, s60, s55
    s_add_u32 s50, s50, 4096
    s_lshl_b32 s55, s23, 11
    s_add_u32 s51, s60, s55
    s_add_u32 s51, s51, 5120
    s_mov_b32 s62, 0x000fffff
    s_mov_b32 s63, 0x000fffff
    s_mov_b32 s64, 0
    s_mov_b32 s91, 0
    s_add_u32 s28, s10, 0
    s_addc_u32 s29, s11, 0
    s_mov_b32 s30, 5242880
    s_mov_b32 s31, 0x00020000
    s_add_u32 s32, s10, 5242880
    s_addc_u32 s33, s11, 0
    s_mov_b32 s34, 2621440
    s_mov_b32 s35, 0x00020000
    s_and_b32 s55, s21, 7
    s_mul_i32 s55, s55, 102400
    s_mul_i32 s56, s23, 25600
    s_add_u32 s55, s55, s56
    s_mul_i32 s56, s24, 12288
    s_add_u32 s55, s55, s56
    s_add_u32 s55, s55, 20185088
    s_mul_i32 s65, s23, 39936
    s_add_u32 s65, s65, s56
    s_add_u32 s40, s10, s55
    s_addc_u32 s41, s11, 0
    s_mov_b32 s42, 13312
    s_mov_b32 s43, 0x00020000
    v_mov_b32 v128, 0
    v_mov_b32 v129, 0
    v_mov_b32 v130, 0
    v_mov_b32 v131, 0
    v_mov_b32 v132, 0
    v_mov_b32 v133, 0
    v_mov_b32 v134, 0
    v_mov_b32 v135, 0
    v_mov_b32 v136, 0
    v_mov_b32 v137, 0
    v_mov_b32 v138, 0
    v_mov_b32 v139, 0
    v_mov_b32 v140, 0
    v_mov_b32 v141, 0
    v_mov_b32 v142, 0
    v_mov_b32 v143, 0
    v_mov_b32 v144, 0
    v_mov_b32 v145, 0
    v_mov_b32 v146, 0
    v_mov_b32 v147, 0
    v_mov_b32 v148, 0
    v_mov_b32 v149, 0
    v_mov_b32 v150, 0
    v_mov_b32 v151, 0
    v_mov_b32 v152, 0
    v_mov_b32 v153, 0
    v_mov_b32 v154, 0
    v_mov_b32 v155, 0
    v_mov_b32 v156, 0
    v_mov_b32 v157, 0
    v_mov_b32 v158, 0
    v_mov_b32 v159, 0
    s_lshl_b32 s55, s21, 3
    s_add_u32 s55, s55, s22
    s_lshl_b32 s55, s55, 6
    v_add_u32 v5, s55, v2
    v_lshrrev_b32 v6, 8, v5
    v_mul_u32_u24 v6, 35840, v6
    v_and_b32 v7, 255, v5
    v_lshl_add_u32 v6, v7, 7, v6
    v_add_u32 v237, 23330816, v6
    s_mov_b32 s92, s10
    s_mov_b32 s93, s11
    s_mov_b32 s94, 26083328
    s_mov_b32 s95, 0x00020000
    s_mov_b32 s74, 25624576
    s_lshl_b32 s66, s20, 7
    s_lshl_b32 s55, s21, 2
    s_add_u32 s66, s66, s55
    s_add_u32 s66, s66, 25960448
    s_cmp_eq_u32 s22, 0
    s_cselect_b32 s89, 26083328, 0
    s_cselect_b32 s75, 131072, 0
    s_lshl_b32 s67, s20, 8
    s_add_u32 s67, s67, 4096
    s_mov_b32 s68, 8192
    s_getreg_b32 s69, hwreg(HW_REG_XCC_ID, 0, 4)
    s_add_u32 s69, s69, 1
    v_lshlrev_b32 v234, 4, v2
    v_lshlrev_b32 v235, 2, v3
    v_lshlrev_b32 v240, 2, v2
    v_lshrrev_b32 v38, 4, v2
    v_mul_u32_u24 v38, 39936, v38
    v_and_b32 v6, 15, v2
    v_lshl_add_u32 v38, v6, 9, v38
    v_mov_b32 v32, 0x3f803f80
    v_mov_b32 v33, v32
    v_mov_b32 v34, v32
    v_mov_b32 v35, v32
    v_mov_b32 v36, 0
    v_mov_b32 v37, 162816
    v_mov_b32 v1, 0xdddddddd
    v_mov_b32 v96, 0
    v_mov_b32 v97, 0
    v_mov_b32 v98, 0
    v_mov_b32 v99, 0
    v_mov_b32 v100, 0
    v_mov_b32 v101, 0
    v_mov_b32 v102, 0
    v_mov_b32 v103, 0
    v_mov_b32 v104, 0
    v_mov_b32 v105, 0
    v_mov_b32 v106, 0
    v_mov_b32 v107, 0
    v_mov_b32 v108, 0
    v_mov_b32 v109, 0
    v_mov_b32 v110, 0
    v_mov_b32 v111, 0
    v_mov_b32 v112, 0
    v_mov_b32 v113, 0
    v_mov_b32 v114, 0
    v_mov_b32 v115, 0
    v_mov_b32 v116, 0
    v_mov_b32 v117, 0
    v_mov_b32 v118, 0
    v_mov_b32 v119, 0
    v_mov_b32 v120, 0
    v_mov_b32 v121, 0
    v_mov_b32 v122, 0
    v_mov_b32 v123, 0
    v_mov_b32 v124, 0
    v_mov_b32 v125, 0
    v_mov_b32 v126, 0
    v_mov_b32 v127, 0
    v_mov_b32 v88, 0
    v_mov_b32 v89, 0
    v_mov_b32 v90, 0
    v_mov_b32 v91, 0
    v_mov_b32 v92, 0
    v_mov_b32 v93, 0
    v_mov_b32 v94, 0
    v_mov_b32 v95, 0
    v_mov_b32 v184, 0
    v_mov_b32 v185, 0
    v_mov_b32 v186, 0
    v_mov_b32 v187, 0
    s_mul_i32 s55, s23, 3072
    s_add_u32 s56, s55, s60
    v_lshl_add_u32 v241, v2, 4, s56
    s_xor_b32 s56, s24, 1
    s_mul_i32 s56, s56, 79872
    s_add_u32 s56, s56, s55
    s_add_u32 s56, s56, 25600
    v_lshl_add_u32 v242, v2, 4, s56
    s_lshl_b32 s55, s27, 3
    s_lshl_b32 s56, s23, 1
    s_add_u32 s55, s55, s56
    s_add_u32 s54, s55, s24
    s_mul_i32 s55, s54, 40960
    s_add_u32 s55, s55, 7864320
    s_lshr_b32 s56, s26, 3
    s_mul_i32 s56, s56, 5120
    s_add_u32 s55, s55, s56
    s_bfe_u32 s56, s26, 0x20001
    s_lshl_b32 s57, s56, 10
    s_add_u32 s57, s57, s55
    s_lshl_b32 s58, s48, 9
    s_add_u32 s57, s57, s58
    s_lshl_b32 s58, s56, 8
    s_add_u32 s58, s58, s55
    s_lshl_b32 s59, s48, 3
    s_add_u32 s58, s58, s59
    s_add_u32 s58, s58, 4096
    v_bfe_u32 v6, v2, 4, 1
    v_mul_u32_u24 v6, 20480, v6
    v_and_b32 v7, 15, v2
    v_lshl_add_u32 v244, v7, 4, v6
    v_lshl_add_u32 v243, v4, 8, v244
    s_lshl_b32 s54, s54, 10
    s_lshr_b32 s59, s26, 2
    s_lshl_b32 s59, s59, 7
    s_add_u32 s54, s54, s59
    s_and_b32 s59, s26, 3
    s_lshl_b32 s59, s59, 2
    s_add_u32 s54, s54, s59
    s_add_u32 s54, s54, 65536
    s_lshl_b32 s59, s2, 3
    s_add_u32 s59, s59, s22
    s_mul_i32 s59, s59, 1280
    s_add_u32 s59, s59, 7864320
    v_bfe_u32 v45, v2, 2, 1
    v_mul_u32_u24 v45, 19, v45
    s_mul_i32 s55, s26, 20
    v_add_u32 v45, s55, v45
    v_lshrrev_b32 v45, 7, v45
    v_lshrrev_b32 v44, 3, v2
    v_mul_u32_u24 v44, 5, v44
    v_add_u32 v45, v45, v44
    v_and_b32 v44, 3, v2
    v_lshlrev_b32 v44, 8, v44
    v_lshl_add_u32 v44, v45, 10, v44
    v_add_u32 v44, 16512, v44
    s_cmp_eq_u32 s85, 0
    s_cbranch_scc1 L2_npoll
    s_barrier
    s_cmp_lg_u32 s22, 7
    s_cbranch_scc1 L2_jdec
    s_mov_b64 s[70:71], 0xffffff
    s_mov_b64 exec, 0xffffff
    s_mov_b32 s3, 400000
Lp4:
    s_sleep 8
    buffer_load_dwordx4 v[40:43], v44, s[44:47], 0 offen sc1
Lp4_c:
    s_waitcnt vmcnt(0)
    v_cmp_eq_u32 vcc, 0, v40
    s_and_b64 s[72:73], vcc, s[70:71]
    v_cmp_eq_u32 vcc, 0, v41
    s_and_b64 vcc, vcc, s[70:71]
    s_or_b64 s[72:73], s[72:73], vcc
    v_cmp_eq_u32 vcc, 0, v42
    s_and_b64 vcc, vcc, s[70:71]
    s_or_b64 s[72:73], s[72:73], vcc
    v_cmp_eq_u32 vcc, 0, v43
    s_and_b64 vcc, vcc, s[70:71]
    s_or_b64 s[72:73], s[72:73], vcc
    s_sub_u32 s3, s3, 1
    s_cselect_b64 s[72:73], 0, s[72:73]
    s_cmp_lg_u64 s[72:73], 0
    s_cbranch_scc1 Lp4
    s_mov_b64 exec, -1
L2_npoll:
    s_barrier
L2_main:
    s_lshl_b32 s52, s24, 14
    s_mul_i32 s53, s24, 163840
    s_add_u32 m0, s49, 0
    s_nop 0
    buffer_load_dwordx4 v24, s[28:31], s52 offen sc1 lds
    s_add_u32 m0, s50, 0
    s_nop 0
    buffer_load_dword v25, s[28:31], s52 offen sc1 lds
    s_add_u32 s52, s52, 2048
    s_add_u32 m0, s51, 0
    s_mov_b64 exec, s[62:63]
    buffer_load_dwordx4 v26, s[32:35], s53 offen sc1 lds
    s_mov_b64 exec, -1
    s_mov_b64 exec, s[62:63]
    buffer_load_dwordx4 v27, s[32:35], s53 offen offset:1024 sc1 lds
    s_mov_b64 exec, -1
    s_add_u32 s53, s53, 20480
    ds_write_b128 v38, v[32:35] offset:31040
    ds_write_b32 v37, v36
    buffer_load_dwordx4 v[8:11], v28, s[28:31], 0 offen sc1
    buffer_load_dwordx4 v[12:15], v245, s[28:31], 0 offen sc1
    buffer_load_dwordx2 v[16:17], v29, s[28:31], 0 offen sc1
    buffer_load_dwordx2 v[20:21], v246, s[28:31], 0 offen sc1
    v_cmp_gt_u32 vcc, 32, v2
    s_waitcnt vmcnt(0) lgkmcnt(0)
    s_barrier
    ds_read_b128 v[160:163], v30
    ds_read_b64 v[168:169], v31 offset:4096
    ds_read_b128 v[164:167], v30 offset:1024
    ds_read_b128 v[172:175], v247 offset:5120
    ds_read_b128 v[176:179], v247 offset:6144
    s_add_u32 m0, s49, 39936
    s_nop 0
    buffer_load_dwordx4 v24, s[28:31], s52 offen sc1 lds
    s_add_u32 m0, s50, 39936
    s_nop 0
    buffer_load_dword v25, s[28:31], s52 offen sc1 lds
    s_add_u32 s52, s52, 2048
    s_add_u32 m0, s51, 39936
    s_mov_b64 exec, s[62:63]
    buffer_load_dwordx4 v26, s[32:35], s53 offen sc1 lds
    s_mov_b64 exec, -1
    s_mov_b64 exec, s[62:63]
    buffer_load_dwordx4 v27, s[32:35], s53 offen offset:1024 sc1 lds
    s_mov_b64 exec, -1
    s_add_u32 s53, s53, 20480
    v_cndmask_b32 v18, v16, 0, vcc
    v_cndmask_b32 v19, v17, 0, vcc
    v_cndmask_b32 v16, 0, v16, vcc
    v_cndmask_b32 v17, 0, v17, vcc
    v_cndmask_b32 v22, v20, 0, vcc
    v_cndmask_b32 v23, v21, 0, vcc
    v_cndmask_b32 v20, 0, v20, vcc
    v_cndmask_b32 v21, 0, v21, vcc
    s_waitcnt lgkmcnt(0)
    v_mfma_f32_32x32x16_bf16 v[32:47], v[160:163], v[8:11], v[128:143]
    v_mfma_f32_32x32x8_bf16 v[32:47], v[168:169], v[16:17], v[32:47]
    v_mfma_f32_32x32x16_bf16 v[48:63], v[160:163], v[12:15], v[144:159]
    v_mfma_f32_32x32x8_bf16 v[48:63], v[168:169], v[20:21], v[48:63]
    s_nop 8
    s_nop 1
    v_exp_f32 v32, v32
    v_exp_f32 v33, v33
    v_smfmac_f32_32x32x32_bf16 v[112:127], v[184:187], v[88:95], v1
    s_waitcnt lgkmcnt(0)
    v_exp_f32 v34, v34
    s_add_u32 m0, s90, 0
    v_exp_f32 v35, v35
    buffer_load_dwordx4 v224, s[36:39], 0 offen offset:0 lds
    v_exp_f32 v36, v36
    v_exp_f32 v37, v37
    v_mfma_f32_32x32x16_bf16 v[64:79], v[164:167], v[8:11], v[128:143]
    ds_read_b128 v[180:183], v247 offset:7168
    ds_read_b128 v[184:187], v247 offset:8192
    v_exp_f32 v38, v38
    v_exp_f32 v39, v39
    v_exp_f32 v40, v40
    s_add_u32 m0, s90, 0
    v_exp_f32 v41, v41
    buffer_load_dwordx4 v225, s[36:39], 0 offen offset:1024 lds
    v_mfma_f32_32x32x8_bf16 v[64:79], v[168:169], v[18:19], v[64:79]
    v_exp_f32 v42, v42
    v_exp_f32 v43, v43
    v_exp_f32 v44, v44
    v_exp_f32 v45, v45
    v_smfmac_f32_32x32x32_bf16 v[96:111], v[172:175], v[32:39], v1
    v_exp_f32 v46, v46
    s_add_u32 m0, s90, 0
    v_exp_f32 v47, v47
    buffer_load_dwordx4 v226, s[36:39], 0 offen offset:2048 lds
    v_exp_f32 v48, v48
    v_exp_f32 v49, v49
    v_smfmac_f32_32x32x32_bf16 v[96:111], v[176:179], v[40:47], v1
    v_exp_f32 v50, v50
    v_exp_f32 v51, v51
    v_exp_f32 v52, v52
    v_exp_f32 v53, v53
    v_mfma_f32_32x32x16_bf16 v[80:95], v[164:167], v[12:15], v[144:159]
    v_exp_f32 v54, v54
    v_exp_f32 v55, v55
    v_exp_f32 v56, v56
    s_add_u32 m0, s90, 0
    v_exp_f32 v57, v57
    buffer_load_dwordx4 v227, s[36:39], 0 offen offset:3072 lds
    v_mfma_f32_32x32x8_bf16 v[80:95], v[168:169], v[22:23], v[80:95]
    ds_read_b128 v[160:163], v30 offset:2048
    ds_read_b64 v[170:171], v31 offset:4608
    v_exp_f32 v58, v58
    v_exp_f32 v59, v59
    v_exp_f32 v60, v60
    v_exp_f32 v61, v61
    v_smfmac_f32_32x32x32_bf16 v[112:127], v[172:175], v[48:55], v1
    v_exp_f32 v62, v62
    v_exp_f32 v63, v63
    v_exp_f32 v64, v64
    v_exp_f32 v65, v65
    v_smfmac_f32_32x32x32_bf16 v[112:127], v[176:179], v[56:63], v1
    s_waitcnt lgkmcnt(0)
    v_exp_f32 v66, v66
    s_add_u32 m0, s90, 4096
    v_exp_f32 v67, v67
    buffer_load_dwordx4 v228, s[36:39], 0 offen offset:0 lds
    v_exp_f32 v68, v68
    v_exp_f32 v69, v69
    v_mfma_f32_32x32x16_bf16 v[32:47], v[160:163], v[8:11], v[128:143]
    ds_read_b128 v[172:175], v247 offset:9216
    ds_read_b128 v[176:179], v247 offset:10240
    v_exp_f32 v70, v70
    v_exp_f32 v71, v71
    v_exp_f32 v72, v72
    s_add_u32 m0, s90, 4096
    v_exp_f32 v73, v73
    buffer_load_dwordx4 v229, s[36:39], 0 offen offset:1024 lds
    v_mfma_f32_32x32x8_bf16 v[32:47], v[170:171], v[16:17], v[32:47]
    v_exp_f32 v74, v74
    v_exp_f32 v75, v75
    v_exp_f32 v76, v76
    v_exp_f32 v77, v77
    v_smfmac_f32_32x32x32_bf16 v[96:111], v[180:183], v[64:71], v1
    v_exp_f32 v78, v78
    s_add_u32 m0, s90, 4096
    v_exp_f32 v79, v79
    buffer_load_dwordx4 v230, s[36:39], 0 offen offset:2048 lds
    v_exp_f32 v80, v80
    v_exp_f32 v81, v81
    v_smfmac_f32_32x32x32_bf16 v[96:111], v[184:187], v[72:79], v1
    v_exp_f32 v82, v82
    v_exp_f32 v83, v83
    v_exp_f32 v84, v84
    v_exp_f32 v85, v85
    v_mfma_f32_32x32x16_bf16 v[48:63], v[160:163], v[12:15], v[144:159]
    v_exp_f32 v86, v86
    v_exp_f32 v87, v87
    v_exp_f32 v88, v88
    s_add_u32 m0, s90, 4096
    v_exp_f32 v89, v89
    buffer_load_dwordx4 v231, s[36:39], 0 offen offset:3072 lds
    v_mfma_f32_32x32x8_bf16 v[48:63], v[170:171], v[20:21], v[48:63]
    ds_read_b128 v[164:167], v30 offset:3072
    v_exp_f32 v90, v90
    v_exp_f32 v91, v91
    v_exp_f32 v92, v92
    v_exp_f32 v93, v93
    v_smfmac_f32_32x32x32_bf16 v[112:127], v[180:183], v[80:87], v1
    v_exp_f32 v94, v94
    v_exp_f32 v95, v95
    v_exp_f32 v32, v32
    v_exp_f32 v33, v33
    v_smfmac_f32_32x32x32_bf16 v[112:127], v[184:187], v[88:95], v1
    s_waitcnt lgkmcnt(0)
    v_exp_f32 v34, v34
    v_exp_f32 v35, v35
    v_exp_f32 v36, v36
    v_exp_f32 v37, v37
    v_mfma_f32_32x32x16_bf16 v[64:79], v[164:167], v[8:11], v[128:143]
    ds_read_b128 v[180:183], v247 offset:11264
    ds_read_b128 v[184:187], v247 offset:12288
    v_exp_f32 v38, v38
    v_exp_f32 v39, v39
    v_exp_f32 v40, v40
    v_exp_f32 v41, v41
    v_mfma_f32_32x32x8_bf16 v[64:79], v[170:171], v[18:19], v[64:79]
    v_exp_f32 v42, v42
    v_exp_f32 v43, v43
    v_exp_f32 v44, v44
    v_exp_f32 v45, v45
    v_smfmac_f32_32x32x32_bf16 v[96:111], v[172:175], v[32:39], v1
    v_exp_f32 v46, v46
    v_exp_f32 v47, v47
    v_exp_f32 v48, v48
    v_exp_f32 v49, v49
    v_smfmac_f32_32x32x32_bf16 v[96:111], v[176:179], v[40:47], v1
    v_exp_f32 v50, v50
    v_exp_f32 v51, v51
    v_exp_f32 v52, v52
    v_exp_f32 v53, v53
    v_mfma_f32_32x32x16_bf16 v[80:95], v[164:167], v[12:15], v[144:159]
    v_exp_f32 v54, v54
    v_exp_f32 v55, v55
    v_exp_f32 v56, v56
    v_exp_f32 v57, v57
    v_mfma_f32_32x32x8_bf16 v[80:95], v[170:171], v[22:23], v[80:95]
    s_waitcnt vmcnt(8) lgkmcnt(0)
    s_barrier
    ds_read_b128 v[160:163], v30 offset:39936
    ds_read_b64 v[168:169], v31 offset:44032
    v_exp_f32 v58, v58
    v_exp_f32 v59, v59
    s_add_u32 m0, s49, 0
    v_exp_f32 v60, v60
    buffer_load_dwordx4 v24, s[28:31], s52 offen sc1 lds
    v_exp_f32 v61, v61
    v_smfmac_f32_32x32x32_bf16 v[112:127], v[172:175], v[48:55], v1
    v_exp_f32 v62, v62
    s_add_u32 m0, s50, 0
    v_exp_f32 v63, v63
    buffer_load_dword v25, s[28:31], s52 offen sc1 lds
    s_add_u32 s52, s52, 2048
    v_exp_f32 v64, v64
    v_exp_f32 v65, v65
    v_smfmac_f32_32x32x32_bf16 v[112:127], v[176:179], v[56:63], v1
    s_waitcnt lgkmcnt(0)
    v_exp_f32 v66, v66
    s_add_u32 m0, s51, 0
    s_mov_b64 exec, s[62:63]
    buffer_load_dwordx4 v26, s[32:35], s53 offen sc1 lds
    s_mov_b64 exec, -1
    v_exp_f32 v67, v67
    v_exp_f32 v68, v68
    v_exp_f32 v69, v69
    v_mfma_f32_32x32x16_bf16 v[32:47], v[160:163], v[8:11], v[128:143]
    ds_read_b128 v[172:175], v247 offset:45056
    ds_read_b128 v[176:179], v247 offset:46080
    v_exp_f32 v70, v70
    s_mov_b64 exec, s[62:63]
    buffer_load_dwordx4 v27, s[32:35], s53 offen offset:1024 sc1 lds
    s_mov_b64 exec, -1
    s_add_u32 s53, s53, 20480
    v_exp_f32 v71, v71
    v_exp_f32 v72, v72
    v_exp_f32 v73, v73
    v_mfma_f32_32x32x8_bf16 v[32:47], v[168:169], v[16:17], v[32:47]
    v_exp_f32 v74, v74
    v_exp_f32 v75, v75
    v_exp_f32 v76, v76
    v_exp_f32 v77, v77
    v_smfmac_f32_32x32x32_bf16 v[96:111], v[180:183], v[64:71], v1
    v_exp_f32 v78, v78
    v_exp_f32 v79, v79
    v_exp_f32 v80, v80
    v_exp_f32 v81, v81
    v_smfmac_f32_32x32x32_bf16 v[96:111], v[184:187], v[72:79], v1
    v_exp_f32 v82, v82
    v_exp_f32 v83, v83
    v_exp_f32 v84, v84
    v_exp_f32 v85, v85
    v_mfma_f32_32x32x16_bf16 v[48:63], v[160:163], v[12:15], v[144:159]
    v_exp_f32 v86, v86
    v_exp_f32 v87, v87
    v_exp_f32 v88, v88
    v_exp_f32 v89, v89
    v_mfma_f32_32x32x8_bf16 v[48:63], v[168:169], v[20:21], v[48:63]
    ds_read_b128 v[164:167], v30 offset:40960
    v_exp_f32 v90, v90
    v_exp_f32 v91, v91
    v_exp_f32 v92, v92
    v_exp_f32 v93, v93
    v_smfmac_f32_32x32x32_bf16 v[112:127], v[180:183], v[80:87], v1
    v_exp_f32 v94, v94
    v_exp_f32 v95, v95
    v_exp_f32 v32, v32
    v_exp_f32 v33, v33
    v_smfmac_f32_32x32x32_bf16 v[112:127], v[184:187], v[88:95], v1
    s_waitcnt lgkmcnt(0)
    v_exp_f32 v34, v34
    v_exp_f32 v35, v35
    v_exp_f32 v36, v36
    v_exp_f32 v37, v37
    v_mfma_f32_32x32x16_bf16 v[64:79], v[164:167], v[8:11], v[128:143]
    ds_read_b128 v[180:183], v247 offset:47104
    ds_read_b128 v[184:187], v247 offset:48128
    v_exp_f32 v38, v38
    v_exp_f32 v39, v39
    v_exp_f32 v40, v40
    v_exp_f32 v41, v41
    v_mfma_f32_32x32x8_bf16 v[64:79], v[168:169], v[18:19], v[64:79]
    v_exp_f32 v42, v42
    v_exp_f32 v43, v43
    v_mov_b32 v188, -1
    v_mov_b32 v189, -1
    v_mov_b32 v190, -1
    v_mov_b32 v191, -1
    s_cmp_eq_u32 s64, 0
    s_cselect_b32 s94, 26083328, 0
    buffer_store_dwordx4 v[188:191], v234, s[92:95], s59 offen sc1
    v_exp_f32 v44, v44
    v_exp_f32 v45, v45
    v_smfmac_f32_32x32x32_bf16 v[96:111], v[172:175], v[32:39], v1
    v_exp_f32 v46, v46
    v_exp_f32 v47, v47
    v_exp_f32 v48, v48
    v_exp_f32 v49, v49
    v_smfmac_f32_32x32x32_bf16 v[96:111], v[176:179], v[40:47], v1
    v_exp_f32 v50, v50
    v_exp_f32 v51, v51
    s_cmp_eq_u32 s64, 0
    s_cselect_b32 s94, 26083328, 0
    s_mov_b64 exec, 0xffff
    buffer_store_dwordx4 v[188:191], v234, s[92:95], s59 offen offset:1024 sc1
    s_mov_b64 exec, -1
    v_exp_f32 v52, v52
    v_exp_f32 v53, v53
    v_mfma_f32_32x32x16_bf16 v[80:95], v[164:167], v[12:15], v[144:159]
    v_exp_f32 v54, v54
    v_exp_f32 v55, v55
    v_exp_f32 v56, v56
    v_exp_f32 v57, v57
    v_mfma_f32_32x32x8_bf16 v[80:95], v[168:169], v[22:23], v[80:95]
    ds_read_b128 v[160:163], v30 offset:41984
    ds_read_b64 v[170:171], v31 offset:44544
    v_exp_f32 v58, v58
    v_exp_f32 v59, v59
    v_exp_f32 v60, v60
    v_exp_f32 v61, v61
    v_smfmac_f32_32x32x32_bf16 v[112:127], v[172:175], v[48:55], v1
    v_exp_f32 v62, v62
    v_exp_f32 v63, v63
    v_exp_f32 v64, v64
    v_exp_f32 v65, v65
    v_smfmac_f32_32x32x32_bf16 v[112:127], v[176:179], v[56:63], v1
    s_waitcnt lgkmcnt(0)
    v_exp_f32 v66, v66
    v_exp_f32 v67, v67
    v_exp_f32 v68, v68
    v_exp_f32 v69, v69
    v_mfma_f32_32x32x16_bf16 v[32:47], v[160:163], v[8:11], v[128:143]
    ds_read_b128 v[172:175], v247 offset:49152
    ds_read_b128 v[176:179], v247 offset:50176
    v_exp_f32 v70, v70
    v_exp_f32 v71, v71
    v_exp_f32 v72, v72
    v_exp_f32 v73, v73
    v_mfma_f32_32x32x8_bf16 v[32:47], v[170:171], v[16:17], v[32:47]
    v_exp_f32 v74, v74
    v_exp_f32 v75, v75
    v_exp_f32 v76, v76
    v_exp_f32 v77, v77
    v_smfmac_f32_32x32x32_bf16 v[96:111], v[180:183], v[64:71], v1
    v_exp_f32 v78, v78
    v_exp_f32 v79, v79
    v_exp_f32 v80, v80
    v_exp_f32 v81, v81
    v_smfmac_f32_32x32x32_bf16 v[96:111], v[184:187], v[72:79], v1
    v_exp_f32 v82, v82
    v_exp_f32 v83, v83
    v_exp_f32 v84, v84
    v_exp_f32 v85, v85
    v_mfma_f32_32x32x16_bf16 v[48:63], v[160:163], v[12:15], v[144:159]
    v_exp_f32 v86, v86
    v_exp_f32 v87, v87
    v_exp_f32 v88, v88
    v_exp_f32 v89, v89
    v_mfma_f32_32x32x8_bf16 v[48:63], v[170:171], v[20:21], v[48:63]
    ds_read_b128 v[164:167], v30 offset:43008
    v_exp_f32 v90, v90
    v_exp_f32 v91, v91
    v_exp_f32 v92, v92
    v_exp_f32 v93, v93
    v_smfmac_f32_32x32x32_bf16 v[112:127], v[180:183], v[80:87], v1
    v_exp_f32 v94, v94
    v_exp_f32 v95, v95
    v_exp_f32 v32, v32
    v_exp_f32 v33, v33
    v_smfmac_f32_32x32x32_bf16 v[112:127], v[184:187], v[88:95], v1
    s_waitcnt lgkmcnt(0)
    v_exp_f32 v34, v34
    v_exp_f32 v35, v35
    v_exp_f32 v36, v36
    v_exp_f32 v37, v37
    v_mfma_f32_32x32x16_bf16 v[64:79], v[164:167], v[8:11], v[128:143]
    ds_read_b128 v[180:183], v247 offset:51200
    ds_read_b128 v[184:187], v247 offset:52224
    v_exp_f32 v38, v38
    v_exp_f32 v39, v39
    v_exp_f32 v40, v40
    v_exp_f32 v41, v41
    v_mfma_f32_32x32x8_bf16 v[64:79], v[170:171], v[18:19], v[64:79]
    v_exp_f32 v42, v42
    v_exp_f32 v43, v43
    v_exp_f32 v44, v44
    v_exp_f32 v45, v45
    v_smfmac_f32_32x32x32_bf16 v[96:111], v[172:175], v[32:39], v1
    v_exp_f32 v46, v46
    v_exp_f32 v47, v47
    v_exp_f32 v48, v48
    v_exp_f32 v49, v49
    v_smfmac_f32_32x32x32_bf16 v[96:111], v[176:179], v[40:47], v1
    v_exp_f32 v50, v50
    v_exp_f32 v51, v51
    v_exp_f32 v52, v52
    v_exp_f32 v53, v53
    v_mfma_f32_32x32x16_bf16 v[80:95], v[164:167], v[12:15], v[144:159]
    v_exp_f32 v54, v54
    v_exp_f32 v55, v55
    v_exp_f32 v56, v56
    v_exp_f32 v57, v57
    v_mfma_f32_32x32x8_bf16 v[80:95], v[170:171], v[22:23], v[80:95]
    s_waitcnt vmcnt(2) lgkmcnt(0)
    s_barrier
    ds_read_b128 v[160:163], v30 offset:0
    ds_read_b64 v[168:169], v31 offset:4096
    v_exp_f32 v58, v58
    v_exp_f32 v59, v59
    s_add_u32 m0, s49, 39936
    v_exp_f32 v60, v60
    buffer_load_dwordx4 v24, s[28:31], s52 offen sc1 lds
    v_exp_f32 v61, v61
    v_smfmac_f32_32x32x32_bf16 v[112:127], v[172:175], v[48:55], v1
    v_exp_f32 v62, v62
    s_add_u32 m0, s50, 39936
    v_exp_f32 v63, v63
    buffer_load_dword v25, s[28:31], s52 offen sc1 lds
    s_add_u32 s52, s52, 2048
    v_exp_f32 v64, v64
    v_exp_f32 v65, v65
    v_smfmac_f32_32x32x32_bf16 v[112:127], v[176:179], v[56:63], v1
    s_waitcnt lgkmcnt(0)
    v_exp_f32 v66, v66
    s_add_u32 m0, s51, 39936
    s_mov_b64 exec, s[62:63]
    buffer_load_dwordx4 v26, s[32:35], s53 offen sc1 lds
    s_mov_b64 exec, -1
    v_exp_f32 v67, v67
    v_exp_f32 v68, v68
    v_exp_f32 v69, v69
    v_mfma_f32_32x32x16_bf16 v[32:47], v[160:163], v[8:11], v[128:143]
    ds_read_b128 v[172:175], v247 offset:5120
    ds_read_b128 v[176:179], v247 offset:6144
    v_exp_f32 v70, v70
    s_mov_b64 exec, s[62:63]
    buffer_load_dwordx4 v27, s[32:35], s53 offen offset:1024 sc1 lds
    s_mov_b64 exec, -1
    s_add_u32 s53, s53, 20480
    v_exp_f32 v71, v71
    v_exp_f32 v72, v72
    v_exp_f32 v73, v73
    v_mfma_f32_32x32x8_bf16 v[32:47], v[168:169], v[16:17], v[32:47]
    v_exp_f32 v74, v74
    v_exp_f32 v75, v75
    v_exp_f32 v76, v76
    v_exp_f32 v77, v77
    v_smfmac_f32_32x32x32_bf16 v[96:111], v[180:183], v[64:71], v1
    v_exp_f32 v78, v78
    v_exp_f32 v79, v79
    v_exp_f32 v80, v80
    v_exp_f32 v81, v81
    v_smfmac_f32_32x32x32_bf16 v[96:111], v[184:187], v[72:79], v1
    v_exp_f32 v82, v82
    v_exp_f32 v83, v83
    v_exp_f32 v84, v84
    v_exp_f32 v85, v85
    v_mfma_f32_32x32x16_bf16 v[48:63], v[160:163], v[12:15], v[144:159]
    v_exp_f32 v86, v86
    v_exp_f32 v87, v87
    v_exp_f32 v88, v88
    v_exp_f32 v89, v89
    v_mfma_f32_32x32x8_bf16 v[48:63], v[168:169], v[20:21], v[48:63]
    ds_read_b128 v[164:167], v30 offset:1024
    v_exp_f32 v90, v90
    v_exp_f32 v91, v91
    v_exp_f32 v92, v92
    v_exp_f32 v93, v93
    v_smfmac_f32_32x32x32_bf16 v[112:127], v[180:183], v[80:87], v1
    v_exp_f32 v94, v94
    v_exp_f32 v95, v95
    v_exp_f32 v32, v32
    v_exp_f32 v33, v33
    v_smfmac_f32_32x32x32_bf16 v[112:127], v[184:187], v[88:95], v1
    s_waitcnt lgkmcnt(0)
    s_cmp_eq_u32 s85, 0
    s_cbranch_scc1 L2_jfr
    v_lshrrev_b32 v5, 4, v2
    v_bfe_u32 v6, v2, 2, 2
    v_lshl_add_u32 v5, v5, 3, v6
    v_lshlrev_b32 v5, 8, v5
    v_lshl_add_u32 v5, v6, 5, v5
    v_bfe_u32 v6, v2, 4, 1
    v_lshl_add_u32 v5, v6, 7, v5
    v_and_b32 v6, 3, v2
    v_lshl_add_u32 v5, v6, 3, v5
    v_add_u32 v5, s90, v5
    v_xor_b32 v6, 0, v5
    ds_read_b64_tr_b16 v[192:193], v6
    ds_read_b64_tr_b16 v[194:195], v6 offset:1024
    v_xor_b32 v6, 32, v5
    ds_read_b64_tr_b16 v[196:197], v6
    ds_read_b64_tr_b16 v[198:199], v6 offset:1024
    v_xor_b32 v6, 64, v5
    ds_read_b64_tr_b16 v[200:201], v6
    ds_read_b64_tr_b16 v[202:203], v6 offset:1024
    v_xor_b32 v6, 96, v5
    ds_read_b64_tr_b16 v[204:205], v6
    ds_read_b64_tr_b16 v[206:207], v6 offset:1024
    v_xor_b32 v6, 128, v5
    ds_read_b64_tr_b16 v[208:209], v6
    ds_read_b64_tr_b16 v[210:211], v6 offset:1024
    v_xor_b32 v6, 160, v5
    ds_read_b64_tr_b16 v[212:213], v6
    ds_read_b64_tr_b16 v[214:215], v6 offset:1024
    v_xor_b32 v6, 192, v5
    ds_read_b64_tr_b16 v[216:217], v6
    ds_read_b64_tr_b16 v[218:219], v6 offset:1024
    s_waitcnt lgkmcnt(8)
    v_xor_b32 v6, 224, v5
    ds_read_b64_tr_b16 v[220:221], v6
    ds_read_b64_tr_b16 v[222:223], v6 offset:1024
    v_and_b32 v5, 15, v2
    v_mov_b32 v6, 0x3f803f80
    v_cmp_eq_u32 vcc, 0, v5
    s_nop 1
    v_cndmask_b32 v188, 0, v6, vcc
    v_cndmask_b32 v189, 0, v6, vcc
    v_cndmask_b32 v190, 0, v6, vcc
    v_cndmask_b32 v191, 0, v6, vcc
    s_waitcnt lgkmcnt(0)
    s_nop 0
    v_mfma_f32_16x16x32_bf16 v[224:227], v[188:191], v[192:195], 0
    v_mfma_f32_16x16x32_bf16 v[228:231], v[188:191], v[208:211], 0
    v_cmp_eq_u32 vcc, 4, v5
    s_nop 1
    v_cndmask_b32 v188, 0, v6, vcc
    v_cndmask_b32 v189, 0, v6, vcc
    v_cndmask_b32 v190, 0, v6, vcc
    v_cndmask_b32 v191, 0, v6, vcc
    s_nop 1
    v_mfma_f32_16x16x32_bf16 v[224:227], v[188:191], v[196:199], v[224:227]
    v_mfma_f32_16x16x32_bf16 v[228:231], v[188:191], v[212:215], v[228:231]
    v_cmp_eq_u32 vcc, 8, v5
    s_nop 1
    v_cndmask_b32 v188, 0, v6, vcc
    v_cndmask_b32 v189, 0, v6, vcc
    v_cndmask_b32 v190, 0, v6, vcc
    v_cndmask_b32 v191, 0, v6, vcc
    s_nop 1
    v_mfma_f32_16x16x32_bf16 v[224:227], v[188:191], v[200:203], v[224:227]
    v_mfma_f32_16x16x32_bf16 v[228:231], v[188:191], v[216:219], v[228:231]
    v_cmp_eq_u32 vcc, 12, v5
    s_nop 1
    v_cndmask_b32 v188, 0, v6, vcc
    v_cndmask_b32 v189, 0, v6, vcc
    v_cndmask_b32 v190, 0, v6, vcc
    v_cndmask_b32 v191, 0, v6, vcc
    s_nop 1
    v_mfma_f32_16x16x32_bf16 v[224:227], v[188:191], v[204:207], v[224:227]
    v_mfma_f32_16x16x32_bf16 v[228:231], v[188:191], v[220:223], v[228:231]
L2_jfr:
    v_exp_f32 v34, v34
    v_exp_f32 v35, v35
    v_exp_f32 v36, v36
    v_exp_f32 v37, v37
    v_mfma_f32_32x32x16_bf16 v[64:79], v[164:167], v[8:11], v[128:143]
    ds_read_b128 v[180:183], v247 offset:7168
    ds_read_b128 v[184:187], v247 offset:8192
    v_exp_f32 v38, v38
    v_exp_f32 v39, v39
    v_exp_f32 v40, v40
    v_exp_f32 v41, v41
    v_mfma_f32_32x32x8_bf16 v[64:79], v[168:169], v[18:19], v[64:79]
    v_exp_f32 v42, v42
    v_exp_f32 v43, v43
    s_mov_b32 s94, s86
    buffer_store_dwordx4 v[192:195], v234, s[92:95], s76 offen sc1
    v_exp_f32 v44, v44
    v_exp_f32 v45, v45
    v_smfmac_f32_32x32x32_bf16 v[96:111], v[172:175], v[32:39], v1
    v_exp_f32 v46, v46
    v_exp_f32 v47, v47
    v_exp_f32 v48, v48
    v_exp_f32 v49, v49
    v_smfmac_f32_32x32x32_bf16 v[96:111], v[176:179], v[40:47], v1
    v_exp_f32 v50, v50
    v_exp_f32 v51, v51
    s_mov_b32 s94, s86
    buffer_store_dwordx4 v[196:199], v234, s[92:95], s77 offen sc1
    v_exp_f32 v52, v52
    v_exp_f32 v53, v53
    v_mfma_f32_32x32x16_bf16 v[80:95], v[164:167], v[12:15], v[144:159]
    v_exp_f32 v54, v54
    v_exp_f32 v55, v55
    v_exp_f32 v56, v56
    v_exp_f32 v57, v57
    v_mfma_f32_32x32x8_bf16 v[80:95], v[168:169], v[22:23], v[80:95]
    ds_read_b128 v[160:163], v30 offset:2048
    ds_read_b64 v[170:171], v31 offset:4608
    v_exp_f32 v58, v58
    v_exp_f32 v59, v59
    s_mov_b32 s94, s86
    buffer_store_dwordx4 v[200:203], v234, s[92:95], s78 offen sc1
    v_exp_f32 v60, v60
    v_exp_f32 v61, v61
    v_smfmac_f32_32x32x32_bf16 v[112:127], v[172:175], v[48:55], v1
    v_exp_f32 v62, v62
    v_exp_f32 v63, v63
    v_exp_f32 v64, v64
    v_exp_f32 v65, v65
    v_smfmac_f32_32x32x32_bf16 v[112:127], v[176:179], v[56:63], v1
    s_waitcnt lgkmcnt(0)
    v_exp_f32 v66, v66
    v_exp_f32 v67, v67
    s_mov_b32 s94, s86
    buffer_store_dwordx4 v[204:207], v234, s[92:95], s79 offen sc1
    v_exp_f32 v68, v68
    v_exp_f32 v69, v69
    v_mfma_f32_32x32x16_bf16 v[32:47], v[160:163], v[8:11], v[128:143]
    ds_read_b128 v[172:175], v247 offset:9216
    ds_read_b128 v[176:179], v247 offset:10240
    v_exp_f32 v70, v70
    v_exp_f32 v71, v71
    v_exp_f32 v72, v72
    v_exp_f32 v73, v73
    v_mfma_f32_32x32x8_bf16 v[32:47], v[170:171], v[16:17], v[32:47]
    v_exp_f32 v74, v74
    v_exp_f32 v75, v75
    s_mov_b32 s94, s87
    buffer_store_dwordx4 v[208:211], v234, s[92:95], s80 offen sc1
    v_exp_f32 v76, v76
    v_exp_f32 v77, v77
    v_smfmac_f32_32x32x32_bf16 v[96:111], v[180:183], v[64:71], v1
    v_exp_f32 v78, v78
    v_exp_f32 v79, v79
    v_exp_f32 v80, v80
    v_exp_f32 v81, v81
    v_smfmac_f32_32x32x32_bf16 v[96:111], v[184:187], v[72:79], v1
    v_exp_f32 v82, v82
    v_exp_f32 v83, v83
    s_mov_b32 s94, s87
    buffer_store_dwordx4 v[212:215], v234, s[92:95], s81 offen sc1
    v_exp_f32 v84, v84
    v_exp_f32 v85, v85
    v_mfma_f32_32x32x16_bf16 v[48:63], v[160:163], v[12:15], v[144:159]
    v_exp_f32 v86, v86
    v_exp_f32 v87, v87
    v_exp_f32 v88, v88
    v_exp_f32 v89, v89
    v_mfma_f32_32x32x8_bf16 v[48:63], v[170:171], v[20:21], v[48:63]
    ds_read_b128 v[164:167], v30 offset:3072
    v_exp_f32 v90, v90
    v_exp_f32 v91, v91
    s_mov_b32 s94, s87
    buffer_store_dwordx4 v[216:219], v234, s[92:95], s82 offen sc1
    v_exp_f32 v92, v92
    v_exp_f32 v93, v93
    v_smfmac_f32_32x32x32_bf16 v[112:127], v[180:183], v[80:87], v1
    v_exp_f32 v94, v94
    v_exp_f32 v95, v95
    v_exp_f32 v32, v32
    v_exp_f32 v33, v33
    v_smfmac_f32_32x32x32_bf16 v[112:127], v[184:187], v[88:95], v1
    s_waitcnt lgkmcnt(0)
    v_exp_f32 v34, v34
    v_exp_f32 v35, v35
    s_mov_b32 s94, s87
    buffer_store_dwordx4 v[220:223], v234, s[92:95], s83 offen sc1
    v_exp_f32 v36, v36
    v_exp_f32 v37, v37
    v_mfma_f32_32x32x16_bf16 v[64:79], v[164:167], v[8:11], v[128:143]
    ds_read_b128 v[180:183], v247 offset:11264
    ds_read_b128 v[184:187], v247 offset:12288
    v_exp_f32 v38, v38
    v_exp_f32 v39, v39
    v_exp_f32 v40, v40
    v_exp_f32 v41, v41
    v_mfma_f32_32x32x8_bf16 v[64:79], v[170:171], v[18:19], v[64:79]
    v_exp_f32 v42, v42
    v_exp_f32 v43, v43
    s_mov_b32 s94, s88
    buffer_store_dword v224, v240, s[92:95], s84 offen offset:0 sc1
    v_exp_f32 v44, v44
    v_exp_f32 v45, v45
    v_smfmac_f32_32x32x32_bf16 v[96:111], v[172:175], v[32:39], v1
    v_exp_f32 v46, v46
    v_exp_f32 v47, v47
    v_exp_f32 v48, v48
    v_exp_f32 v49, v49
    v_smfmac_f32_32x32x32_bf16 v[96:111], v[176:179], v[40:47], v1
    v_exp_f32 v50, v50
    v_exp_f32 v51, v51
    s_mov_b32 s94, s88
    buffer_store_dword v228, v240, s[92:95], s84 offen offset:256 sc1
    v_exp_f32 v52, v52
    v_exp_f32 v53, v53
    v_mfma_f32_32x32x16_bf16 v[80:95], v[164:167], v[12:15], v[144:159]
    v_exp_f32 v54, v54
    v_exp_f32 v55, v55
    v_exp_f32 v56, v56
    v_exp_f32 v57, v57
    v_mfma_f32_32x32x8_bf16 v[80:95], v[170:171], v[22:23], v[80:95]
    s_waitcnt vmcnt(10) lgkmcnt(0)
    s_barrier
    ds_read_b128 v[160:163], v30 offset:39936
    ds_read_b64 v[168:169], v31 offset:44032
    v_exp_f32 v58, v58
    v_exp_f32 v59, v59
    s_add_u32 m0, s49, 0
    v_exp_f32 v60, v60
    buffer_load_dwordx4 v24, s[28:31], s52 offen sc1 lds
    v_exp_f32 v61, v61
    v_smfmac_f32_32x32x32_bf16 v[112:127], v[172:175], v[48:55], v1
    v_exp_f32 v62, v62
    s_add_u32 m0, s50, 0
    v_exp_f32 v63, v63
    buffer_load_dword v25, s[28:31], s52 offen sc1 lds
    s_add_u32 s52, s52, 2048
    v_exp_f32 v64, v64
    v_exp_f32 v65, v65
    v_smfmac_f32_32x32x32_bf16 v[112:127], v[176:179], v[56:63], v1
    s_waitcnt lgkmcnt(0)
    v_exp_f32 v66, v66
    s_add_u32 m0, s51, 0
    s_mov_b64 exec, s[62:63]
    buffer_load_dwordx4 v26, s[32:35], s53 offen sc1 lds
    s_mov_b64 exec, -1
    v_exp_f32 v67, v67
    v_exp_f32 v68, v68
    v_exp_f32 v69, v69
    v_mfma_f32_32x32x16_bf16 v[32:47], v[160:163], v[8:11], v[128:143]
    ds_read_b128 v[172:175], v247 offset:45056
    ds_read_b128 v[176:179], v247 offset:46080
    v_exp_f32 v70, v70
    s_mov_b64 exec, s[62:63]
    buffer_load_dwordx4 v27, s[32:35], s53 offen offset:1024 sc1 lds
    s_mov_b64 exec, -1
    s_add_u32 s53, s53, 20480
    v_exp_f32 v71, v71
    v_exp_f32 v72, v72
    v_exp_f32 v73, v73
    v_mfma_f32_32x32x8_bf16 v[32:47], v[168:169], v[16:17], v[32:47]
    v_exp_f32 v74, v74
    v_exp_f32 v75, v75
    v_exp_f32 v76, v76
    v_exp_f32 v77, v77
    v_smfmac_f32_32x32x32_bf16 v[96:111], v[180:183], v[64:71], v1
    v_exp_f32 v78, v78
    v_exp_f32 v79, v79
    v_exp_f32 v80, v80
    v_exp_f32 v81, v81
    v_smfmac_f32_32x32x32_bf16 v[96:111], v[184:187], v[72:79], v1
    v_exp_f32 v82, v82
    v_exp_f32 v83, v83
    v_exp_f32 v84, v84
    v_exp_f32 v85, v85
    v_mfma_f32_32x32x16_bf16 v[48:63], v[160:163], v[12:15], v[144:159]
    v_exp_f32 v86, v86
    v_exp_f32 v87, v87
    v_exp_f32 v88, v88
    v_exp_f32 v89, v89
    v_mfma_f32_32x32x8_bf16 v[48:63], v[168:169], v[20:21], v[48:63]
    ds_read_b128 v[164:167], v30 offset:40960
    v_exp_f32 v90, v90
    v_exp_f32 v91, v91
    v_exp_f32 v92, v92
    v_exp_f32 v93, v93
    v_smfmac_f32_32x32x32_bf16 v[112:127], v[180:183], v[80:87], v1
    v_exp_f32 v94, v94
    v_exp_f32 v95, v95
    v_exp_f32 v32, v32
    v_exp_f32 v33, v33
    v_smfmac_f32_32x32x32_bf16 v[112:127], v[184:187], v[88:95], v1
    s_waitcnt lgkmcnt(0)
    v_exp_f32 v34, v34
    v_exp_f32 v35, v35
    v_exp_f32 v36, v36
    v_exp_f32 v37, v37
    v_mfma_f32_32x32x16_bf16 v[64:79], v[164:167], v[8:11], v[128:143]
    ds_read_b128 v[180:183], v247 offset:47104
    ds_read_b128 v[184:187], v247 offset:48128
    v_exp_f32 v38, v38
    v_exp_f32 v39, v39
    v_exp_f32 v40, v40
    v_exp_f32 v41, v41
    v_mfma_f32_32x32x8_bf16 v[64:79], v[168:169], v[18:19], v[64:79]
    v_exp_f32 v42, v42
    v_exp_f32 v43, v43
    v_exp_f32 v44, v44
    v_exp_f32 v45, v45
    v_smfmac_f32_32x32x32_bf16 v[96:111], v[172:175], v[32:39], v1
    v_exp_f32 v46, v46
    v_exp_f32 v47, v47
    v_exp_f32 v48, v48
    v_exp_f32 v49, v49
    v_smfmac_f32_32x32x32_bf16 v[96:111], v[176:179], v[40:47], v1
    v_exp_f32 v50, v50
    v_exp_f32 v51, v51
    v_exp_f32 v52, v52
    v_exp_f32 v53, v53
    v_mfma_f32_32x32x16_bf16 v[80:95], v[164:167], v[12:15], v[144:159]
    v_exp_f32 v54, v54
    v_exp_f32 v55, v55
    v_exp_f32 v56, v56
    v_exp_f32 v57, v57
    v_mfma_f32_32x32x8_bf16 v[80:95], v[168:169], v[22:23], v[80:95]
    ds_read_b128 v[160:163], v30 offset:41984
    ds_read_b64 v[170:171], v31 offset:44544
    v_exp_f32 v58, v58
    v_exp_f32 v59, v59
    v_exp_f32 v60, v60
    v_exp_f32 v61, v61
    v_smfmac_f32_32x32x32_bf16 v[112:127], v[172:175], v[48:55], v1
    v_exp_f32 v62, v62
    v_exp_f32 v63, v63
    v_exp_f32 v64, v64
    v_exp_f32 v65, v65
    v_smfmac_f32_32x32x32_bf16 v[112:127], v[176:179], v[56:63], v1
    s_waitcnt lgkmcnt(0)
    v_exp_f32 v66, v66
    v_exp_f32 v67, v67
    v_exp_f32 v68, v68
    v_exp_f32 v69, v69
    v_mfma_f32_32x32x16_bf16 v[32:47], v[160:163], v[8:11], v[128:143]
    ds_read_b128 v[172:175], v247 offset:49152
    ds_read_b128 v[176:179], v247 offset:50176
    v_exp_f32 v70, v70
    v_exp_f32 v71, v71
    v_exp_f32 v72, v72
    v_exp_f32 v73, v73
    v_mfma_f32_32x32x8_bf16 v[32:47], v[170:171], v[16:17], v[32:47]
    v_exp_f32 v74, v74
    v_exp_f32 v75, v75
    v_exp_f32 v76, v76
    v_exp_f32 v77, v77
    v_smfmac_f32_32x32x32_bf16 v[96:111], v[180:183], v[64:71], v1
    v_exp_f32 v78, v78
    v_exp_f32 v79, v79
    v_exp_f32 v80, v80
    v_exp_f32 v81, v81
    v_smfmac_f32_32x32x32_bf16 v[96:111], v[184:187], v[72:79], v1
    v_exp_f32 v82, v82
    v_exp_f32 v83, v83
    v_exp_f32 v84, v84
    v_exp_f32 v85, v85
    v_mfma_f32_32x32x16_bf16 v[48:63], v[160:163], v[12:15], v[144:159]
    v_exp_f32 v86, v86
    v_exp_f32 v87, v87
    v_exp_f32 v88, v88
    v_exp_f32 v89, v89
    v_mfma_f32_32x32x8_bf16 v[48:63], v[170:171], v[20:21], v[48:63]
    ds_read_b128 v[164:167], v30 offset:43008
    v_exp_f32 v90, v90
    v_exp_f32 v91, v91
    v_exp_f32 v92, v92
    v_exp_f32 v93, v93
    v_smfmac_f32_32x32x32_bf16 v[112:127], v[180:183], v[80:87], v1
    v_exp_f32 v94, v94
    v_exp_f32 v95, v95
    v_exp_f32 v32, v32
    v_exp_f32 v33, v33
    v_smfmac_f32_32x32x32_bf16 v[112:127], v[184:187], v[88:95], v1
    s_waitcnt lgkmcnt(0)
    v_exp_f32 v34, v34
    v_exp_f32 v35, v35
    v_exp_f32 v36, v36
    v_exp_f32 v37, v37
    v_mfma_f32_32x32x16_bf16 v[64:79], v[164:167], v[8:11], v[128:143]
    ds_read_b128 v[180:183], v247 offset:51200
    ds_read_b128 v[184:187], v247 offset:52224
    v_exp_f32 v38, v38
    v_exp_f32 v39, v39
    v_exp_f32 v40, v40
    v_exp_f32 v41, v41
    v_mfma_f32_32x32x8_bf16 v[64:79], v[170:171], v[18:19], v[64:79]
    v_exp_f32 v42, v42
    v_exp_f32 v43, v43
    v_exp_f32 v44, v44
    v_exp_f32 v45, v45
    v_smfmac_f32_32x32x32_bf16 v[96:111], v[172:175], v[32:39], v1
    v_exp_f32 v46, v46
    v_exp_f32 v47, v47
    v_exp_f32 v48, v48
    v_exp_f32 v49, v49
    v_smfmac_f32_32x32x32_bf16 v[96:111], v[176:179], v[40:47], v1
    v_exp_f32 v50, v50
    v_exp_f32 v51, v51
    v_exp_f32 v52, v52
    v_exp_f32 v53, v53
    v_mfma_f32_32x32x16_bf16 v[80:95], v[164:167], v[12:15], v[144:159]
    v_exp_f32 v54, v54
    v_exp_f32 v55, v55
    v_exp_f32 v56, v56
    v_exp_f32 v57, v57
    v_mfma_f32_32x32x8_bf16 v[80:95], v[170:171], v[22:23], v[80:95]
    s_waitcnt vmcnt(0) lgkmcnt(0)
    s_barrier
    ds_read_b128 v[160:163], v30 offset:0
    ds_read_b64 v[168:169], v31 offset:4096
    v_exp_f32 v58, v58
    v_exp_f32 v59, v59
    s_add_u32 m0, s49, 39936
    v_exp_f32 v60, v60
    buffer_load_dwordx4 v24, s[28:31], s52 offen sc1 lds
    v_exp_f32 v61, v61
    v_smfmac_f32_32x32x32_bf16 v[112:127], v[172:175], v[48:55], v1
    v_exp_f32 v62, v62
    s_add_u32 m0, s50, 39936
    v_exp_f32 v63, v63
    buffer_load_dword v25, s[28:31], s52 offen sc1 lds
    s_add_u32 s52, s52, 2048
    v_exp_f32 v64, v64
    v_exp_f32 v65, v65
    v_smfmac_f32_32x32x32_bf16 v[112:127], v[176:179], v[56:63], v1
    s_waitcnt lgkmcnt(0)
    v_exp_f32 v66, v66
    s_add_u32 m0, s51, 39936
    s_mov_b64 exec, s[62:63]
    buffer_load_dwordx4 v26, s[32:35], s53 offen sc1 lds
    s_mov_b64 exec, -1
    v_exp_f32 v67, v67
    v_exp_f32 v68, v68
    v_exp_f32 v69, v69
    v_mfma_f32_32x32x16_bf16 v[32:47], v[160:163], v[8:11], v[128:143]
    ds_read_b128 v[172:175], v247 offset:5120
    ds_read_b128 v[176:179], v247 offset:6144
    v_exp_f32 v70, v70
    s_mov_b64 exec, s[62:63]
    buffer_load_dwordx4 v27, s[32:35], s53 offen offset:1024 sc1 lds
    s_mov_b64 exec, -1
    s_add_u32 s53, s53, 20480
    v_exp_f32 v71, v71
    v_exp_f32 v72, v72
    v_exp_f32 v73, v73
    v_mfma_f32_32x32x8_bf16 v[32:47], v[168:169], v[16:17], v[32:47]
    v_exp_f32 v74, v74
    v_exp_f32 v75, v75
    v_exp_f32 v76, v76
    v_exp_f32 v77, v77
    v_smfmac_f32_32x32x32_bf16 v[96:111], v[180:183], v[64:71], v1
    v_exp_f32 v78, v78
    v_exp_f32 v79, v79
    s_mov_b32 exec_lo, 0xff
    s_mov_b32 exec_hi, 0x0
    s_mov_b32 s94, s74
    buffer_load_dword v239, v237, s[92:95], 0 offen sc1
    s_mov_b64 exec, -1
    v_exp_f32 v80, v80
    v_exp_f32 v81, v81
    v_smfmac_f32_32x32x32_bf16 v[96:111], v[184:187], v[72:79], v1
    v_exp_f32 v82, v82
    v_exp_f32 v83, v83
    v_exp_f32 v84, v84
    v_exp_f32 v85, v85
    v_mfma_f32_32x32x16_bf16 v[48:63], v[160:163], v[12:15], v[144:159]
    v_exp_f32 v86, v86
    v_exp_f32 v87, v87
    v_exp_f32 v88, v88
    v_exp_f32 v89, v89
    v_mfma_f32_32x32x8_bf16 v[48:63], v[168:169], v[20:21], v[48:63]
    ds_read_b128 v[164:167], v30 offset:1024
    v_exp_f32 v90, v90
    v_exp_f32 v91, v91
    v_exp_f32 v92, v92
    v_exp_f32 v93, v93
    v_smfmac_f32_32x32x32_bf16 v[112:127], v[180:183], v[80:87], v1
    v_exp_f32 v94, v94
    v_exp_f32 v95, v95
    v_exp_f32 v32, v32
    v_exp_f32 v33, v33
    v_smfmac_f32_32x32x32_bf16 v[112:127], v[184:187], v[88:95], v1
    s_waitcnt lgkmcnt(0)
    v_exp_f32 v34, v34
    v_mov_b32 v233, 1
    s_mov_b32 s94, s89
    s_mov_b64 exec, 1
    buffer_store_dword v233, off, s[92:95], s66 sc1
    s_mov_b64 exec, -1
    v_exp_f32 v35, v35
    v_exp_f32 v36, v36
    v_exp_f32 v37, v37
    v_mfma_f32_32x32x16_bf16 v[64:79], v[164:167], v[8:11], v[128:143]
    ds_read_b128 v[180:183], v247 offset:7168
    ds_read_b128 v[184:187], v247 offset:8192
    v_exp_f32 v38, v38
    v_exp_f32 v39, v39
    v_exp_f32 v40, v40
    v_exp_f32 v41, v41
    v_mfma_f32_32x32x8_bf16 v[64:79], v[168:169], v[18:19], v[64:79]
    v_exp_f32 v42, v42
    v_exp_f32 v43, v43
    v_exp_f32 v44, v44
    v_exp_f32 v45, v45
    v_smfmac_f32_32x32x32_bf16 v[96:111], v[172:175], v[32:39], v1
    v_exp_f32 v46, v46
    v_exp_f32 v47, v47
    s_mov_b32 exec_lo, 0xff00
    s_mov_b32 exec_hi, 0x0
    s_mov_b32 s94, s74
    buffer_load_dword v239, v237, s[92:95], 0 offen sc1
    s_mov_b64 exec, -1
    v_exp_f32 v48, v48
    v_exp_f32 v49, v49
    v_smfmac_f32_32x32x32_bf16 v[96:111], v[176:179], v[40:47], v1
    v_exp_f32 v50, v50
    v_exp_f32 v51, v51
    v_exp_f32 v52, v52
    v_exp_f32 v53, v53
    v_mfma_f32_32x32x16_bf16 v[80:95], v[164:167], v[12:15], v[144:159]
    v_exp_f32 v54, v54
    v_exp_f32 v55, v55
    v_exp_f32 v56, v56
    v_exp_f32 v57, v57
    v_mfma_f32_32x32x8_bf16 v[80:95], v[168:169], v[22:23], v[80:95]
    ds_read_b128 v[160:163], v30 offset:2048
    ds_read_b64 v[170:171], v31 offset:4608
    v_exp_f32 v58, v58
    v_exp_f32 v59, v59
    v_exp_f32 v60, v60
    v_exp_f32 v61, v61
    v_smfmac_f32_32x32x32_bf16 v[112:127], v[172:175], v[48:55], v1
    v_exp_f32 v62, v62
    v_exp_f32 v63, v63
    v_exp_f32 v64, v64
    v_exp_f32 v65, v65
    v_smfmac_f32_32x32x32_bf16 v[112:127], v[176:179], v[56:63], v1
    s_waitcnt lgkmcnt(0)
    v_exp_f32 v66, v66
    v_exp_f32 v67, v67
    v_exp_f32 v68, v68
    v_exp_f32 v69, v69
    v_mfma_f32_32x32x16_bf16 v[32:47], v[160:163], v[8:11], v[128:143]
    ds_read_b128 v[172:175], v247 offset:9216
    ds_read_b128 v[176:179], v247 offset:10240
    v_exp_f32 v70, v70
    v_exp_f32 v71, v71
    v_exp_f32 v72, v72
    v_exp_f32 v73, v73
    v_mfma_f32_32x32x8_bf16 v[32:47], v[170:171], v[16:17], v[32:47]
    v_exp_f32 v74, v74
    v_exp_f32 v75, v75
    v_exp_f32 v76, v76
    v_exp_f32 v77, v77
    v_smfmac_f32_32x32x32_bf16 v[96:111], v[180:183], v[64:71], v1
    v_exp_f32 v78, v78
    v_exp_f32 v79, v79
    s_mov_b32 exec_lo, 0xff0000
    s_mov_b32 exec_hi, 0x0
    s_mov_b32 s94, s74
    buffer_load_dword v239, v237, s[92:95], 0 offen sc1
    s_mov_b64 exec, -1
    v_exp_f32 v80, v80
    v_exp_f32 v81, v81
    v_smfmac_f32_32x32x32_bf16 v[96:111], v[184:187], v[72:79], v1
    v_exp_f32 v82, v82
    v_exp_f32 v83, v83
    v_exp_f32 v84, v84
    v_exp_f32 v85, v85
    v_mfma_f32_32x32x16_bf16 v[48:63], v[160:163], v[12:15], v[144:159]
    v_exp_f32 v86, v86
    v_exp_f32 v87, v87
    v_exp_f32 v88, v88
    v_exp_f32 v89, v89
    v_mfma_f32_32x32x8_bf16 v[48:63], v[170:171], v[20:21], v[48:63]
    ds_read_b128 v[164:167], v30 offset:3072
    v_exp_f32 v90, v90
    v_exp_f32 v91, v91
    v_exp_f32 v92, v92
    v_exp_f32 v93, v93
    v_smfmac_f32_32x32x32_bf16 v[112:127], v[180:183], v[80:87], v1
    v_exp_f32 v94, v94
    v_exp_f32 v95, v95
    v_exp_f32 v32, v32
    v_exp_f32 v33, v33
    v_smfmac_f32_32x32x32_bf16 v[112:127], v[184:187], v[88:95], v1
    s_waitcnt lgkmcnt(0)
    v_exp_f32 v34, v34
    v_exp_f32 v35, v35
    v_exp_f32 v36, v36
    v_exp_f32 v37, v37
    v_mfma_f32_32x32x16_bf16 v[64:79], v[164:167], v[8:11], v[128:143]
    ds_read_b128 v[180:183], v247 offset:11264
    ds_read_b128 v[184:187], v247 offset:12288
    v_exp_f32 v38, v38
    v_exp_f32 v39, v39
    v_exp_f32 v40, v40
    v_exp_f32 v41, v41
    v_mfma_f32_32x32x8_bf16 v[64:79], v[170:171], v[18:19], v[64:79]
    v_exp_f32 v42, v42
    v_exp_f32 v43, v43
    v_exp_f32 v44, v44
    v_exp_f32 v45, v45
    v_smfmac_f32_32x32x32_bf16 v[96:111], v[172:175], v[32:39], v1
    v_exp_f32 v46, v46
    v_exp_f32 v47, v47
    s_mov_b32 exec_lo, 0xff000000
    s_mov_b32 exec_hi, 0x0
    s_mov_b32 s94, s74
    buffer_load_dword v239, v237, s[92:95], 0 offen sc1
    s_mov_b64 exec, -1
    v_exp_f32 v48, v48
    v_exp_f32 v49, v49
    v_smfmac_f32_32x32x32_bf16 v[96:111], v[176:179], v[40:47], v1
    v_exp_f32 v50, v50
    v_exp_f32 v51, v51
    v_exp_f32 v52, v52
    v_exp_f32 v53, v53
    v_mfma_f32_32x32x16_bf16 v[80:95], v[164:167], v[12:15], v[144:159]
    v_exp_f32 v54, v54
    v_exp_f32 v55, v55
    v_exp_f32 v56, v56
    v_exp_f32 v57, v57
    v_mfma_f32_32x32x8_bf16 v[80:95], v[170:171], v[22:23], v[80:95]
    s_waitcnt vmcnt(5) lgkmcnt(0)
    s_barrier
    ds_read_b128 v[160:163], v30 offset:39936
    ds_read_b64 v[168:169], v31 offset:44032
    v_exp_f32 v58, v58
    v_exp_f32 v59, v59
    s_add_u32 m0, s49, 0
    v_exp_f32 v60, v60
    buffer_load_dwordx4 v24, s[28:31], s52 offen sc1 lds
    v_exp_f32 v61, v61
    v_smfmac_f32_32x32x32_bf16 v[112:127], v[172:175], v[48:55], v1
    v_exp_f32 v62, v62
    s_add_u32 m0, s50, 0
    v_exp_f32 v63, v63
    buffer_load_dword v25, s[28:31], s52 offen sc1 lds
    s_add_u32 s52, s52, 2048
    v_exp_f32 v64, v64
    v_exp_f32 v65, v65
    v_smfmac_f32_32x32x32_bf16 v[112:127], v[176:179], v[56:63], v1
    s_waitcnt lgkmcnt(0)
    v_exp_f32 v66, v66
    s_add_u32 m0, s51, 0
    s_mov_b64 exec, s[62:63]
    buffer_load_dwordx4 v26, s[32:35], s53 offen sc1 lds
    s_mov_b64 exec, -1
    v_exp_f32 v67, v67
    v_exp_f32 v68, v68
    v_exp_f32 v69, v69
    v_mfma_f32_32x32x16_bf16 v[32:47], v[160:163], v[8:11], v[128:143]
    ds_read_b128 v[172:175], v247 offset:45056
    ds_read_b128 v[176:179], v247 offset:46080
    v_exp_f32 v70, v70
    s_mov_b64 exec, s[62:63]
    buffer_load_dwordx4 v27, s[32:35], s53 offen offset:1024 sc1 lds
    s_mov_b64 exec, -1
    s_add_u32 s53, s53, 20480
    v_exp_f32 v71, v71
    v_exp_f32 v72, v72
    v_exp_f32 v73, v73
    v_mfma_f32_32x32x8_bf16 v[32:47], v[168:169], v[16:17], v[32:47]
    v_exp_f32 v74, v74
    v_exp_f32 v75, v75
    v_exp_f32 v76, v76
    v_exp_f32 v77, v77
    v_smfmac_f32_32x32x32_bf16 v[96:111], v[180:183], v[64:71], v1
    v_exp_f32 v78, v78
    v_exp_f32 v79, v79
    s_mov_b32 exec_lo, 0x0
    s_mov_b32 exec_hi, 0xff
    s_mov_b32 s94, s74
    buffer_load_dword v239, v237, s[92:95], 0 offen sc1
    s_mov_b64 exec, -1
    v_exp_f32 v80, v80
    v_exp_f32 v81, v81
    v_smfmac_f32_32x32x32_bf16 v[96:111], v[184:187], v[72:79], v1
    v_exp_f32 v82, v82
    v_exp_f32 v83, v83
    v_exp_f32 v84, v84
    v_exp_f32 v85, v85
    v_mfma_f32_32x32x16_bf16 v[48:63], v[160:163], v[12:15], v[144:159]
    v_exp_f32 v86, v86
    v_exp_f32 v87, v87
    v_exp_f32 v88, v88
    v_exp_f32 v89, v89
    v_mfma_f32_32x32x8_bf16 v[48:63], v[168:169], v[20:21], v[48:63]
    ds_read_b128 v[164:167], v30 offset:40960
    v_exp_f32 v90, v90
    v_exp_f32 v91, v91
    v_exp_f32 v92, v92
    v_exp_f32 v93, v93
    v_smfmac_f32_32x32x32_bf16 v[112:127], v[180:183], v[80:87], v1
    v_exp_f32 v94, v94
    v_exp_f32 v95, v95
    v_exp_f32 v32, v32
    v_exp_f32 v33, v33
    v_smfmac_f32_32x32x32_bf16 v[112:127], v[184:187], v[88:95], v1
    s_waitcnt lgkmcnt(0)
    v_exp_f32 v34, v34
    v_exp_f32 v35, v35
    v_exp_f32 v36, v36
    v_exp_f32 v37, v37
    v_mfma_f32_32x32x16_bf16 v[64:79], v[164:167], v[8:11], v[128:143]
    ds_read_b128 v[180:183], v247 offset:47104
    ds_read_b128 v[184:187], v247 offset:48128
    v_exp_f32 v38, v38
    v_exp_f32 v39, v39
    v_exp_f32 v40, v40
    v_exp_f32 v41, v41
    v_mfma_f32_32x32x8_bf16 v[64:79], v[168:169], v[18:19], v[64:79]
    v_exp_f32 v42, v42
    v_exp_f32 v43, v43
    v_exp_f32 v44, v44
    v_exp_f32 v45, v45
    v_smfmac_f32_32x32x32_bf16 v[96:111], v[172:175], v[32:39], v1
    v_exp_f32 v46, v46
    v_exp_f32 v47, v47
    s_mov_b32 exec_lo, 0x0
    s_mov_b32 exec_hi, 0xff00
    s_mov_b32 s94, s74
    buffer_load_dword v239, v237, s[92:95], 0 offen sc1
    s_mov_b64 exec, -1
    v_exp_f32 v48, v48
    v_exp_f32 v49, v49
    v_smfmac_f32_32x32x32_bf16 v[96:111], v[176:179], v[40:47], v1
    v_exp_f32 v50, v50
    v_exp_f32 v51, v51
    v_exp_f32 v52, v52
    v_exp_f32 v53, v53
    v_mfma_f32_32x32x16_bf16 v[80:95], v[164:167], v[12:15], v[144:159]
    v_exp_f32 v54, v54
    v_exp_f32 v55, v55
    v_exp_f32 v56, v56
    v_exp_f32 v57, v57
    v_mfma_f32_32x32x8_bf16 v[80:95], v[168:169], v[22:23], v[80:95]
    ds_read_b128 v[160:163], v30 offset:41984
    ds_read_b64 v[170:171], v31 offset:44544
    v_exp_f32 v58, v58
    v_exp_f32 v59, v59
    v_exp_f32 v60, v60
    v_exp_f32 v61, v61
    v_smfmac_f32_32x32x32_bf16 v[112:127], v[172:175], v[48:55], v1
    v_exp_f32 v62, v62
    v_exp_f32 v63, v63
    v_exp_f32 v64, v64
    v_exp_f32 v65, v65
    v_smfmac_f32_32x32x32_bf16 v[112:127], v[176:179], v[56:63], v1
    s_waitcnt lgkmcnt(0)
    v_exp_f32 v66, v66
    v_exp_f32 v67, v67
    v_exp_f32 v68, v68
    v_exp_f32 v69, v69
    v_mfma_f32_32x32x16_bf16 v[32:47], v[160:163], v[8:11], v[128:143]
    ds_read_b128 v[172:175], v247 offset:49152
    ds_read_b128 v[176:179], v247 offset:50176
    v_exp_f32 v70, v70
    v_exp_f32 v71, v71
    v_exp_f32 v72, v72
    v_exp_f32 v73, v73
    v_mfma_f32_32x32x8_bf16 v[32:47], v[170:171], v[16:17], v[32:47]
    v_exp_f32 v74, v74
    v_exp_f32 v75, v75
    v_exp_f32 v76, v76
    v_exp_f32 v77, v77
    v_smfmac_f32_32x32x32_bf16 v[96:111], v[180:183], v[64:71], v1
    v_exp_f32 v78, v78
    v_exp_f32 v79, v79
    s_mov_b32 exec_lo, 0x0
    s_mov_b32 exec_hi, 0xff0000
    s_mov_b32 s94, s74
    buffer_load_dword v239, v237, s[92:95], 0 offen sc1
    s_mov_b64 exec, -1
    v_exp_f32 v80, v80
    v_exp_f32 v81, v81
    v_smfmac_f32_32x32x32_bf16 v[96:111], v[184:187], v[72:79], v1
    v_exp_f32 v82, v82
    v_exp_f32 v83, v83
    v_exp_f32 v84, v84
    v_exp_f32 v85, v85
    v_mfma_f32_32x32x16_bf16 v[48:63], v[160:163], v[12:15], v[144:159]
    v_exp_f32 v86, v86
    v_exp_f32 v87, v87
    v_exp_f32 v88, v88
    v_exp_f32 v89, v89
    v_mfma_f32_32x32x8_bf16 v[48:63], v[170:171], v[20:21], v[48:63]
    ds_read_b128 v[164:167], v30 offset:43008
    v_exp_f32 v90, v90
    v_exp_f32 v91, v91
    v_exp_f32 v92, v92
    v_exp_f32 v93, v93
    v_smfmac_f32_32x32x32_bf16 v[112:127], v[180:183], v[80:87], v1
    v_exp_f32 v94, v94
    v_exp_f32 v95, v95
    v_exp_f32 v32, v32
    v_exp_f32 v33, v33
    v_smfmac_f32_32x32x32_bf16 v[112:127], v[184:187], v[88:95], v1
    s_waitcnt lgkmcnt(0)
    v_exp_f32 v34, v34
    v_exp_f32 v35, v35
    v_exp_f32 v36, v36
    v_exp_f32 v37, v37
    v_mfma_f32_32x32x16_bf16 v[64:79], v[164:167], v[8:11], v[128:143]
    ds_read_b128 v[180:183], v247 offset:51200
    ds_read_b128 v[184:187], v247 offset:52224
    v_exp_f32 v38, v38
    v_exp_f32 v39, v39
    v_exp_f32 v40, v40
    v_exp_f32 v41, v41
    v_mfma_f32_32x32x8_bf16 v[64:79], v[170:171], v[18:19], v[64:79]
    v_exp_f32 v42, v42
    v_exp_f32 v43, v43
    v_exp_f32 v44, v44
    v_exp_f32 v45, v45
    v_smfmac_f32_32x32x32_bf16 v[96:111], v[172:175], v[32:39], v1
    v_exp_f32 v46, v46
    v_exp_f32 v47, v47
    s_mov_b32 exec_lo, 0x0
    s_mov_b32 exec_hi, 0xff000000
    s_mov_b32 s94, s74
    buffer_load_dword v239, v237, s[92:95], 0 offen sc1
    s_mov_b64 exec, -1
    v_exp_f32 v48, v48
    v_exp_f32 v49, v49
    v_smfmac_f32_32x32x32_bf16 v[96:111], v[176:179], v[40:47], v1
    v_exp_f32 v50, v50
    v_exp_f32 v51, v51
    v_exp_f32 v52, v52
    v_exp_f32 v53, v53
    v_mfma_f32_32x32x16_bf16 v[80:95], v[164:167], v[12:15], v[144:159]
    v_exp_f32 v54, v54
    v_exp_f32 v55, v55
    v_exp_f32 v56, v56
    v_exp_f32 v57, v57
    v_mfma_f32_32x32x8_bf16 v[80:95], v[170:171], v[22:23], v[80:95]
    s_waitcnt vmcnt(4) lgkmcnt(0)
    s_barrier
    ds_read_b128 v[160:163], v30 offset:0
    ds_read_b64 v[168:169], v31 offset:4096
    v_exp_f32 v58, v58
    v_exp_f32 v59, v59
    s_add_u32 m0, s49, 39936
    v_exp_f32 v60, v60
    buffer_load_dwordx4 v24, s[28:31], s52 offen sc1 lds
    v_exp_f32 v61, v61
    v_smfmac_f32_32x32x32_bf16 v[112:127], v[172:175], v[48:55], v1
    v_exp_f32 v62, v62
    s_add_u32 m0, s50, 39936
    v_exp_f32 v63, v63
    buffer_load_dword v25, s[28:31], s52 offen sc1 lds
    s_add_u32 s52, s52, 2048
    v_exp_f32 v64, v64
    v_exp_f32 v65, v65
    v_smfmac_f32_32x32x32_bf16 v[112:127], v[176:179], v[56:63], v1
    s_waitcnt lgkmcnt(0)
    v_exp_f32 v66, v66
    s_add_u32 m0, s51, 39936
    s_mov_b64 exec, s[62:63]
    buffer_load_dwordx4 v26, s[32:35], s53 offen sc1 lds
    s_mov_b64 exec, -1
    v_exp_f32 v67, v67
    v_exp_f32 v68, v68
    v_exp_f32 v69, v69
    v_mfma_f32_32x32x16_bf16 v[32:47], v[160:163], v[8:11], v[128:143]
    ds_read_b128 v[172:175], v247 offset:5120
    ds_read_b128 v[176:179], v247 offset:6144
    v_exp_f32 v70, v70
    s_mov_b64 exec, s[62:63]
    buffer_load_dwordx4 v27, s[32:35], s53 offen offset:1024 sc1 lds
    s_mov_b64 exec, -1
    s_add_u32 s53, s53, 20480
    v_exp_f32 v71, v71
    v_exp_f32 v72, v72
    v_exp_f32 v73, v73
    v_mfma_f32_32x32x8_bf16 v[32:47], v[168:169], v[16:17], v[32:47]
    v_exp_f32 v74, v74
    v_exp_f32 v75, v75
    v_exp_f32 v76, v76
    v_exp_f32 v77, v77
    v_smfmac_f32_32x32x32_bf16 v[96:111], v[180:183], v[64:71], v1
    v_exp_f32 v78, v78
    v_exp_f32 v79, v79
    v_exp_f32 v80, v80
    v_exp_f32 v81, v81
    v_smfmac_f32_32x32x32_bf16 v[96:111], v[184:187], v[72:79], v1
    v_exp_f32 v82, v82
    v_exp_f32 v83, v83
    v_exp_f32 v84, v84
    v_exp_f32 v85, v85
    v_mfma_f32_32x32x16_bf16 v[48:63], v[160:163], v[12:15], v[144:159]
    v_exp_f32 v86, v86
    v_exp_f32 v87, v87
    v_exp_f32 v88, v88
    v_exp_f32 v89, v89
    v_mfma_f32_32x32x8_bf16 v[48:63], v[168:169], v[20:21], v[48:63]
    ds_read_b128 v[164:167], v30 offset:1024
    v_exp_f32 v90, v90
    v_exp_f32 v91, v91
    v_exp_f32 v92, v92
    v_exp_f32 v93, v93
    v_smfmac_f32_32x32x32_bf16 v[112:127], v[180:183], v[80:87], v1
    v_exp_f32 v94, v94
    v_exp_f32 v95, v95
    v_exp_f32 v32, v32
    v_exp_f32 v33, v33
    v_smfmac_f32_32x32x32_bf16 v[112:127], v[184:187], v[88:95], v1
    s_waitcnt lgkmcnt(0)
    v_exp_f32 v34, v34
    s_mov_b32 s46, s75
    buffer_load_dwordx4 v[188:191], v234, s[44:47], s68 offen sc1
    v_exp_f32 v35, v35
    v_exp_f32 v36, v36
    v_exp_f32 v37, v37
    v_mfma_f32_32x32x16_bf16 v[64:79], v[164:167], v[8:11], v[128:143]
    ds_read_b128 v[180:183], v247 offset:7168
    ds_read_b128 v[184:187], v247 offset:8192
    v_exp_f32 v38, v38
    v_exp_f32 v39, v39
    v_exp_f32 v40, v40
    buffer_load_dword v232, v235, s[44:47], s67 offen sc1
    s_mov_b32 s46, 131072
    v_exp_f32 v41, v41
    v_mfma_f32_32x32x8_bf16 v[64:79], v[168:169], v[18:19], v[64:79]
    v_exp_f32 v42, v42
    v_exp_f32 v43, v43
    v_exp_f32 v44, v44
    v_exp_f32 v45, v45
    v_smfmac_f32_32x32x32_bf16 v[96:111], v[172:175], v[32:39], v1
    v_exp_f32 v46, v46
    v_exp_f32 v47, v47
    v_exp_f32 v48, v48
    v_exp_f32 v49, v49
    v_smfmac_f32_32x32x32_bf16 v[96:111], v[176:179], v[40:47], v1
    v_exp_f32 v50, v50
    v_exp_f32 v51, v51
    v_exp_f32 v52, v52
    v_exp_f32 v53, v53
    v_mfma_f32_32x32x16_bf16 v[80:95], v[164:167], v[12:15], v[144:159]
    v_exp_f32 v54, v54
    v_exp_f32 v55, v55
    v_exp_f32 v56, v56
    v_exp_f32 v57, v57
    v_mfma_f32_32x32x8_bf16 v[80:95], v[168:169], v[22:23], v[80:95]
    ds_read_b128 v[160:163], v30 offset:2048
    ds_read_b64 v[170:171], v31 offset:4608
    v_exp_f32 v58, v58
    v_exp_f32 v59, v59
    v_exp_f32 v60, v60
    v_exp_f32 v61, v61
    v_smfmac_f32_32x32x32_bf16 v[112:127], v[172:175], v[48:55], v1
    v_exp_f32 v62, v62
    v_exp_f32 v63, v63
    v_exp_f32 v64, v64
    v_exp_f32 v65, v65
    v_smfmac_f32_32x32x32_bf16 v[112:127], v[176:179], v[56:63], v1
    s_waitcnt lgkmcnt(0)
    v_exp_f32 v66, v66
    v_exp_f32 v67, v67
    v_exp_f32 v68, v68
    v_exp_f32 v69, v69
    v_mfma_f32_32x32x16_bf16 v[32:47], v[160:163], v[8:11], v[128:143]
    ds_read_b128 v[172:175], v247 offset:9216
    ds_read_b128 v[176:179], v247 offset:10240
    v_exp_f32 v70, v70
    v_exp_f32 v71, v71
    v_exp_f32 v72, v72
    v_exp_f32 v73, v73
    v_mfma_f32_32x32x8_bf16 v[32:47], v[170:171], v[16:17], v[32:47]
    v_exp_f32 v74, v74
    v_exp_f32 v75, v75
    v_exp_f32 v76, v76
    v_exp_f32 v77, v77
    v_smfmac_f32_32x32x32_bf16 v[96:111], v[180:183], v[64:71], v1
    v_exp_f32 v78, v78
    v_exp_f32 v79, v79
    v_exp_f32 v80, v80
    v_exp_f32 v81, v81
    v_smfmac_f32_32x32x32_bf16 v[96:111], v[184:187], v[72:79], v1
    v_exp_f32 v82, v82
    v_exp_f32 v83, v83
    v_exp_f32 v84, v84
    v_exp_f32 v85, v85
    v_mfma_f32_32x32x16_bf16 v[48:63], v[160:163], v[12:15], v[144:159]
    v_exp_f32 v86, v86
    v_exp_f32 v87, v87
    v_exp_f32 v88, v88
    v_exp_f32 v89, v89
    v_mfma_f32_32x32x8_bf16 v[48:63], v[170:171], v[20:21], v[48:63]
    ds_read_b128 v[164:167], v30 offset:3072
    v_exp_f32 v90, v90
    v_exp_f32 v91, v91
    v_exp_f32 v92, v92
    v_exp_f32 v93, v93
    v_smfmac_f32_32x32x32_bf16 v[112:127], v[180:183], v[80:87], v1
    v_exp_f32 v94, v94
    v_exp_f32 v95, v95
    v_exp_f32 v32, v32
    v_exp_f32 v33, v33
    v_smfmac_f32_32x32x32_bf16 v[112:127], v[184:187], v[88:95], v1
    s_waitcnt lgkmcnt(0)
    v_exp_f32 v34, v34
    v_exp_f32 v35, v35
    v_exp_f32 v36, v36
    v_exp_f32 v37, v37
    v_mfma_f32_32x32x16_bf16 v[64:79], v[164:167], v[8:11], v[128:143]
    ds_read_b128 v[180:183], v247 offset:11264
    ds_read_b128 v[184:187], v247 offset:12288
    v_exp_f32 v38, v38
    v_exp_f32 v39, v39
    v_exp_f32 v40, v40
    v_exp_f32 v41, v41
    v_mfma_f32_32x32x8_bf16 v[64:79], v[170:171], v[18:19], v[64:79]
    v_exp_f32 v42, v42
    v_exp_f32 v43, v43
    v_exp_f32 v44, v44
    v_exp_f32 v45, v45
    v_smfmac_f32_32x32x32_bf16 v[96:111], v[172:175], v[32:39], v1
    v_exp_f32 v46, v46
    v_exp_f32 v47, v47
    v_exp_f32 v48, v48
    v_exp_f32 v49, v49
    v_smfmac_f32_32x32x32_bf16 v[96:111], v[176:179], v[40:47], v1
    v_exp_f32 v50, v50
    v_exp_f32 v51, v51
    v_exp_f32 v52, v52
    v_exp_f32 v53, v53
    v_mfma_f32_32x32x16_bf16 v[80:95], v[164:167], v[12:15], v[144:159]
    v_exp_f32 v54, v54
    v_exp_f32 v55, v55
    v_exp_f32 v56, v56
    v_exp_f32 v57, v57
    v_mfma_f32_32x32x8_bf16 v[80:95], v[170:171], v[22:23], v[80:95]
    s_waitcnt vmcnt(0) lgkmcnt(0)
    s_cmp_lg_u32 s22, 0
    s_cbranch_scc1 L2_nchk
    v_min_u32 v188, v188, v189
    v_min3_u32 v188, v188, v190, v191
    v_min_u32 v233, v188, v232
    v_cmp_eq_u32 vcc, 0, v233
    s_cbranch_vccnz L2_late
L2_late_ret:
    v_cmp_ne_u32 vcc, s69, v232
    s_cmp_eq_u32 vcc_lo, 0
    s_cselect_b32 s25, 1, 0
    v_mov_b32 v188, s25
    v_mov_b32 v189, 162820
    ds_write_b32 v189, v188
    s_waitcnt lgkmcnt(0)
L2_nchk:
    s_barrier
    ds_read_b128 v[160:163], v30 offset:39936
    ds_read_b64 v[168:169], v31 offset:44032
    v_exp_f32 v58, v58
    v_exp_f32 v59, v59
    v_exp_f32 v60, v60
    v_exp_f32 v61, v61
    v_smfmac_f32_32x32x32_bf16 v[112:127], v[172:175], v[48:55], v1
    v_exp_f32 v62, v62
    v_exp_f32 v63, v63
    v_exp_f32 v64, v64
    v_exp_f32 v65, v65
    v_smfmac_f32_32x32x32_bf16 v[112:127], v[176:179], v[56:63], v1
    s_waitcnt lgkmcnt(0)
    v_exp_f32 v66, v66
    s_add_u32 m0, s65, 0
    s_mov_b32 s61, 0
    buffer_load_dwordx4 v234, s[40:43], s61 offen offset:0 sc1 lds
    v_exp_f32 v67, v67
    v_exp_f32 v68, v68
    v_exp_f32 v69, v69
    v_mfma_f32_32x32x16_bf16 v[32:47], v[160:163], v[8:11], v[128:143]
    ds_read_b128 v[172:175], v247 offset:45056
    ds_read_b128 v[176:179], v247 offset:46080
    v_exp_f32 v70, v70
    v_exp_f32 v71, v71
    buffer_load_dwordx4 v234, s[40:43], s61 offen offset:1024 sc1 lds
    v_exp_f32 v72, v72
    v_exp_f32 v73, v73
    v_mfma_f32_32x32x8_bf16 v[32:47], v[168:169], v[16:17], v[32:47]
    v_exp_f32 v74, v74
    v_exp_f32 v75, v75
    v_exp_f32 v76, v76
    buffer_load_dwordx4 v234, s[40:43], s61 offen offset:2048 sc1 lds
    v_exp_f32 v77, v77
    v_smfmac_f32_32x32x32_bf16 v[96:111], v[180:183], v[64:71], v1
    v_exp_f32 v78, v78
    v_exp_f32 v79, v79
    v_exp_f32 v80, v80
    v_exp_f32 v81, v81
    v_smfmac_f32_32x32x32_bf16 v[96:111], v[184:187], v[72:79], v1
    v_exp_f32 v82, v82
    buffer_load_dwordx4 v234, s[40:43], s61 offen offset:3072 sc1 lds
    v_exp_f32 v83, v83
    v_exp_f32 v84, v84
    v_exp_f32 v85, v85
    v_mfma_f32_32x32x16_bf16 v[48:63], v[160:163], v[12:15], v[144:159]
    v_exp_f32 v86, v86
    v_exp_f32 v87, v87
    s_add_u32 m0, s65, 4096
    s_mov_b32 s61, 4096
    buffer_load_dwordx4 v234, s[40:43], s61 offen offset:0 sc1 lds
    v_exp_f32 v88, v88
    v_exp_f32 v89, v89
    v_mfma_f32_32x32x8_bf16 v[48:63], v[168:169], v[20:21], v[48:63]
    ds_read_b128 v[164:167], v30 offset:40960
    v_exp_f32 v90, v90
    v_exp_f32 v91, v91
    v_exp_f32 v92, v92
    buffer_load_dwordx4 v234, s[40:43], s61 offen offset:1024 sc1 lds
    v_exp_f32 v93, v93
    v_smfmac_f32_32x32x32_bf16 v[112:127], v[180:183], v[80:87], v1
    v_exp_f32 v94, v94
    v_exp_f32 v95, v95
    v_exp_f32 v32, v32
    v_exp_f32 v33, v33
    v_smfmac_f32_32x32x32_bf16 v[112:127], v[184:187], v[88:95], v1
    s_waitcnt lgkmcnt(0)
    v_exp_f32 v34, v34
    buffer_load_dwordx4 v234, s[40:43], s61 offen offset:2048 sc1 lds
    v_exp_f32 v35, v35
    v_exp_f32 v36, v36
    v_exp_f32 v37, v37
    v_mfma_f32_32x32x16_bf16 v[64:79], v[164:167], v[8:11], v[128:143]
    ds_read_b128 v[180:183], v247 offset:47104
    ds_read_b128 v[184:187], v247 offset:48128
    v_exp_f32 v38, v38
    v_exp_f32 v39, v39
    buffer_load_dwordx4 v234, s[40:43], s61 offen offset:3072 sc1 lds
    v_exp_f32 v40, v40
    v_exp_f32 v41, v41
    v_mfma_f32_32x32x8_bf16 v[64:79], v[168:169], v[18:19], v[64:79]
    v_exp_f32 v42, v42
    v_exp_f32 v43, v43
    v_exp_f32 v44, v44
    s_add_u32 m0, s65, 8192
    s_mov_b32 s61, 8192
    buffer_load_dwordx4 v234, s[40:43], s61 offen offset:0 sc1 lds
    v_exp_f32 v45, v45
    v_smfmac_f32_32x32x32_bf16 v[96:111], v[172:175], v[32:39], v1
    v_exp_f32 v46, v46
    v_exp_f32 v47, v47
    v_exp_f32 v48, v48
    v_exp_f32 v49, v49
    v_smfmac_f32_32x32x32_bf16 v[96:111], v[176:179], v[40:47], v1
    v_exp_f32 v50, v50
    buffer_load_dwordx4 v234, s[40:43], s61 offen offset:1024 sc1 lds
    v_exp_f32 v51, v51
    v_exp_f32 v52, v52
    v_exp_f32 v53, v53
    v_mfma_f32_32x32x16_bf16 v[80:95], v[164:167], v[12:15], v[144:159]
    v_exp_f32 v54, v54
    v_exp_f32 v55, v55
    buffer_load_dwordx4 v234, s[40:43], s61 offen offset:2048 sc1 lds
    v_exp_f32 v56, v56
    v_exp_f32 v57, v57
    v_mfma_f32_32x32x8_bf16 v[80:95], v[168:169], v[22:23], v[80:95]
    ds_read_b128 v[160:163], v30 offset:41984
    ds_read_b64 v[170:171], v31 offset:44544
    v_exp_f32 v58, v58
    v_exp_f32 v59, v59
    v_exp_f32 v60, v60
    buffer_load_dwordx4 v234, s[40:43], s61 offen offset:3072 sc1 lds
    v_exp_f32 v61, v61
    v_smfmac_f32_32x32x32_bf16 v[112:127], v[172:175], v[48:55], v1
    v_exp_f32 v62, v62
    v_exp_f32 v63, v63
    v_exp_f32 v64, v64
    v_exp_f32 v65, v65
    v_smfmac_f32_32x32x32_bf16 v[112:127], v[176:179], v[56:63], v1
    s_waitcnt lgkmcnt(0)
    v_exp_f32 v66, v66
    s_add_u32 m0, s65, 12288
    s_mov_b32 s61, 12288
    buffer_load_dwordx4 v234, s[40:43], s61 offen offset:0 sc1 lds
    v_exp_f32 v67, v67
    v_exp_f32 v68, v68
    v_exp_f32 v69, v69
    v_mfma_f32_32x32x16_bf16 v[32:47], v[160:163], v[8:11], v[128:143]
    ds_read_b128 v[172:175], v247 offset:49152
    ds_read_b128 v[176:179], v247 offset:50176
    v_exp_f32 v70, v70
    v_exp_f32 v71, v71
    v_exp_f32 v72, v72
    v_exp_f32 v73, v73
    v_mfma_f32_32x32x8_bf16 v[32:47], v[170:171], v[16:17], v[32:47]
    v_exp_f32 v74, v74
    v_exp_f32 v75, v75
    v_exp_f32 v76, v76
    v_exp_f32 v77, v77
    v_smfmac_f32_32x32x32_bf16 v[96:111], v[180:183], v[64:71], v1
    v_exp_f32 v78, v78
    v_exp_f32 v79, v79
    v_exp_f32 v80, v80
    v_exp_f32 v81, v81
    v_smfmac_f32_32x32x32_bf16 v[96:111], v[184:187], v[72:79], v1
    v_exp_f32 v82, v82
    v_exp_f32 v83, v83
    v_exp_f32 v84, v84
    v_exp_f32 v85, v85
    v_mfma_f32_32x32x16_bf16 v[48:63], v[160:163], v[12:15], v[144:159]
    v_exp_f32 v86, v86
    v_exp_f32 v87, v87
    v_exp_f32 v88, v88
    v_exp_f32 v89, v89
    v_mfma_f32_32x32x8_bf16 v[48:63], v[170:171], v[20:21], v[48:63]
    ds_read_b128 v[164:167], v30 offset:43008
    v_exp_f32 v90, v90
    v_exp_f32 v91, v91
    v_exp_f32 v92, v92
    v_exp_f32 v93, v93
    v_smfmac_f32_32x32x32_bf16 v[112:127], v[180:183], v[80:87], v1
    v_exp_f32 v94, v94
    v_exp_f32 v95, v95
    v_exp_f32 v32, v32
    v_exp_f32 v33, v33
    v_smfmac_f32_32x32x32_bf16 v[112:127], v[184:187], v[88:95], v1
    s_waitcnt lgkmcnt(0)
    v_exp_f32 v34, v34
    v_exp_f32 v35, v35
    v_exp_f32 v36, v36
    v_exp_f32 v37, v37
    v_mfma_f32_32x32x16_bf16 v[64:79], v[164:167], v[8:11], v[128:143]
    ds_read_b128 v[180:183], v247 offset:51200
    ds_read_b128 v[184:187], v247 offset:52224
    v_exp_f32 v38, v38
    v_exp_f32 v39, v39
    v_exp_f32 v40, v40
    v_exp_f32 v41, v41
    v_mfma_f32_32x32x8_bf16 v[64:79], v[170:171], v[18:19], v[64:79]
    v_exp_f32 v42, v42
    v_exp_f32 v43, v43
    v_exp_f32 v44, v44
    v_exp_f32 v45, v45
    v_smfmac_f32_32x32x32_bf16 v[96:111], v[172:175], v[32:39], v1
    v_exp_f32 v46, v46
    v_exp_f32 v47, v47
    v_exp_f32 v48, v48
    v_exp_f32 v49, v49
    v_smfmac_f32_32x32x32_bf16 v[96:111], v[176:179], v[40:47], v1
    v_exp_f32 v50, v50
    v_exp_f32 v51, v51
    v_exp_f32 v52, v52
    v_exp_f32 v53, v53
    v_mfma_f32_32x32x16_bf16 v[80:95], v[164:167], v[12:15], v[144:159]
    v_exp_f32 v54, v54
    v_exp_f32 v55, v55
    v_exp_f32 v56, v56
    v_exp_f32 v57, v57
    v_mfma_f32_32x32x8_bf16 v[80:95], v[170:171], v[22:23], v[80:95]
    v_exp_f32 v58, v58
    v_exp_f32 v59, v59
    v_exp_f32 v60, v60
    v_exp_f32 v61, v61
    v_smfmac_f32_32x32x32_bf16 v[112:127], v[172:175], v[48:55], v1
    v_exp_f32 v62, v62
    v_exp_f32 v63, v63
    v_exp_f32 v64, v64
    v_exp_f32 v65, v65
    v_smfmac_f32_32x32x32_bf16 v[112:127], v[176:179], v[56:63], v1
    s_waitcnt lgkmcnt(0)
    v_exp_f32 v66, v66
    v_exp_f32 v67, v67
    v_exp_f32 v68, v68
    v_exp_f32 v69, v69
    v_exp_f32 v70, v70
    v_exp_f32 v71, v71
    v_exp_f32 v72, v72
    v_exp_f32 v73, v73
    v_exp_f32 v74, v74
    v_exp_f32 v75, v75
    v_exp_f32 v76, v76
    v_exp_f32 v77, v77
    v_smfmac_f32_32x32x32_bf16 v[96:111], v[180:183], v[64:71], v1
    v_exp_f32 v78, v78
    v_exp_f32 v79, v79
    v_exp_f32 v80, v80
    v_exp_f32 v81, v81
    v_smfmac_f32_32x32x32_bf16 v[96:111], v[184:187], v[72:79], v1
    v_exp_f32 v82, v82
    v_exp_f32 v83, v83
    v_exp_f32 v84, v84
    v_exp_f32 v85, v85
    v_exp_f32 v86, v86
    v_exp_f32 v87, v87
    v_exp_f32 v88, v88
    v_exp_f32 v89, v89
    v_exp_f32 v90, v90
    v_exp_f32 v91, v91
    v_exp_f32 v92, v92
    v_exp_f32 v93, v93
    v_smfmac_f32_32x32x32_bf16 v[112:127], v[180:183], v[80:87], v1
    v_exp_f32 v94, v94
    v_exp_f32 v95, v95
    s_mov_b32 s86, 0
    s_mov_b32 s87, 0
    s_mov_b32 s88, 0
    s_nop 1
    v_smfmac_f32_32x32x32_bf16 v[112:127], v[184:187], v[88:95], v1
    s_cmp_eq_u32 s91, 0
    s_cselect_b32 s94, 26083328, 0
    s_mov_b32 s55, 0x21800000
    s_mov_b32 s56, 0x6c800000
    v_mov_b32 v50, 162816
    s_nop 6
    ds_write_b128 v241, v[112:115] offset:0
    ds_write_b128 v241, v[116:119] offset:1024
    ds_write_b128 v241, v[120:123] offset:2048
    s_waitcnt lgkmcnt(0)
    s_barrier
    ds_read_b128 v[32:35], v242 offset:0
    ds_read_b128 v[36:39], v242 offset:1024
    ds_read_b128 v[40:43], v242 offset:2048
    s_waitcnt lgkmcnt(0)
    v_add_f32 v44, v104, v40
    v_add_f32 v45, v104, v40
    v_pk_add_f32 v[96:97], v[96:97], v[32:33]
    v_pk_add_f32 v[98:99], v[98:99], v[34:35]
    v_pk_add_f32 v[100:101], v[100:101], v[36:37]
    v_permlane32_swap_b32 v44, v45
    v_pk_add_f32 v[102:103], v[102:103], v[38:39]
    v_pk_add_f32 v[104:105], v[104:105], v[40:41]
    v_rcp_f32 v48, v45
    v_pk_add_f32 v[106:107], v[106:107], v[42:43]
    v_pk_mul_f32 v[96:97], v[96:97], v[48:49] op_sel_hi:[1,0]
    v_pk_mul_f32 v[98:99], v[98:99], v[48:49] op_sel_hi:[1,0]
    v_pk_mul_f32 v[100:101], v[100:101], v[48:49] op_sel_hi:[1,0]
    v_pk_mul_f32 v[102:103], v[102:103], v[48:49] op_sel_hi:[1,0]
    v_pk_mul_f32 v[104:105], v[104:105], v[48:49] op_sel_hi:[1,0]
    v_pk_mul_f32 v[106:107], v[106:107], v[48:49] op_sel_hi:[1,0]
    v_cvt_pk_bf16_f32 v32, v96, v97
    v_cvt_pk_bf16_f32 v33, v98, v99
    v_cvt_pk_bf16_f32 v34, v100, v101
    v_cvt_pk_bf16_f32 v35, v102, v103
    v_cvt_pk_bf16_f32 v36, v104, v105
    v_cvt_pk_bf16_f32 v37, v106, v107
    v_min_u32 v32, -2, v32
    v_min_u32 v33, -2, v33
    v_min_u32 v34, -2, v34
    v_min_u32 v35, -2, v35
    v_min_u32 v36, -2, v36
    v_min_u32 v37, -2, v37
    buffer_store_dwordx4 v[32:35], v243, s[92:95], s57 offen sc1
    s_mov_b32 exec_hi, 0
    buffer_store_dwordx2 v[36:37], v244, s[92:95], s58 offen sc1
    s_mov_b64 exec, -1
    v_mul_f32 v46, 0, v96
    v_mul_f32 v47, 0, v104
    v_cmp_gt_u32 vcc, 32, v2
    v_fmac_f32 v46, 0, v97
    v_fmac_f32 v46, 0, v98
    v_fmac_f32 v46, 0, v99
    v_fmac_f32 v46, 0, v100
    v_fmac_f32 v46, 0, v101
    v_fmac_f32 v46, 0, v102
    v_fmac_f32 v46, 0, v103
    v_fmac_f32 v47, 0, v105
    v_fmac_f32 v47, 0, v106
    v_fmac_f32 v47, 0, v107
    v_cndmask_b32 v47, 0, v47, vcc
    v_add_f32 v46, v46, v47
    v_add_f32 v46, v46, v45
    v_cmp_nle_f32 s[70:71], s55, v46
    v_cmp_nge_f32 s[72:73], s56, v46
    v_mov_b32 v51, 1
    s_or_b64 exec, s[70:71], s[72:73]
    s_cselect_b32 s46, 0, 131072
    ds_write_b32 v50, v51
    s_mov_b64 exec, 1
    s_cmp_lg_u32 s64, 0
    s_cbranch_scc1 L2_second
L2_first:
    buffer_store_dword v51, off, s[44:47], s54 sc1
    s_mov_b64 exec, -1
    s_mov_b32 s91, s46
    s_mov_b32 s46, 131072
    s_waitcnt lgkmcnt(0)
    s_barrier
    ds_read_b64 v[52:53], v50
    s_waitcnt lgkmcnt(0)
    v_readfirstlane_b32 s55, v52
    v_readfirstlane_b32 s25, v53
    s_cmp_gt_u32 s55, s64
    s_cbranch_scc1 L2_redo
    s_lshl_b32 s55, s20, 8
    s_lshl_b32 s56, s21, 2
    s_add_u32 s55, s55, s56
    s_add_u32 s55, s55, 12288
    s_mov_b32 s46, s75
    s_mov_b64 exec, 1
    buffer_store_dword v51, off, s[44:47], s55 sc1
    s_mov_b64 exec, -1
    s_mov_b32 s46, 131072
    s_cmp_ge_u32 s22, 4
    s_cbranch_scc1 L3_loader
    s_lshl_b32 s48, s20, 4
    s_lshr_b32 s55, s21, 3
    s_lshl_b32 s55, s55, 2
    s_add_u32 s48, s48, s55
    s_add_u32 s48, s48, s23
    s_and_b32 s49, s21, 7
    s_lshr_b32 s50, s48, 1
    s_lshl_b32 s50, s50, 8
    v_lshlrev_b32 v3, 4, v2
    v_and_b32 v4, 15, v2
    v_lshrrev_b32 v7, 4, v2
    v_mul_u32_u24 v6, 1280, v4
    v_lshl_add_u32 v6, v7, 3, v6
    s_mul_i32 s51, s48, 20480
    s_mul_i32 s55, s49, 160
    s_add_u32 s51, s51, s55
    s_mul_i32 s55, s48, 20480
    s_add_u32 s56, s55, 7864320
    s_add_u32 s57, s55, 0
    s_mov_b32 s61, 0xffff0000
    v_add_u32 v76, 0, v3
    v_add_u32 v77, 39936, v3
    v_add_u32 v78, 79872, v3
    v_add_u32 v79, 119808, v3
    s_lshl_b32 s62, s49, 11
    s_lshr_b32 s63, s49, 1
    s_lshl_b32 s63, s63, 10
    s_and_b32 s55, s49, 1
    s_lshl_b32 s55, s55, 3
    s_add_u32 s63, s63, s55
    s_add_u32 s63, s63, 16384
    s_mul_i32 s64, s48, 20480
    s_add_u32 s64, s64, s55
    s_lshr_b32 s55, s49, 1
    s_lshl_b32 s55, s55, 8
    s_add_u32 s64, s64, s55
    s_add_u32 s64, s64, 5257216
    s_lshl_b32 s55, s49, 3
    v_lshlrev_b32 v248, 4, v4
    v_mov_b32 v74, 0
    v_mov_b32 v75, 0
    v_mov_b32 v60, 0x3f803f80
    v_mov_b32 v61, v60
    v_mov_b32 v62, v60
    v_mov_b32 v63, v60
    s_mov_b32 s84, 0x22222222
    s_mov_b32 s85, s84
    s_mov_b32 s86, 0x44444444
    s_mov_b32 s87, s86
    s_mov_b32 s88, 0x88888888
    s_mov_b32 s89, s88
    s_and_b32 s65, s48, 1
    s_lshl_b32 s65, s65, 2
    s_add_u32 s65, s65, s55
    s_add_u32 s65, s65, s50
    s_add_u32 s65, s65, 16384
    s_lshl_b32 s58, s20, 3
    s_lshr_b32 s55, s21, 4
    s_lshl_b32 s55, s55, 2
    s_add_u32 s58, s58, s55
    s_add_u32 s58, s58, s23
    s_and_b32 s59, s21, 15
    s_mul_i32 s66, s58, 40960
    s_add_u32 s66, s66, 0
    s_lshl_b32 s60, s58, 8
    s_lshr_b32 s76, s59, 1
    s_lshl_b32 s76, s76, 10
    s_and_b32 s55, s59, 1
    s_lshl_b32 s55, s55, 3
    s_add_u32 s76, s76, s55
    s_add_u32 s76, s76, 5251072
    s_mul_i32 s54, s59, 3
    s_lshl_b32 s55, s54, 10
    s_add_u32 s67, s55, 2621440
    s_cmp_ge_u32 s54, 20
    s_cselect_b32 s55, 5222400, 0
    s_add_u32 s67, s67, s55
    s_cmp_ge_u32 s54, 40
    s_cselect_b32 s55, 4292325376, 0
    s_add_u32 s67, s67, s55
    s_add_u32 s54, s54, 1
    s_lshl_b32 s55, s54, 10
    s_add_u32 s68, s55, 2621440
    s_cmp_ge_u32 s54, 20
    s_cselect_b32 s55, 5222400, 0
    s_add_u32 s68, s68, s55
    s_cmp_ge_u32 s54, 40
    s_cselect_b32 s55, 4292325376, 0
    s_add_u32 s68, s68, s55
    s_add_u32 s54, s54, 1
    s_lshl_b32 s55, s54, 10
    s_add_u32 s69, s55, 2621440
    s_cmp_ge_u32 s54, 20
    s_cselect_b32 s55, 5222400, 0
    s_add_u32 s69, s69, s55
    s_cmp_ge_u32 s54, 40
    s_cselect_b32 s55, 4292325376, 0
    s_add_u32 s69, s69, s55
    s_add_u32 s54, s54, 1
    v_add_u32 v250, 20480, v3
    s_lshl_b32 s77, s20, 8
    s_add_u32 s77, s77, 12288
    s_lshl_b32 s78, s59, 2
    s_add_u32 s78, s78, s60
    s_add_u32 s78, s78, 32768
    s_mov_b32 s40, s10
    s_mov_b32 s41, s11
    s_mov_b32 s42, 10485760
    s_mov_b32 s43, 0x00020000
    s_add_u32 s80, s10, s66
    s_addc_u32 s81, s11, 0
    s_mov_b32 s82, 7905280
    s_mov_b32 s83, 0x00020000
    s_mov_b32 s32, s4
    s_mov_b32 s33, s5
    s_mov_b32 s34, 2621440
    s_mov_b32 s35, 0x00020000
    s_add_u32 s28, s10, s56
    s_addc_u32 s29, s11, 0
    s_mov_b32 s30, 20480
    s_mov_b32 s31, 0x00020000
    s_add_u32 s36, s10, s57
    s_addc_u32 s37, s11, 0
    s_mov_b32 s38, 20480
    s_mov_b32 s39, 0x00020000
    s_mul_i32 s55, s23, 39936
    s_add_u32 s55, s55, 36864
    s_mov_b32 m0, s55
    s_mov_b32 s57, 1120
    v_mul_u32_u24 v48, 160, v4
    v_lshl_add_u32 v48, v7, 3, v48
    v_add_u32 v48, s55, v48
    v_add_u32 v1, 0, v2
    v_mul_u32_u24 v1, 6554, v1
    v_lshrrev_b32 v1, 16, v1
    v_mad_u32_u24 v1, v1, s57, v3
    buffer_load_dwordx4 v1, s[32:35], s51 offen offset:0 lds
    v_add_u32 v1, 64, v2
    v_mul_u32_u24 v1, 6554, v1
    v_lshrrev_b32 v1, 16, v1
    v_mad_u32_u24 v1, v1, s57, v3
    buffer_load_dwordx4 v1, s[32:35], s51 offen offset:1024 lds
    v_add_u32 v1, 128, v2
    v_mul_u32_u24 v1, 6554, v1
    v_lshrrev_b32 v1, 16, v1
    v_mad_u32_u24 v1, v1, s57, v3
    s_mov_b32 exec_hi, 0
    buffer_load_dwordx4 v1, s[32:35], s51 offen offset:2048 lds
    s_mov_b64 exec, -1
    s_waitcnt vmcnt(7)
    s_barrier
    ds_read_b128 v[80:83], v76 offset:0
    ds_read_b128 v[84:87], v76 offset:1024
    ds_read_b128 v[88:91], v76 offset:2048
    ds_read_b128 v[92:95], v76 offset:3072
    ds_read_b128 v[96:99], v76 offset:4096
    ds_read_b128 v[100:103], v77 offset:0
    ds_read_b128 v[104:107], v77 offset:1024
    ds_read_b128 v[108:111], v77 offset:2048
    ds_read_b128 v[112:115], v77 offset:3072
    ds_read_b128 v[116:119], v77 offset:4096
    s_waitcnt vmcnt(0)
    ds_read_b64 v[64:65], v48 offset:0
    ds_read_b64 v[66:67], v48 offset:32
    ds_read_b64 v[68:69], v48 offset:64
    ds_read_b64 v[70:71], v48 offset:96
    ds_read_b64 v[72:73], v48 offset:128
    s_cmp_lg_u32 s22, 0
    s_cbranch_scc1 L3_nw
    s_lshl_b32 s55, s50, 2
    s_add_u32 s55, s55, 65536
    v_bfe_u32 v1, v2, 2, 3
    v_lshlrev_b32 v1, 7, v1
    v_and_b32 v5, 3, v2
    v_lshl_add_u32 v1, v5, 2, v1
    v_lshrrev_b32 v5, 5, v2
    v_lshl_add_u32 v1, v5, 10, v1
    s_mov_b64 s[70:71], -1
    s_mov_b32 s3, 400000
    s_branch Lp5_n
Lp5:
    s_sleep 14
Lp5_n:
    buffer_load_dword v5, v1, s[44:47], s55 offen sc1
Lp5_c:
    s_waitcnt vmcnt(0)
    v_cmp_eq_u32 vcc, 0, v5
    s_and_b64 s[72:73], vcc, s[70:71]
    s_sub_u32 s3, s3, 1
    s_cselect_b64 s[72:73], 0, s[72:73]
    s_cmp_lg_u64 s[72:73], 0
    s_cbranch_scc1 Lp5
L3_nw:
    s_waitcnt lgkmcnt(0)
    s_barrier
    s_mov_b32 s52, 0
    buffer_load_dwordx4 v[140:143], v3, s[28:31], s52 offen offset:0 sc1
    buffer_load_dwordx4 v[144:147], v3, s[28:31], s52 offen offset:1024 sc1
    buffer_load_dwordx4 v[148:151], v3, s[28:31], s52 offen offset:2048 sc1
    buffer_load_dwordx4 v[152:155], v3, s[28:31], s52 offen offset:3072 sc1
    s_mov_b32 s52, 4096
    buffer_load_dwordx4 v[156:159], v3, s[28:31], s52 offen offset:0 sc1
    buffer_load_dwordx4 v[160:163], v3, s[28:31], s52 offen offset:1024 sc1
    buffer_load_dwordx4 v[164:167], v3, s[28:31], s52 offen offset:2048 sc1
    buffer_load_dwordx4 v[168:171], v3, s[28:31], s52 offen offset:3072 sc1
    s_waitcnt vmcnt(4) lgkmcnt(5)
    v_max3_u32 v1, v140, v141, v142
    v_max3_u32 v1, v1, v143, v144
    v_max3_u32 v1, v1, v145, v146
    v_max3_u32 v1, v1, v147, v148
    v_max3_u32 v1, v1, v149, v150
    v_max3_u32 v1, v1, v151, v152
    v_max3_u32 v1, v1, v153, v154
    v_max_u32 v1, v1, v155
    v_cmp_eq_u32 vcc, -1, v1
    s_cbranch_vccnz L3_re0
L3_ok0:
    v_mfma_f32_16x16x32_bf16 v[8:11], v[80:83], v[140:143], 0
    ds_read_b128 v[120:123], v78 offset:0
    v_mfma_f32_16x16x32_bf16 v[12:15], v[84:87], v[140:143], 0
    ds_read_b128 v[124:127], v78 offset:1024
    v_mfma_f32_16x16x32_bf16 v[16:19], v[88:91], v[140:143], 0
    s_mov_b32 s52, 8192
    buffer_load_dwordx4 v[172:175], v3, s[28:31], s52 offen offset:0 sc1
    ds_read_b128 v[128:131], v78 offset:2048
    v_mfma_f32_16x16x32_bf16 v[20:23], v[92:95], v[140:143], 0
    ds_read_b128 v[132:135], v78 offset:3072
    v_mfma_f32_16x16x32_bf16 v[24:27], v[96:99], v[140:143], 0
    ds_read_b128 v[136:139], v78 offset:4096
    buffer_load_dwordx4 v[176:179], v3, s[28:31], s52 offen offset:1024 sc1
    s_waitcnt vmcnt(8) lgkmcnt(5)
    v_mfma_f32_16x16x32_bf16 v[8:11], v[100:103], v[144:147], v[8:11]
    ds_read_b128 v[80:83], v79 offset:0
    v_mfma_f32_16x16x32_bf16 v[12:15], v[104:107], v[144:147], v[12:15]
    ds_read_b128 v[84:87], v79 offset:1024
    v_mfma_f32_16x16x32_bf16 v[16:19], v[108:111], v[144:147], v[16:19]
    buffer_load_dwordx4 v[180:183], v3, s[28:31], s52 offen offset:2048 sc1
    ds_read_b128 v[88:91], v79 offset:2048
    v_mfma_f32_16x16x32_bf16 v[20:23], v[112:115], v[144:147], v[20:23]
    ds_read_b128 v[92:95], v79 offset:3072
    v_mfma_f32_16x16x32_bf16 v[24:27], v[116:119], v[144:147], v[24:27]
    ds_read_b128 v[96:99], v79 offset:4096
    buffer_load_dwordx4 v[184:187], v3, s[28:31], s52 offen offset:3072 sc1
    s_waitcnt vmcnt(9) lgkmcnt(5)
    s_barrier
    v_mfma_f32_16x16x32_bf16 v[8:11], v[120:123], v[148:151], v[8:11]
    ds_read_b128 v[100:103], v76 offset:5120
    v_mfma_f32_16x16x32_bf16 v[12:15], v[124:127], v[148:151], v[12:15]
    ds_read_b128 v[104:107], v76 offset:6144
    v_mfma_f32_16x16x32_bf16 v[16:19], v[128:131], v[148:151], v[16:19]
    s_mov_b32 s52, 12288
    buffer_load_dwordx4 v[188:191], v3, s[28:31], s52 offen offset:0 sc1
    ds_read_b128 v[108:111], v76 offset:7168
    v_mfma_f32_16x16x32_bf16 v[20:23], v[132:135], v[148:151], v[20:23]
    ds_read_b128 v[112:115], v76 offset:8192
    v_mfma_f32_16x16x32_bf16 v[24:27], v[136:139], v[148:151], v[24:27]
    ds_read_b128 v[116:119], v76 offset:9216
    buffer_load_dwordx4 v[192:195], v3, s[28:31], s52 offen offset:1024 sc1
    s_waitcnt vmcnt(10) lgkmcnt(5)
    v_mfma_f32_16x16x32_bf16 v[8:11], v[80:83], v[152:155], v[8:11]
    ds_read_b128 v[120:123], v77 offset:5120
    v_mfma_f32_16x16x32_bf16 v[12:15], v[84:87], v[152:155], v[12:15]
    ds_read_b128 v[124:127], v77 offset:6144
    v_mfma_f32_16x16x32_bf16 v[16:19], v[88:91], v[152:155], v[16:19]
    buffer_load_dwordx4 v[196:199], v3, s[28:31], s52 offen offset:2048 sc1
    ds_read_b128 v[128:131], v77 offset:7168
    v_mfma_f32_16x16x32_bf16 v[20:23], v[92:95], v[152:155], v[20:23]
    ds_read_b128 v[132:135], v77 offset:8192
    v_mfma_f32_16x16x32_bf16 v[24:27], v[96:99], v[152:155], v[24:27]
    ds_read_b128 v[136:139], v77 offset:9216
    buffer_load_dwordx4 v[200:203], v3, s[28:31], s52 offen offset:3072 sc1
    s_waitcnt vmcnt(8) lgkmcnt(5)
    v_max3_u32 v1, v156, v157, v158
    v_max3_u32 v1, v1, v159, v160
    v_max3_u32 v1, v1, v161, v162
    v_max3_u32 v1, v1, v163, v164
    v_max3_u32 v1, v1, v165, v166
    v_max3_u32 v1, v1, v167, v168
    v_max3_u32 v1, v1, v169, v170
    v_max_u32 v1, v1, v171
    v_cmp_eq_u32 vcc, -1, v1
    s_cbranch_vccnz L3_re4
L3_ok4:
    v_mfma_f32_16x16x32_bf16 v[8:11], v[100:103], v[156:159], v[8:11]
    ds_read_b128 v[80:83], v78 offset:5120
    v_mfma_f32_16x16x32_bf16 v[12:15], v[104:107], v[156:159], v[12:15]
    ds_read_b128 v[84:87], v78 offset:6144
    v_mfma_f32_16x16x32_bf16 v[16:19], v[108:111], v[156:159], v[16:19]
    s_mov_b32 s52, 16384
    buffer_load_dwordx4 v[204:207], v3, s[28:31], s52 offen offset:0 sc1
    ds_read_b128 v[88:91], v78 offset:7168
    v_mfma_f32_16x16x32_bf16 v[20:23], v[112:115], v[156:159], v[20:23]
    ds_read_b128 v[92:95], v78 offset:8192
    v_mfma_f32_16x16x32_bf16 v[24:27], v[116:119], v[156:159], v[24:27]
    ds_read_b128 v[96:99], v78 offset:9216
    buffer_load_dwordx4 v[208:211], v3, s[28:31], s52 offen offset:1024 sc1
    s_waitcnt vmcnt(12) lgkmcnt(5)
    v_mfma_f32_16x16x32_bf16 v[8:11], v[120:123], v[160:163], v[8:11]
    ds_read_b128 v[100:103], v79 offset:5120
    v_mfma_f32_16x16x32_bf16 v[12:15], v[124:127], v[160:163], v[12:15]
    ds_read_b128 v[104:107], v79 offset:6144
    v_mfma_f32_16x16x32_bf16 v[16:19], v[128:131], v[160:163], v[16:19]
    buffer_load_dwordx4 v[212:215], v3, s[28:31], s52 offen offset:2048 sc1
    ds_read_b128 v[108:111], v79 offset:7168
    v_mfma_f32_16x16x32_bf16 v[20:23], v[132:135], v[160:163], v[20:23]
    ds_read_b128 v[112:115], v79 offset:8192
    v_mfma_f32_16x16x32_bf16 v[24:27], v[136:139], v[160:163], v[24:27]
    ds_read_b128 v[116:119], v79 offset:9216
    buffer_load_dwordx4 v[216:219], v3, s[28:31], s52 offen offset:3072 sc1
    s_waitcnt vmcnt(13) lgkmcnt(5)
    s_barrier
    v_mfma_f32_16x16x32_bf16 v[8:11], v[80:83], v[164:167], v[8:11]
    ds_read_b128 v[120:123], v76 offset:10240
    v_mfma_f32_16x16x32_bf16 v[12:15], v[84:87], v[164:167], v[12:15]
    ds_read_b128 v[124:127], v76 offset:11264
    v_mfma_f32_16x16x32_bf16 v[16:19], v[88:91], v[164:167], v[16:19]
    ds_read_b128 v[128:131], v76 offset:12288
    v_mfma_f32_16x16x32_bf16 v[20:23], v[92:95], v[164:167], v[20:23]
    ds_read_b128 v[132:135], v76 offset:13312
    v_mfma_f32_16x16x32_bf16 v[24:27], v[96:99], v[164:167], v[24:27]
    ds_read_b128 v[136:139], v76 offset:14336
    s_waitcnt vmcnt(12) lgkmcnt(5)
    v_mfma_f32_16x16x32_bf16 v[8:11], v[100:103], v[168:171], v[8:11]
    ds_read_b128 v[80:83], v77 offset:10240
    v_mfma_f32_16x16x32_bf16 v[12:15], v[104:107], v[168:171], v[12:15]
    ds_read_b128 v[84:87], v77 offset:11264
    v_mfma_f32_16x16x32_bf16 v[16:19], v[108:111], v[168:171], v[16:19]
    ds_read_b128 v[88:91], v77 offset:12288
    v_mfma_f32_16x16x32_bf16 v[20:23], v[112:115], v[168:171], v[20:23]
    ds_read_b128 v[92:95], v77 offset:13312
    v_mfma_f32_16x16x32_bf16 v[24:27], v[116:119], v[168:171], v[24:27]
    ds_read_b128 v[96:99], v77 offset:14336
    s_waitcnt vmcnt(8) lgkmcnt(5)
    v_max3_u32 v1, v172, v173, v174
    v_max3_u32 v1, v1, v175, v176
    v_max3_u32 v1, v1, v177, v178
    v_max3_u32 v1, v1, v179, v180
    v_max3_u32 v1, v1, v181, v182
    v_max3_u32 v1, v1, v183, v184
    v_max3_u32 v1, v1, v185, v186
    v_max_u32 v1, v1, v187
    v_cmp_eq_u32 vcc, -1, v1
    s_cbranch_vccnz L3_re8
L3_ok8:
    v_mfma_f32_16x16x32_bf16 v[8:11], v[120:123], v[172:175], v[8:11]
    ds_read_b128 v[100:103], v78 offset:10240
    v_mfma_f32_16x16x32_bf16 v[12:15], v[124:127], v[172:175], v[12:15]
    ds_read_b128 v[104:107], v78 offset:11264
    v_mfma_f32_16x16x32_bf16 v[16:19], v[128:131], v[172:175], v[16:19]
    ds_read_b128 v[108:111], v78 offset:12288
    v_mfma_f32_16x16x32_bf16 v[20:23], v[132:135], v[172:175], v[20:23]
    ds_read_b128 v[112:115], v78 offset:13312
    v_mfma_f32_16x16x32_bf16 v[24:27], v[136:139], v[172:175], v[24:27]
    ds_read_b128 v[116:119], v78 offset:14336
    s_waitcnt vmcnt(10) lgkmcnt(5)
    v_mfma_f32_16x16x32_bf16 v[8:11], v[80:83], v[176:179], v[8:11]
    ds_read_b128 v[120:123], v79 offset:10240
    v_mfma_f32_16x16x32_bf16 v[12:15], v[84:87], v[176:179], v[12:15]
    ds_read_b128 v[124:127], v79 offset:11264
    v_mfma_f32_16x16x32_bf16 v[16:19], v[88:91], v[176:179], v[16:19]
    ds_read_b128 v[128:131], v79 offset:12288
    v_mfma_f32_16x16x32_bf16 v[20:23], v[92:95], v[176:179], v[20:23]
    ds_read_b128 v[132:135], v79 offset:13312
    v_mfma_f32_16x16x32_bf16 v[24:27], v[96:99], v[176:179], v[24:27]
    ds_read_b128 v[136:139], v79 offset:14336
    s_waitcnt vmcnt(9) lgkmcnt(5)
    s_barrier
    v_mfma_f32_16x16x32_bf16 v[8:11], v[100:103], v[180:183], v[8:11]
    ds_read_b128 v[80:83], v76 offset:15360
    v_mfma_f32_16x16x32_bf16 v[12:15], v[104:107], v[180:183], v[12:15]
    ds_read_b128 v[84:87], v76 offset:16384
    v_mfma_f32_16x16x32_bf16 v[16:19], v[108:111], v[180:183], v[16:19]
    ds_read_b128 v[88:91], v76 offset:17408
    v_mfma_f32_16x16x32_bf16 v[20:23], v[112:115], v[180:183], v[20:23]
    ds_read_b128 v[92:95], v76 offset:18432
    v_mfma_f32_16x16x32_bf16 v[24:27], v[116:119], v[180:183], v[24:27]
    ds_read_b128 v[96:99], v76 offset:19456
    s_waitcnt vmcnt(8) lgkmcnt(5)
    v_mfma_f32_16x16x32_bf16 v[8:11], v[120:123], v[184:187], v[8:11]
    ds_read_b128 v[100:103], v77 offset:15360
    v_mfma_f32_16x16x32_bf16 v[12:15], v[124:127], v[184:187], v[12:15]
    ds_read_b128 v[104:107], v77 offset:16384
    v_mfma_f32_16x16x32_bf16 v[16:19], v[128:131], v[184:187], v[16:19]
    ds_read_b128 v[108:111], v77 offset:17408
    v_mfma_f32_16x16x32_bf16 v[20:23], v[132:135], v[184:187], v[20:23]
    ds_read_b128 v[112:115], v77 offset:18432
    v_mfma_f32_16x16x32_bf16 v[24:27], v[136:139], v[184:187], v[24:27]
    ds_read_b128 v[116:119], v77 offset:19456
    s_waitcnt vmcnt(4) lgkmcnt(5)
    v_max3_u32 v1, v188, v189, v190
    v_max3_u32 v1, v1, v191, v192
    v_max3_u32 v1, v1, v193, v194
    v_max3_u32 v1, v1, v195, v196
    v_max3_u32 v1, v1, v197, v198
    v_max3_u32 v1, v1, v199, v200
    v_max3_u32 v1, v1, v201, v202
    v_max_u32 v1, v1, v203
    v_cmp_eq_u32 vcc, -1, v1
    s_cbranch_vccnz L3_re12
L3_ok12:
    v_mfma_f32_16x16x32_bf16 v[8:11], v[80:83], v[188:191], v[8:11]
    ds_read_b128 v[120:123], v78 offset:15360
    v_mfma_f32_16x16x32_bf16 v[12:15], v[84:87], v[188:191], v[12:15]
    ds_read_b128 v[124:127], v78 offset:16384
    v_mfma_f32_16x16x32_bf16 v[16:19], v[88:91], v[188:191], v[16:19]
    ds_read_b128 v[128:131], v78 offset:17408
    v_mfma_f32_16x16x32_bf16 v[20:23], v[92:95], v[188:191], v[20:23]
    ds_read_b128 v[132:135], v78 offset:18432
    v_mfma_f32_16x16x32_bf16 v[24:27], v[96:99], v[188:191], v[24:27]
    ds_read_b128 v[136:139], v78 offset:19456
    v_and_b32 v49, 31, v2
    v_lshlrev_b32 v49, 2, v49
    buffer_load_dword v48, v49, s[44:47], s77 offen sc1
    s_waitcnt vmcnt(7) lgkmcnt(5)
    v_mfma_f32_16x16x32_bf16 v[8:11], v[100:103], v[192:195], v[8:11]
    ds_read_b128 v[80:83], v79 offset:15360
    v_mfma_f32_16x16x32_bf16 v[12:15], v[104:107], v[192:195], v[12:15]
    ds_read_b128 v[84:87], v79 offset:16384
    v_mfma_f32_16x16x32_bf16 v[16:19], v[108:111], v[192:195], v[16:19]
    ds_read_b128 v[88:91], v79 offset:17408
    v_mfma_f32_16x16x32_bf16 v[20:23], v[112:115], v[192:195], v[20:23]
    ds_read_b128 v[92:95], v79 offset:18432
    v_mfma_f32_16x16x32_bf16 v[24:27], v[116:119], v[192:195], v[24:27]
    ds_read_b128 v[96:99], v79 offset:19456
    v_lshlrev_b32 v28, 16, v64
    v_and_b32 v29, s61, v64
    v_lshlrev_b32 v30, 16, v65
    v_and_b32 v31, s61, v65
    s_waitcnt vmcnt(6) lgkmcnt(5)
    s_barrier
    v_mfma_f32_16x16x32_bf16 v[8:11], v[120:123], v[196:199], v[8:11]
    ds_read_b128 v[100:103], v76 offset:20480
    v_mfma_f32_16x16x32_bf16 v[12:15], v[124:127], v[196:199], v[12:15]
    ds_read_b128 v[104:107], v76 offset:21504
    v_mfma_f32_16x16x32_bf16 v[16:19], v[128:131], v[196:199], v[16:19]
    ds_read_b128 v[108:111], v76 offset:22528
    v_mfma_f32_16x16x32_bf16 v[20:23], v[132:135], v[196:199], v[20:23]
    ds_read_b128 v[112:115], v76 offset:23552
    v_mfma_f32_16x16x32_bf16 v[24:27], v[136:139], v[196:199], v[24:27]
    ds_read_b128 v[116:119], v76 offset:24576
    v_lshlrev_b32 v32, 16, v66
    v_and_b32 v33, s61, v66
    v_lshlrev_b32 v34, 16, v67
    v_and_b32 v35, s61, v67
    s_waitcnt vmcnt(5) lgkmcnt(5)
    v_mfma_f32_16x16x32_bf16 v[8:11], v[80:83], v[200:203], v[8:11]
    ds_read_b128 v[120:123], v77 offset:20480
    v_mfma_f32_16x16x32_bf16 v[12:15], v[84:87], v[200:203], v[12:15]
    ds_read_b128 v[124:127], v77 offset:21504
    v_mfma_f32_16x16x32_bf16 v[16:19], v[88:91], v[200:203], v[16:19]
    ds_read_b128 v[128:131], v77 offset:22528
    v_mfma_f32_16x16x32_bf16 v[20:23], v[92:95], v[200:203], v[20:23]
    ds_read_b128 v[132:135], v77 offset:23552
    v_mfma_f32_16x16x32_bf16 v[24:27], v[96:99], v[200:203], v[24:27]
    ds_read_b128 v[136:139], v77 offset:24576
    v_lshlrev_b32 v36, 16, v68
    v_and_b32 v37, s61, v68
    v_lshlrev_b32 v38, 16, v69
    v_and_b32 v39, s61, v69
    s_waitcnt vmcnt(1) lgkmcnt(5)
    v_max3_u32 v1, v204, v205, v206
    v_max3_u32 v1, v1, v207, v208
    v_max3_u32 v1, v1, v209, v210
    v_max3_u32 v1, v1, v211, v212
    v_max3_u32 v1, v1, v213, v214
    v_max3_u32 v1, v1, v215, v216
    v_max3_u32 v1, v1, v217, v218
    v_max_u32 v1, v1, v219
    v_cmp_eq_u32 vcc, -1, v1
    s_cbranch_vccnz L3_re16
L3_ok16:
    v_mfma_f32_16x16x32_bf16 v[8:11], v[100:103], v[204:207], v[8:11]
    ds_read_b128 v[80:83], v78 offset:20480
    v_mfma_f32_16x16x32_bf16 v[12:15], v[104:107], v[204:207], v[12:15]
    ds_read_b128 v[84:87], v78 offset:21504
    v_mfma_f32_16x16x32_bf16 v[16:19], v[108:111], v[204:207], v[16:19]
    ds_read_b128 v[88:91], v78 offset:22528
    v_mfma_f32_16x16x32_bf16 v[20:23], v[112:115], v[204:207], v[20:23]
    ds_read_b128 v[92:95], v78 offset:23552
    v_mfma_f32_16x16x32_bf16 v[24:27], v[116:119], v[204:207], v[24:27]
    ds_read_b128 v[96:99], v78 offset:24576
    v_lshlrev_b32 v40, 16, v70
    v_and_b32 v41, s61, v70
    v_lshlrev_b32 v42, 16, v71
    v_and_b32 v43, s61, v71
    s_waitcnt vmcnt(3) lgkmcnt(5)
    v_mfma_f32_16x16x32_bf16 v[8:11], v[120:123], v[208:211], v[8:11]
    ds_read_b128 v[100:103], v79 offset:20480
    v_mfma_f32_16x16x32_bf16 v[12:15], v[124:127], v[208:211], v[12:15]
    ds_read_b128 v[104:107], v79 offset:21504
    v_mfma_f32_16x16x32_bf16 v[16:19], v[128:131], v[208:211], v[16:19]
    ds_read_b128 v[108:111], v79 offset:22528
    v_mfma_f32_16x16x32_bf16 v[20:23], v[132:135], v[208:211], v[20:23]
    ds_read_b128 v[112:115], v79 offset:23552
    v_mfma_f32_16x16x32_bf16 v[24:27], v[136:139], v[208:211], v[24:27]
    ds_read_b128 v[116:119], v79 offset:24576
    v_lshlrev_b32 v44, 16, v72
    v_and_b32 v45, s61, v72
    v_lshlrev_b32 v46, 16, v73
    v_and_b32 v47, s61, v73
    s_waitcnt vmcnt(2) lgkmcnt(5)
    v_mfma_f32_16x16x32_bf16 v[8:11], v[80:83], v[212:215], v[8:11]
    v_mfma_f32_16x16x32_bf16 v[12:15], v[84:87], v[212:215], v[12:15]
    v_mfma_f32_16x16x32_bf16 v[16:19], v[88:91], v[212:215], v[16:19]
    v_mfma_f32_16x16x32_bf16 v[20:23], v[92:95], v[212:215], v[20:23]
    v_mfma_f32_16x16x32_bf16 v[24:27], v[96:99], v[212:215], v[24:27]
    s_waitcnt vmcnt(1) lgkmcnt(0)
    v_mfma_f32_16x16x32_bf16 v[8:11], v[100:103], v[216:219], v[8:11]
    v_mfma_f32_16x16x32_bf16 v[12:15], v[104:107], v[216:219], v[12:15]
    v_mfma_f32_16x16x32_bf16 v[16:19], v[108:111], v[216:219], v[16:19]
    v_mfma_f32_16x16x32_bf16 v[20:23], v[112:115], v[216:219], v[20:23]
    v_mfma_f32_16x16x32_bf16 v[24:27], v[116:119], v[216:219], v[24:27]
    s_barrier
    s_waitcnt vmcnt(0)
    v_cmp_eq_u32 vcc, 0, v48
    s_cbranch_vccnz L3_gd
L3_gdr:
    s_nop 2
    v_pk_add_f32 v[8:9], v[8:9], v[28:29]
    v_cvt_pk_bf16_f32 v64, v8, v9
    v_pk_add_f32 v[10:11], v[10:11], v[30:31]
    v_cvt_pk_bf16_f32 v65, v10, v11
    v_pk_add_f32 v[12:13], v[12:13], v[32:33]
    v_cvt_pk_bf16_f32 v66, v12, v13
    v_pk_add_f32 v[14:15], v[14:15], v[34:35]
    v_cvt_pk_bf16_f32 v67, v14, v15
    buffer_store_dwordx4 v[64:67], v3, s[36:39], s62 offen
    v_pk_add_f32 v[16:17], v[16:17], v[36:37]
    v_cvt_pk_bf16_f32 v68, v16, v17
    v_pk_add_f32 v[18:19], v[18:19], v[38:39]
    v_cvt_pk_bf16_f32 v69, v18, v19
    v_pk_add_f32 v[20:21], v[20:21], v[40:41]
    v_cvt_pk_bf16_f32 v70, v20, v21
    v_pk_add_f32 v[22:23], v[22:23], v[42:43]
    v_cvt_pk_bf16_f32 v71, v22, v23
    buffer_store_dwordx4 v[68:71], v3, s[36:39], s62 offen offset:1024
    v_pk_add_f32 v[24:25], v[24:25], v[44:45]
    v_cvt_pk_bf16_f32 v72, v24, v25
    v_pk_add_f32 v[26:27], v[26:27], v[46:47]
    v_cvt_pk_bf16_f32 v73, v26, v27
    buffer_store_dwordx2 v[72:73], v3, s[36:39], s63 offen
    v_mfma_f32_16x16x32_bf16 v[52:55], v[64:67], v[64:67], 0
    v_mfma_f32_16x16x32_bf16 v[56:59], v[60:63], v[64:67], 0
    v_mfma_f32_16x16x32_bf16 v[52:55], v[68:71], v[68:71], v[52:55]
    v_mfma_f32_16x16x32_bf16 v[56:59], v[60:63], v[68:71], v[56:59]
    v_mfma_f32_16x16x32_bf16 v[52:55], v[72:75], v[72:75], v[52:55]
    v_mfma_f32_16x16x32_bf16 v[56:59], v[60:63], v[72:75], v[56:59]
    s_mov_b32 exec_lo, 0x00f0000f
    s_mov_b32 exec_hi, 0xf0000f00
    s_nop 5
    v_cndmask_b32 v57, v52, v53, s[84:85]
    v_cndmask_b32 v57, v57, v54, s[86:87]
    v_cndmask_b32 v57, v57, v55, s[88:89]
    buffer_store_dwordx2 v[56:57], v248, s[40:43], s64 offen
    v_mov_b32 v1, 1
    s_mov_b64 exec, 1
    s_cmp_eq_u32 s25, 0
    s_waitcnt vmcnt(0)
    s_cbranch_scc1 Lsg6
    buffer_store_dword v1, off, s[44:47], s65
Lsg6_e:
    s_mov_b64 exec, -1
    s_add_u32 s28, s10, s66
    s_addc_u32 s29, s11, 0
    s_mov_b32 s30, 40960
    s_mov_b32 s31, 0x00020000
    s_barrier
    ds_read_b128 v[80:83], v76 offset:25600
    ds_read_b128 v[84:87], v76 offset:26624
    ds_read_b128 v[88:91], v76 offset:27648
    ds_read_b128 v[92:95], v76 offset:28672
    ds_read_b128 v[96:99], v76 offset:29696
    ds_read_b128 v[100:103], v76 offset:30720
    ds_read_b128 v[104:107], v76 offset:31744
    s_add_u32 s55, s60, 16384
    v_lshlrev_b32 v1, 2, v2
    s_mov_b64 s[70:71], 0xffff
    s_mov_b32 s3, 400000
Lp7:
    buffer_load_dword v5, v1, s[44:47], s55 offen sc1
Lp7_c:
    s_waitcnt vmcnt(0)
    v_cmp_eq_u32 vcc, 0, v5
    s_and_b64 s[72:73], vcc, s[70:71]
    s_sub_u32 s3, s3, 1
    s_cselect_b64 s[72:73], 0, s[72:73]
    s_cmp_lg_u64 s[72:73], 0
    s_cbranch_scc1 Lp7
    s_cmp_eq_u32 s25, 0
    s_cbranch_scc1 Laq8
Laq8_e:
    s_add_u32 s55, s66, 5257216
    s_add_u32 s56, s55, 20480
    buffer_load_dwordx4 v[236:239], v3, s[40:43], s55 offen sc1
    buffer_load_dwordx4 v[240:243], v3, s[40:43], s56 offen sc1
    s_mov_b32 s52, 0
    s_add_u32 s53, s52, 20480
    buffer_load_dwordx4 v[140:143], v3, s[28:31], s52 offen offset:0 sc1
    buffer_load_dwordx4 v[144:147], v3, s[28:31], s53 offen offset:0 sc1
    buffer_load_dwordx4 v[148:151], v3, s[28:31], s52 offen offset:1024 sc1
    buffer_load_dwordx4 v[152:155], v3, s[28:31], s53 offen offset:1024 sc1
    buffer_load_dwordx4 v[156:159], v3, s[28:31], s52 offen offset:2048 sc1
    buffer_load_dwordx4 v[160:163], v3, s[28:31], s53 offen offset:2048 sc1
    buffer_load_dwordx4 v[164:167], v3, s[28:31], s52 offen offset:3072 sc1
    buffer_load_dwordx4 v[168:171], v3, s[28:31], s53 offen offset:3072 sc1
    s_mov_b32 s52, 4096
    s_add_u32 s53, s52, 20480
    buffer_load_dwordx4 v[172:175], v3, s[28:31], s52 offen offset:0 sc1
    buffer_load_dwordx4 v[176:179], v3, s[28:31], s53 offen offset:0 sc1
    buffer_load_dwordx4 v[180:183], v3, s[28:31], s52 offen offset:1024 sc1
    buffer_load_dwordx4 v[184:187], v3, s[28:31], s53 offen offset:1024 sc1
    buffer_load_dwordx4 v[188:191], v3, s[28:31], s52 offen offset:2048 sc1
    buffer_load_dwordx4 v[192:195], v3, s[28:31], s53 offen offset:2048 sc1
    buffer_load_dwordx4 v[196:199], v3, s[28:31], s52 offen offset:3072 sc1
    buffer_load_dwordx4 v[200:203], v3, s[28:31], s53 offen offset:3072 sc1
    s_waitcnt vmcnt(14) lgkmcnt(0)
    v_mfma_f32_16x16x32_bf16 v[8:11], v[80:83], v[140:143], 0
    ds_read_b128 v[108:111], v77 offset:25600
    v_mfma_f32_16x16x32_bf16 v[12:15], v[80:83], v[144:147], 0
    ds_read_b128 v[112:115], v77 offset:26624
    v_mfma_f32_16x16x32_bf16 v[16:19], v[84:87], v[140:143], 0
    ds_read_b128 v[116:119], v77 offset:27648
    v_mfma_f32_16x16x32_bf16 v[20:23], v[84:87], v[144:147], 0
    ds_read_b128 v[120:123], v77 offset:28672
    v_mfma_f32_16x16x32_bf16 v[24:27], v[88:91], v[140:143], 0
    ds_read_b128 v[124:127], v77 offset:29696
    v_mfma_f32_16x16x32_bf16 v[28:31], v[88:91], v[144:147], 0
    ds_read_b128 v[128:131], v77 offset:30720
    v_mfma_f32_16x16x32_bf16 v[32:35], v[92:95], v[140:143], 0
    ds_read_b128 v[132:135], v77 offset:31744
    v_mfma_f32_16x16x32_bf16 v[36:39], v[92:95], v[144:147], 0
    v_mfma_f32_16x16x32_bf16 v[40:43], v[96:99], v[140:143], 0
    v_mfma_f32_16x16x32_bf16 v[44:47], v[96:99], v[144:147], 0
    v_mfma_f32_16x16x32_bf16 v[48:51], v[100:103], v[140:143], 0
    v_mfma_f32_16x16x32_bf16 v[52:55], v[100:103], v[144:147], 0
    v_mfma_f32_16x16x32_bf16 v[56:59], v[104:107], v[140:143], 0
    v_mfma_f32_16x16x32_bf16 v[60:63], v[104:107], v[144:147], 0
    s_mov_b32 s52, 8192
    s_add_u32 s53, s52, 20480
    buffer_load_dwordx4 v[140:143], v3, s[28:31], s52 offen offset:0 sc1
    buffer_load_dwordx4 v[144:147], v3, s[28:31], s53 offen offset:0 sc1
    s_waitcnt vmcnt(14) lgkmcnt(0)
    v_mfma_f32_16x16x32_bf16 v[8:11], v[108:111], v[148:151], v[8:11]
    ds_read_b128 v[80:83], v78 offset:25600
    v_mfma_f32_16x16x32_bf16 v[12:15], v[108:111], v[152:155], v[12:15]
    ds_read_b128 v[84:87], v78 offset:26624
    v_mfma_f32_16x16x32_bf16 v[16:19], v[112:115], v[148:151], v[16:19]
    ds_read_b128 v[88:91], v78 offset:27648
    v_mfma_f32_16x16x32_bf16 v[20:23], v[112:115], v[152:155], v[20:23]
    ds_read_b128 v[92:95], v78 offset:28672
    v_mfma_f32_16x16x32_bf16 v[24:27], v[116:119], v[148:151], v[24:27]
    ds_read_b128 v[96:99], v78 offset:29696
    v_mfma_f32_16x16x32_bf16 v[28:31], v[116:119], v[152:155], v[28:31]
    ds_read_b128 v[100:103], v78 offset:30720
    v_mfma_f32_16x16x32_bf16 v[32:35], v[120:123], v[148:151], v[32:35]
    ds_read_b128 v[104:107], v78 offset:31744
    v_mfma_f32_16x16x32_bf16 v[36:39], v[120:123], v[152:155], v[36:39]
    v_mfma_f32_16x16x32_bf16 v[40:43], v[124:127], v[148:151], v[40:43]
    v_mfma_f32_16x16x32_bf16 v[44:47], v[124:127], v[152:155], v[44:47]
    v_mfma_f32_16x16x32_bf16 v[48:51], v[128:131], v[148:151], v[48:51]
    v_mfma_f32_16x16x32_bf16 v[52:55], v[128:131], v[152:155], v[52:55]
    v_mfma_f32_16x16x32_bf16 v[56:59], v[132:135], v[148:151], v[56:59]
    v_mfma_f32_16x16x32_bf16 v[60:63], v[132:135], v[152:155], v[60:63]
    buffer_load_dwordx4 v[148:151], v3, s[28:31], s52 offen offset:1024 sc1
    buffer_load_dwordx4 v[152:155], v3, s[28:31], s53 offen offset:1024 sc1
    s_waitcnt vmcnt(14) lgkmcnt(0)
    v_mfma_f32_16x16x32_bf16 v[8:11], v[80:83], v[156:159], v[8:11]
    ds_read_b128 v[108:111], v79 offset:25600
    v_mfma_f32_16x16x32_bf16 v[12:15], v[80:83], v[160:163], v[12:15]
    ds_read_b128 v[112:115], v79 offset:26624
    v_mfma_f32_16x16x32_bf16 v[16:19], v[84:87], v[156:159], v[16:19]
    ds_read_b128 v[116:119], v79 offset:27648
    v_mfma_f32_16x16x32_bf16 v[20:23], v[84:87], v[160:163], v[20:23]
    ds_read_b128 v[120:123], v79 offset:28672
    v_mfma_f32_16x16x32_bf16 v[24:27], v[88:91], v[156:159], v[24:27]
    ds_read_b128 v[124:127], v79 offset:29696
    v_mfma_f32_16x16x32_bf16 v[28:31], v[88:91], v[160:163], v[28:31]
    ds_read_b128 v[128:131], v79 offset:30720
    v_mfma_f32_16x16x32_bf16 v[32:35], v[92:95], v[156:159], v[32:35]
    ds_read_b128 v[132:135], v79 offset:31744
    v_mfma_f32_16x16x32_bf16 v[36:39], v[92:95], v[160:163], v[36:39]
    v_mfma_f32_16x16x32_bf16 v[40:43], v[96:99], v[156:159], v[40:43]
    v_mfma_f32_16x16x32_bf16 v[44:47], v[96:99], v[160:163], v[44:47]
    v_mfma_f32_16x16x32_bf16 v[48:51], v[100:103], v[156:159], v[48:51]
    v_mfma_f32_16x16x32_bf16 v[52:55], v[100:103], v[160:163], v[52:55]
    v_mfma_f32_16x16x32_bf16 v[56:59], v[104:107], v[156:159], v[56:59]
    v_mfma_f32_16x16x32_bf16 v[60:63], v[104:107], v[160:163], v[60:63]
    buffer_load_dwordx4 v[156:159], v3, s[28:31], s52 offen offset:2048 sc1
    buffer_load_dwordx4 v[160:163], v3, s[28:31], s53 offen offset:2048 sc1
    v_add_f32 v236, v236, v238
    v_add_f32 v237, v237, v239
    v_mov_b32 v238, v236
    v_mov_b32 v239, v237
    s_nop 1
    v_permlane32_swap_b32 v236, v238
    s_waitcnt vmcnt(14) lgkmcnt(0)
    s_barrier
    v_mfma_f32_16x16x32_bf16 v[8:11], v[108:111], v[164:167], v[8:11]
    ds_read_b128 v[80:83], v76 offset:32768
    v_mfma_f32_16x16x32_bf16 v[12:15], v[108:111], v[168:171], v[12:15]
    ds_read_b128 v[84:87], v76 offset:33792
    v_mfma_f32_16x16x32_bf16 v[16:19], v[112:115], v[164:167], v[16:19]
    ds_read_b128 v[88:91], v76 offset:34816
    v_mfma_f32_16x16x32_bf16 v[20:23], v[112:115], v[168:171], v[20:23]
    ds_read_b128 v[92:95], v76 offset:35840
    v_mfma_f32_16x16x32_bf16 v[24:27], v[116:119], v[164:167], v[24:27]
    ds_read_b128 v[96:99], v76 offset:36864
    v_mfma_f32_16x16x32_bf16 v[28:31], v[116:119], v[168:171], v[28:31]
    ds_read_b128 v[100:103], v76 offset:37888
    v_mfma_f32_16x16x32_bf16 v[32:35], v[120:123], v[164:167], v[32:35]
    ds_read_b128 v[104:107], v76 offset:38912
    v_mfma_f32_16x16x32_bf16 v[36:39], v[120:123], v[168:171], v[36:39]
    v_mfma_f32_16x16x32_bf16 v[40:43], v[124:127], v[164:167], v[40:43]
    v_mfma_f32_16x16x32_bf16 v[44:47], v[124:127], v[168:171], v[44:47]
    v_mfma_f32_16x16x32_bf16 v[48:51], v[128:131], v[164:167], v[48:51]
    v_mfma_f32_16x16x32_bf16 v[52:55], v[128:131], v[168:171], v[52:55]
    v_mfma_f32_16x16x32_bf16 v[56:59], v[132:135], v[164:167], v[56:59]
    v_mfma_f32_16x16x32_bf16 v[60:63], v[132:135], v[168:171], v[60:63]
    buffer_load_dwordx4 v[164:167], v3, s[28:31], s52 offen offset:3072 sc1
    buffer_load_dwordx4 v[168:171], v3, s[28:31], s53 offen offset:3072 sc1
    v_permlane32_swap_b32 v237, v239
    v_add_f32 v236, v236, v238
    v_add_f32 v237, v237, v239
    v_mov_b32 v238, v236
    v_mov_b32 v239, v237
    s_nop 1
    s_waitcnt vmcnt(14) lgkmcnt(0)
    v_mfma_f32_16x16x32_bf16 v[8:11], v[80:83], v[172:175], v[8:11]
    ds_read_b128 v[108:111], v77 offset:32768
    v_mfma_f32_16x16x32_bf16 v[12:15], v[80:83], v[176:179], v[12:15]
    ds_read_b128 v[112:115], v77 offset:33792
    v_mfma_f32_16x16x32_bf16 v[16:19], v[84:87], v[172:175], v[16:19]
    ds_read_b128 v[116:119], v77 offset:34816
    v_mfma_f32_16x16x32_bf16 v[20:23], v[84:87], v[176:179], v[20:23]
    ds_read_b128 v[120:123], v77 offset:35840
    v_mfma_f32_16x16x32_bf16 v[24:27], v[88:91], v[172:175], v[24:27]
    ds_read_b128 v[124:127], v77 offset:36864
    v_mfma_f32_16x16x32_bf16 v[28:31], v[88:91], v[176:179], v[28:31]
    ds_read_b128 v[128:131], v77 offset:37888
    v_mfma_f32_16x16x32_bf16 v[32:35], v[92:95], v[172:175], v[32:35]
    ds_read_b128 v[132:135], v77 offset:38912
    v_mfma_f32_16x16x32_bf16 v[36:39], v[92:95], v[176:179], v[36:39]
    v_mfma_f32_16x16x32_bf16 v[40:43], v[96:99], v[172:175], v[40:43]
    v_mfma_f32_16x16x32_bf16 v[44:47], v[96:99], v[176:179], v[44:47]
    v_mfma_f32_16x16x32_bf16 v[48:51], v[100:103], v[172:175], v[48:51]
    v_mfma_f32_16x16x32_bf16 v[52:55], v[100:103], v[176:179], v[52:55]
    v_mfma_f32_16x16x32_bf16 v[56:59], v[104:107], v[172:175], v[56:59]
    v_mfma_f32_16x16x32_bf16 v[60:63], v[104:107], v[176:179], v[60:63]
    s_mov_b32 s52, 12288
    s_add_u32 s53, s52, 20480
    buffer_load_dwordx4 v[172:175], v3, s[28:31], s52 offen offset:0 sc1
    buffer_load_dwordx4 v[176:179], v3, s[28:31], s53 offen offset:0 sc1
    v_permlane16_swap_b32 v236, v238
    v_permlane16_swap_b32 v237, v239
    v_add_f32 v236, v236, v238
    v_add_f32 v237, v237, v239
    v_mul_f32 v236, 0xbacccccd, v236
    v_mul_f32 v237, 0x3acccccd, v237
    s_waitcnt vmcnt(14) lgkmcnt(0)
    v_mfma_f32_16x16x32_bf16 v[8:11], v[108:111], v[180:183], v[8:11]
    ds_read_b128 v[80:83], v78 offset:32768
    v_mfma_f32_16x16x32_bf16 v[12:15], v[108:111], v[184:187], v[12:15]
    ds_read_b128 v[84:87], v78 offset:33792
    v_mfma_f32_16x16x32_bf16 v[16:19], v[112:115], v[180:183], v[16:19]
    ds_read_b128 v[88:91], v78 offset:34816
    v_mfma_f32_16x16x32_bf16 v[20:23], v[112:115], v[184:187], v[20:23]
    ds_read_b128 v[92:95], v78 offset:35840
    v_mfma_f32_16x16x32_bf16 v[24:27], v[116:119], v[180:183], v[24:27]
    ds_read_b128 v[96:99], v78 offset:36864
    v_mfma_f32_16x16x32_bf16 v[28:31], v[116:119], v[184:187], v[28:31]
    ds_read_b128 v[100:103], v78 offset:37888
    v_mfma_f32_16x16x32_bf16 v[32:35], v[120:123], v[180:183], v[32:35]
    ds_read_b128 v[104:107], v78 offset:38912
    v_mfma_f32_16x16x32_bf16 v[36:39], v[120:123], v[184:187], v[36:39]
    v_mfma_f32_16x16x32_bf16 v[40:43], v[124:127], v[180:183], v[40:43]
    v_mfma_f32_16x16x32_bf16 v[44:47], v[124:127], v[184:187], v[44:47]
    v_mfma_f32_16x16x32_bf16 v[48:51], v[128:131], v[180:183], v[48:51]
    v_mfma_f32_16x16x32_bf16 v[52:55], v[128:131], v[184:187], v[52:55]
    v_mfma_f32_16x16x32_bf16 v[56:59], v[132:135], v[180:183], v[56:59]
    v_mfma_f32_16x16x32_bf16 v[60:63], v[132:135], v[184:187], v[60:63]
    buffer_load_dwordx4 v[180:183], v3, s[28:31], s52 offen offset:1024 sc1
    buffer_load_dwordx4 v[184:187], v3, s[28:31], s53 offen offset:1024 sc1
    v_fma_f32 v237, -v236, v236, v237
    v_max_f32 v237, 0, v237
    v_add_f32 v237, 0x3727c5ac, v237
    v_rsq_f32 v238, v237
    s_nop 0
    v_mul_f32 v244, 0xbfb8aa3b, v238
    s_waitcnt vmcnt(14) lgkmcnt(0)
    v_mfma_f32_16x16x32_bf16 v[8:11], v[80:83], v[188:191], v[8:11]
    ds_read_b128 v[108:111], v79 offset:32768
    v_mfma_f32_16x16x32_bf16 v[12:15], v[80:83], v[192:195], v[12:15]
    ds_read_b128 v[112:115], v79 offset:33792
    v_mfma_f32_16x16x32_bf16 v[16:19], v[84:87], v[188:191], v[16:19]
    ds_read_b128 v[116:119], v79 offset:34816
    v_mfma_f32_16x16x32_bf16 v[20:23], v[84:87], v[192:195], v[20:23]
    ds_read_b128 v[120:123], v79 offset:35840
    v_mfma_f32_16x16x32_bf16 v[24:27], v[88:91], v[188:191], v[24:27]
    ds_read_b128 v[124:127], v79 offset:36864
    v_mfma_f32_16x16x32_bf16 v[28:31], v[88:91], v[192:195], v[28:31]
    ds_read_b128 v[128:131], v79 offset:37888
    v_mfma_f32_16x16x32_bf16 v[32:35], v[92:95], v[188:191], v[32:35]
    ds_read_b128 v[132:135], v79 offset:38912
    v_mfma_f32_16x16x32_bf16 v[36:39], v[92:95], v[192:195], v[36:39]
    v_mfma_f32_16x16x32_bf16 v[40:43], v[96:99], v[188:191], v[40:43]
    v_mfma_f32_16x16x32_bf16 v[44:47], v[96:99], v[192:195], v[44:47]
    v_mfma_f32_16x16x32_bf16 v[48:51], v[100:103], v[188:191], v[48:51]
    v_mfma_f32_16x16x32_bf16 v[52:55], v[100:103], v[192:195], v[52:55]
    v_mfma_f32_16x16x32_bf16 v[56:59], v[104:107], v[188:191], v[56:59]
    v_mfma_f32_16x16x32_bf16 v[60:63], v[104:107], v[192:195], v[60:63]
    buffer_load_dwordx4 v[188:191], v3, s[28:31], s52 offen offset:2048 sc1
    buffer_load_dwordx4 v[192:195], v3, s[28:31], s53 offen offset:2048 sc1
    v_mul_f32 v238, v237, v238
    v_add_f32 v240, v240, v242
    v_add_f32 v241, v241, v243
    v_mov_b32 v242, v240
    v_mov_b32 v243, v241
    s_nop 1
    s_waitcnt vmcnt(14) lgkmcnt(0)
    s_barrier
    v_mfma_f32_16x16x32_bf16 v[8:11], v[108:111], v[196:199], v[8:11]
    ds_read_b128 v[80:83], v76 offset:0
    v_mfma_f32_16x16x32_bf16 v[12:15], v[108:111], v[200:203], v[12:15]
    ds_read_b128 v[84:87], v76 offset:1024
    v_mfma_f32_16x16x32_bf16 v[16:19], v[112:115], v[196:199], v[16:19]
    ds_read_b128 v[88:91], v76 offset:2048
    v_mfma_f32_16x16x32_bf16 v[20:23], v[112:115], v[200:203], v[20:23]
    ds_read_b128 v[92:95], v76 offset:3072
    v_mfma_f32_16x16x32_bf16 v[24:27], v[116:119], v[196:199], v[24:27]
    ds_read_b128 v[96:99], v76 offset:4096
    v_mfma_f32_16x16x32_bf16 v[28:31], v[116:119], v[200:203], v[28:31]
    ds_read_b128 v[100:103], v76 offset:5120
    v_mfma_f32_16x16x32_bf16 v[32:35], v[120:123], v[196:199], v[32:35]
    ds_read_b128 v[104:107], v76 offset:6144
    v_mfma_f32_16x16x32_bf16 v[36:39], v[120:123], v[200:203], v[36:39]
    v_mfma_f32_16x16x32_bf16 v[40:43], v[124:127], v[196:199], v[40:43]
    v_mfma_f32_16x16x32_bf16 v[44:47], v[124:127], v[200:203], v[44:47]
    v_mfma_f32_16x16x32_bf16 v[48:51], v[128:131], v[196:199], v[48:51]
    v_mfma_f32_16x16x32_bf16 v[52:55], v[128:131], v[200:203], v[52:55]
    v_mfma_f32_16x16x32_bf16 v[56:59], v[132:135], v[196:199], v[56:59]
    v_mfma_f32_16x16x32_bf16 v[60:63], v[132:135], v[200:203], v[60:63]
    buffer_load_dwordx4 v[196:199], v3, s[28:31], s52 offen offset:3072 sc1
    buffer_load_dwordx4 v[200:203], v3, s[28:31], s53 offen offset:3072 sc1
    v_permlane32_swap_b32 v240, v242
    v_permlane32_swap_b32 v241, v243
    v_add_f32 v240, v240, v242
    v_add_f32 v241, v241, v243
    v_mov_b32 v242, v240
    v_mov_b32 v243, v241
    s_waitcnt vmcnt(14) lgkmcnt(0)
    v_mfma_f32_16x16x32_bf16 v[8:11], v[80:83], v[140:143], v[8:11]
    ds_read_b128 v[108:111], v77 offset:0
    v_mfma_f32_16x16x32_bf16 v[12:15], v[80:83], v[144:147], v[12:15]
    ds_read_b128 v[112:115], v77 offset:1024
    v_mfma_f32_16x16x32_bf16 v[16:19], v[84:87], v[140:143], v[16:19]
    ds_read_b128 v[116:119], v77 offset:2048
    v_mfma_f32_16x16x32_bf16 v[20:23], v[84:87], v[144:147], v[20:23]
    ds_read_b128 v[120:123], v77 offset:3072
    v_mfma_f32_16x16x32_bf16 v[24:27], v[88:91], v[140:143], v[24:27]
    ds_read_b128 v[124:127], v77 offset:4096
    v_mfma_f32_16x16x32_bf16 v[28:31], v[88:91], v[144:147], v[28:31]
    ds_read_b128 v[128:131], v77 offset:5120
    v_mfma_f32_16x16x32_bf16 v[32:35], v[92:95], v[140:143], v[32:35]
    ds_read_b128 v[132:135], v77 offset:6144
    v_mfma_f32_16x16x32_bf16 v[36:39], v[92:95], v[144:147], v[36:39]
    v_mfma_f32_16x16x32_bf16 v[40:43], v[96:99], v[140:143], v[40:43]
    v_mfma_f32_16x16x32_bf16 v[44:47], v[96:99], v[144:147], v[44:47]
    v_mfma_f32_16x16x32_bf16 v[48:51], v[100:103], v[140:143], v[48:51]
    v_mfma_f32_16x16x32_bf16 v[52:55], v[100:103], v[144:147], v[52:55]
    v_mfma_f32_16x16x32_bf16 v[56:59], v[104:107], v[140:143], v[56:59]
    v_mfma_f32_16x16x32_bf16 v[60:63], v[104:107], v[144:147], v[60:63]
    s_mov_b32 s52, 16384
    s_add_u32 s53, s52, 20480
    buffer_load_dwordx4 v[140:143], v3, s[28:31], s52 offen offset:0 sc1
    buffer_load_dwordx4 v[144:147], v3, s[28:31], s53 offen offset:0 sc1
    s_nop 1
    v_permlane16_swap_b32 v240, v242
    v_permlane16_swap_b32 v241, v243
    v_add_f32 v240, v240, v242
    v_add_f32 v241, v241, v243
    v_mul_f32 v240, 0xbacccccd, v240
    s_waitcnt vmcnt(14) lgkmcnt(0)
    v_mfma_f32_16x16x32_bf16 v[8:11], v[108:111], v[148:151], v[8:11]
    ds_read_b128 v[80:83], v78 offset:0
    v_mfma_f32_16x16x32_bf16 v[12:15], v[108:111], v[152:155], v[12:15]
    ds_read_b128 v[84:87], v78 offset:1024
    v_mfma_f32_16x16x32_bf16 v[16:19], v[112:115], v[148:151], v[16:19]
    ds_read_b128 v[88:91], v78 offset:2048
    v_mfma_f32_16x16x32_bf16 v[20:23], v[112:115], v[152:155], v[20:23]
    ds_read_b128 v[92:95], v78 offset:3072
    v_mfma_f32_16x16x32_bf16 v[24:27], v[116:119], v[148:151], v[24:27]
    ds_read_b128 v[96:99], v78 offset:4096
    v_mfma_f32_16x16x32_bf16 v[28:31], v[116:119], v[152:155], v[28:31]
    ds_read_b128 v[100:103], v78 offset:5120
    v_mfma_f32_16x16x32_bf16 v[32:35], v[120:123], v[148:151], v[32:35]
    ds_read_b128 v[104:107], v78 offset:6144
    v_mfma_f32_16x16x32_bf16 v[36:39], v[120:123], v[152:155], v[36:39]
    v_mfma_f32_16x16x32_bf16 v[40:43], v[124:127], v[148:151], v[40:43]
    v_mfma_f32_16x16x32_bf16 v[44:47], v[124:127], v[152:155], v[44:47]
    v_mfma_f32_16x16x32_bf16 v[48:51], v[128:131], v[148:151], v[48:51]
    v_mfma_f32_16x16x32_bf16 v[52:55], v[128:131], v[152:155], v[52:55]
    v_mfma_f32_16x16x32_bf16 v[56:59], v[132:135], v[148:151], v[56:59]
    v_mfma_f32_16x16x32_bf16 v[60:63], v[132:135], v[152:155], v[60:63]
    buffer_load_dwordx4 v[148:151], v3, s[28:31], s52 offen offset:1024 sc1
    buffer_load_dwordx4 v[152:155], v3, s[28:31], s53 offen offset:1024 sc1
    v_mul_f32 v241, 0x3acccccd, v241
    v_fma_f32 v241, -v240, v240, v241
    v_max_f32 v241, 0, v241
    v_add_f32 v241, 0x3727c5ac, v241
    v_rsq_f32 v242, v241
    s_nop 0
    s_waitcnt vmcnt(14) lgkmcnt(0)
    v_mfma_f32_16x16x32_bf16 v[8:11], v[80:83], v[156:159], v[8:11]
    ds_read_b128 v[108:111], v79 offset:0
    v_mfma_f32_16x16x32_bf16 v[12:15], v[80:83], v[160:163], v[12:15]
    ds_read_b128 v[112:115], v79 offset:1024
    v_mfma_f32_16x16x32_bf16 v[16:19], v[84:87], v[156:159], v[16:19]
    ds_read_b128 v[116:119], v79 offset:2048
    v_mfma_f32_16x16x32_bf16 v[20:23], v[84:87], v[160:163], v[20:23]
    ds_read_b128 v[120:123], v79 offset:3072
    v_mfma_f32_16x16x32_bf16 v[24:27], v[88:91], v[156:159], v[24:27]
    ds_read_b128 v[124:127], v79 offset:4096
    v_mfma_f32_16x16x32_bf16 v[28:31], v[88:91], v[160:163], v[28:31]
    ds_read_b128 v[128:131], v79 offset:5120
    v_mfma_f32_16x16x32_bf16 v[32:35], v[92:95], v[156:159], v[32:35]
    ds_read_b128 v[132:135], v79 offset:6144
    v_mfma_f32_16x16x32_bf16 v[36:39], v[92:95], v[160:163], v[36:39]
    v_mfma_f32_16x16x32_bf16 v[40:43], v[96:99], v[156:159], v[40:43]
    v_mfma_f32_16x16x32_bf16 v[44:47], v[96:99], v[160:163], v[44:47]
    v_mfma_f32_16x16x32_bf16 v[48:51], v[100:103], v[156:159], v[48:51]
    v_mfma_f32_16x16x32_bf16 v[52:55], v[100:103], v[160:163], v[52:55]
    v_mfma_f32_16x16x32_bf16 v[56:59], v[104:107], v[156:159], v[56:59]
    v_mfma_f32_16x16x32_bf16 v[60:63], v[104:107], v[160:163], v[60:63]
    buffer_load_dwordx4 v[156:159], v3, s[28:31], s52 offen offset:2048 sc1
    buffer_load_dwordx4 v[160:163], v3, s[28:31], s53 offen offset:2048 sc1
    v_mul_f32 v246, 0xbfb8aa3b, v242
    v_mul_f32 v242, v241, v242
    v_lshlrev_b32 v249, 4, v7
    v_add_u32 v249, 162944, v249
    s_waitcnt vmcnt(14) lgkmcnt(0)
    s_barrier
    v_mfma_f32_16x16x32_bf16 v[8:11], v[108:111], v[164:167], v[8:11]
    ds_read_b128 v[80:83], v76 offset:7168
    v_mfma_f32_16x16x32_bf16 v[12:15], v[108:111], v[168:171], v[12:15]
    ds_read_b128 v[84:87], v76 offset:8192
    v_mfma_f32_16x16x32_bf16 v[16:19], v[112:115], v[164:167], v[16:19]
    ds_read_b128 v[88:91], v76 offset:9216
    v_mfma_f32_16x16x32_bf16 v[20:23], v[112:115], v[168:171], v[20:23]
    ds_read_b128 v[92:95], v76 offset:10240
    v_mfma_f32_16x16x32_bf16 v[24:27], v[116:119], v[164:167], v[24:27]
    ds_read_b128 v[96:99], v76 offset:11264
    v_mfma_f32_16x16x32_bf16 v[28:31], v[116:119], v[168:171], v[28:31]
    ds_read_b128 v[100:103], v76 offset:12288
    v_mfma_f32_16x16x32_bf16 v[32:35], v[120:123], v[164:167], v[32:35]
    ds_read_b128 v[104:107], v76 offset:13312
    v_mfma_f32_16x16x32_bf16 v[36:39], v[120:123], v[168:171], v[36:39]
    v_mfma_f32_16x16x32_bf16 v[40:43], v[124:127], v[164:167], v[40:43]
    v_mfma_f32_16x16x32_bf16 v[44:47], v[124:127], v[168:171], v[44:47]
    v_mfma_f32_16x16x32_bf16 v[48:51], v[128:131], v[164:167], v[48:51]
    v_mfma_f32_16x16x32_bf16 v[52:55], v[128:131], v[168:171], v[52:55]
    v_mfma_f32_16x16x32_bf16 v[56:59], v[132:135], v[164:167], v[56:59]
    v_mfma_f32_16x16x32_bf16 v[60:63], v[132:135], v[168:171], v[60:63]
    buffer_load_dwordx4 v[164:167], v3, s[28:31], s52 offen offset:3072 sc1
    buffer_load_dwordx4 v[168:171], v3, s[28:31], s53 offen offset:3072 sc1
    s_waitcnt vmcnt(14) lgkmcnt(0)
    v_mfma_f32_16x16x32_bf16 v[8:11], v[80:83], v[172:175], v[8:11]
    ds_read_b128 v[108:111], v77 offset:7168
    v_mfma_f32_16x16x32_bf16 v[12:15], v[80:83], v[176:179], v[12:15]
    ds_read_b128 v[112:115], v77 offset:8192
    v_mfma_f32_16x16x32_bf16 v[16:19], v[84:87], v[172:175], v[16:19]
    ds_read_b128 v[116:119], v77 offset:9216
    v_mfma_f32_16x16x32_bf16 v[20:23], v[84:87], v[176:179], v[20:23]
    ds_read_b128 v[120:123], v77 offset:10240
    v_mfma_f32_16x16x32_bf16 v[24:27], v[88:91], v[172:175], v[24:27]
    ds_read_b128 v[124:127], v77 offset:11264
    v_mfma_f32_16x16x32_bf16 v[28:31], v[88:91], v[176:179], v[28:31]
    ds_read_b128 v[128:131], v77 offset:12288
    v_mfma_f32_16x16x32_bf16 v[32:35], v[92:95], v[172:175], v[32:35]
    ds_read_b128 v[132:135], v77 offset:13312
    v_mfma_f32_16x16x32_bf16 v[36:39], v[92:95], v[176:179], v[36:39]
    v_mfma_f32_16x16x32_bf16 v[40:43], v[96:99], v[172:175], v[40:43]
    v_mfma_f32_16x16x32_bf16 v[44:47], v[96:99], v[176:179], v[44:47]
    v_mfma_f32_16x16x32_bf16 v[48:51], v[100:103], v[172:175], v[48:51]
    v_mfma_f32_16x16x32_bf16 v[52:55], v[100:103], v[176:179], v[52:55]
    v_mfma_f32_16x16x32_bf16 v[56:59], v[104:107], v[172:175], v[56:59]
    v_mfma_f32_16x16x32_bf16 v[60:63], v[104:107], v[176:179], v[60:63]
    s_waitcnt vmcnt(12) lgkmcnt(0)
    v_mfma_f32_16x16x32_bf16 v[8:11], v[108:111], v[180:183], v[8:11]
    ds_read_b128 v[80:83], v78 offset:7168
    v_mfma_f32_16x16x32_bf16 v[12:15], v[108:111], v[184:187], v[12:15]
    ds_read_b128 v[84:87], v78 offset:8192
    v_mfma_f32_16x16x32_bf16 v[16:19], v[112:115], v[180:183], v[16:19]
    ds_read_b128 v[88:91], v78 offset:9216
    v_mfma_f32_16x16x32_bf16 v[20:23], v[112:115], v[184:187], v[20:23]
    ds_read_b128 v[92:95], v78 offset:10240
    v_mfma_f32_16x16x32_bf16 v[24:27], v[116:119], v[180:183], v[24:27]
    ds_read_b128 v[96:99], v78 offset:11264
    v_mfma_f32_16x16x32_bf16 v[28:31], v[116:119], v[184:187], v[28:31]
    ds_read_b128 v[100:103], v78 offset:12288
    v_mfma_f32_16x16x32_bf16 v[32:35], v[120:123], v[180:183], v[32:35]
    ds_read_b128 v[104:107], v78 offset:13312
    v_mfma_f32_16x16x32_bf16 v[36:39], v[120:123], v[184:187], v[36:39]
    v_mfma_f32_16x16x32_bf16 v[40:43], v[124:127], v[180:183], v[40:43]
    v_mfma_f32_16x16x32_bf16 v[44:47], v[124:127], v[184:187], v[44:47]
    v_mfma_f32_16x16x32_bf16 v[48:51], v[128:131], v[180:183], v[48:51]
    v_mfma_f32_16x16x32_bf16 v[52:55], v[128:131], v[184:187], v[52:55]
    v_mfma_f32_16x16x32_bf16 v[56:59], v[132:135], v[180:183], v[56:59]
    v_mfma_f32_16x16x32_bf16 v[60:63], v[132:135], v[184:187], v[60:63]
    s_waitcnt vmcnt(10) lgkmcnt(0)
    v_mfma_f32_16x16x32_bf16 v[8:11], v[80:83], v[188:191], v[8:11]
    ds_read_b128 v[108:111], v79 offset:7168
    v_mfma_f32_16x16x32_bf16 v[12:15], v[80:83], v[192:195], v[12:15]
    ds_read_b128 v[112:115], v79 offset:8192
    v_mfma_f32_16x16x32_bf16 v[16:19], v[84:87], v[188:191], v[16:19]
    ds_read_b128 v[116:119], v79 offset:9216
    v_mfma_f32_16x16x32_bf16 v[20:23], v[84:87], v[192:195], v[20:23]
    ds_read_b128 v[120:123], v79 offset:10240
    v_mfma_f32_16x16x32_bf16 v[24:27], v[88:91], v[188:191], v[24:27]
    ds_read_b128 v[124:127], v79 offset:11264
    v_mfma_f32_16x16x32_bf16 v[28:31], v[88:91], v[192:195], v[28:31]
    ds_read_b128 v[128:131], v79 offset:12288
    v_mfma_f32_16x16x32_bf16 v[32:35], v[92:95], v[188:191], v[32:35]
    ds_read_b128 v[132:135], v79 offset:13312
    v_mfma_f32_16x16x32_bf16 v[36:39], v[92:95], v[192:195], v[36:39]
    v_mfma_f32_16x16x32_bf16 v[40:43], v[96:99], v[188:191], v[40:43]
    v_mfma_f32_16x16x32_bf16 v[44:47], v[96:99], v[192:195], v[44:47]
    v_mfma_f32_16x16x32_bf16 v[48:51], v[100:103], v[188:191], v[48:51]
    v_mfma_f32_16x16x32_bf16 v[52:55], v[100:103], v[192:195], v[52:55]
    v_mfma_f32_16x16x32_bf16 v[56:59], v[104:107], v[188:191], v[56:59]
    v_mfma_f32_16x16x32_bf16 v[60:63], v[104:107], v[192:195], v[60:63]
    s_waitcnt vmcnt(8) lgkmcnt(0)
    s_barrier
    v_mfma_f32_16x16x32_bf16 v[8:11], v[108:111], v[196:199], v[8:11]
    ds_read_b128 v[80:83], v76 offset:14336
    v_mfma_f32_16x16x32_bf16 v[12:15], v[108:111], v[200:203], v[12:15]
    ds_read_b128 v[84:87], v76 offset:15360
    v_mfma_f32_16x16x32_bf16 v[16:19], v[112:115], v[196:199], v[16:19]
    ds_read_b128 v[88:91], v76 offset:16384
    v_mfma_f32_16x16x32_bf16 v[20:23], v[112:115], v[200:203], v[20:23]
    ds_read_b128 v[92:95], v76 offset:17408
    v_mfma_f32_16x16x32_bf16 v[24:27], v[116:119], v[196:199], v[24:27]
    ds_read_b128 v[96:99], v76 offset:18432
    v_mfma_f32_16x16x32_bf16 v[28:31], v[116:119], v[200:203], v[28:31]
    ds_read_b128 v[100:103], v76 offset:19456
    v_mfma_f32_16x16x32_bf16 v[32:35], v[120:123], v[196:199], v[32:35]
    ds_read_b128 v[104:107], v76 offset:20480
    v_mfma_f32_16x16x32_bf16 v[36:39], v[120:123], v[200:203], v[36:39]
    v_mfma_f32_16x16x32_bf16 v[40:43], v[124:127], v[196:199], v[40:43]
    v_mfma_f32_16x16x32_bf16 v[44:47], v[124:127], v[200:203], v[44:47]
    v_mfma_f32_16x16x32_bf16 v[48:51], v[128:131], v[196:199], v[48:51]
    v_mfma_f32_16x16x32_bf16 v[52:55], v[128:131], v[200:203], v[52:55]
    v_mfma_f32_16x16x32_bf16 v[56:59], v[132:135], v[196:199], v[56:59]
    v_mfma_f32_16x16x32_bf16 v[60:63], v[132:135], v[200:203], v[60:63]
    s_waitcnt vmcnt(6) lgkmcnt(0)
    v_mfma_f32_16x16x32_bf16 v[8:11], v[80:83], v[140:143], v[8:11]
    ds_read_b128 v[108:111], v77 offset:14336
    v_mfma_f32_16x16x32_bf16 v[12:15], v[80:83], v[144:147], v[12:15]
    ds_read_b128 v[112:115], v77 offset:15360
    v_mfma_f32_16x16x32_bf16 v[16:19], v[84:87], v[140:143], v[16:19]
    ds_read_b128 v[116:119], v77 offset:16384
    v_mfma_f32_16x16x32_bf16 v[20:23], v[84:87], v[144:147], v[20:23]
    ds_read_b128 v[120:123], v77 offset:17408
    v_mfma_f32_16x16x32_bf16 v[24:27], v[88:91], v[140:143], v[24:27]
    ds_read_b128 v[124:127], v77 offset:18432
    v_mfma_f32_16x16x32_bf16 v[28:31], v[88:91], v[144:147], v[28:31]
    ds_read_b128 v[128:131], v77 offset:19456
    v_mfma_f32_16x16x32_bf16 v[32:35], v[92:95], v[140:143], v[32:35]
    ds_read_b128 v[132:135], v77 offset:20480
    v_mfma_f32_16x16x32_bf16 v[36:39], v[92:95], v[144:147], v[36:39]
    v_mfma_f32_16x16x32_bf16 v[40:43], v[96:99], v[140:143], v[40:43]
    v_mfma_f32_16x16x32_bf16 v[44:47], v[96:99], v[144:147], v[44:47]
    v_mfma_f32_16x16x32_bf16 v[48:51], v[100:103], v[140:143], v[48:51]
    v_mfma_f32_16x16x32_bf16 v[52:55], v[100:103], v[144:147], v[52:55]
    v_mfma_f32_16x16x32_bf16 v[56:59], v[104:107], v[140:143], v[56:59]
    v_mfma_f32_16x16x32_bf16 v[60:63], v[104:107], v[144:147], v[60:63]
    s_waitcnt vmcnt(4) lgkmcnt(0)
    v_mfma_f32_16x16x32_bf16 v[8:11], v[108:111], v[148:151], v[8:11]
    ds_read_b128 v[80:83], v78 offset:14336
    v_mfma_f32_16x16x32_bf16 v[12:15], v[108:111], v[152:155], v[12:15]
    ds_read_b128 v[84:87], v78 offset:15360
    v_mfma_f32_16x16x32_bf16 v[16:19], v[112:115], v[148:151], v[16:19]
    ds_read_b128 v[88:91], v78 offset:16384
    v_mfma_f32_16x16x32_bf16 v[20:23], v[112:115], v[152:155], v[20:23]
    ds_read_b128 v[92:95], v78 offset:17408
    v_mfma_f32_16x16x32_bf16 v[24:27], v[116:119], v[148:151], v[24:27]
    ds_read_b128 v[96:99], v78 offset:18432
    v_mfma_f32_16x16x32_bf16 v[28:31], v[116:119], v[152:155], v[28:31]
    ds_read_b128 v[100:103], v78 offset:19456
    v_mfma_f32_16x16x32_bf16 v[32:35], v[120:123], v[148:151], v[32:35]
    ds_read_b128 v[104:107], v78 offset:20480
    v_mfma_f32_16x16x32_bf16 v[36:39], v[120:123], v[152:155], v[36:39]
    v_mfma_f32_16x16x32_bf16 v[40:43], v[124:127], v[148:151], v[40:43]
    v_mfma_f32_16x16x32_bf16 v[44:47], v[124:127], v[152:155], v[44:47]
    v_mfma_f32_16x16x32_bf16 v[48:51], v[128:131], v[148:151], v[48:51]
    v_mfma_f32_16x16x32_bf16 v[52:55], v[128:131], v[152:155], v[52:55]
    v_mfma_f32_16x16x32_bf16 v[56:59], v[132:135], v[148:151], v[56:59]
    v_mfma_f32_16x16x32_bf16 v[60:63], v[132:135], v[152:155], v[60:63]
    s_waitcnt vmcnt(2) lgkmcnt(0)
    v_mfma_f32_16x16x32_bf16 v[8:11], v[80:83], v[156:159], v[8:11]
    ds_read_b128 v[108:111], v79 offset:14336
    v_mfma_f32_16x16x32_bf16 v[12:15], v[80:83], v[160:163], v[12:15]
    ds_read_b128 v[112:115], v79 offset:15360
    v_mfma_f32_16x16x32_bf16 v[16:19], v[84:87], v[156:159], v[16:19]
    ds_read_b128 v[116:119], v79 offset:16384
    v_mfma_f32_16x16x32_bf16 v[20:23], v[84:87], v[160:163], v[20:23]
    ds_read_b128 v[120:123], v79 offset:17408
    v_mfma_f32_16x16x32_bf16 v[24:27], v[88:91], v[156:159], v[24:27]
    ds_read_b128 v[124:127], v79 offset:18432
    v_mfma_f32_16x16x32_bf16 v[28:31], v[88:91], v[160:163], v[28:31]
    ds_read_b128 v[128:131], v79 offset:19456
    v_mfma_f32_16x16x32_bf16 v[32:35], v[92:95], v[156:159], v[32:35]
    ds_read_b128 v[132:135], v79 offset:20480
    v_mfma_f32_16x16x32_bf16 v[36:39], v[92:95], v[160:163], v[36:39]
    v_mfma_f32_16x16x32_bf16 v[40:43], v[96:99], v[156:159], v[40:43]
    v_mfma_f32_16x16x32_bf16 v[44:47], v[96:99], v[160:163], v[44:47]
    v_mfma_f32_16x16x32_bf16 v[48:51], v[100:103], v[156:159], v[48:51]
    v_mfma_f32_16x16x32_bf16 v[52:55], v[100:103], v[160:163], v[52:55]
    v_mfma_f32_16x16x32_bf16 v[56:59], v[104:107], v[156:159], v[56:59]
    v_mfma_f32_16x16x32_bf16 v[60:63], v[104:107], v[160:163], v[60:63]
    s_waitcnt vmcnt(0) lgkmcnt(0)
    v_mfma_f32_16x16x32_bf16 v[8:11], v[108:111], v[164:167], v[8:11]
    v_mfma_f32_16x16x32_bf16 v[12:15], v[108:111], v[168:171], v[12:15]
    v_mfma_f32_16x16x32_bf16 v[16:19], v[112:115], v[164:167], v[16:19]
    v_mfma_f32_16x16x32_bf16 v[20:23], v[112:115], v[168:171], v[20:23]
    v_mfma_f32_16x16x32_bf16 v[24:27], v[116:119], v[164:167], v[24:27]
    v_mfma_f32_16x16x32_bf16 v[28:31], v[116:119], v[168:171], v[28:31]
    v_mfma_f32_16x16x32_bf16 v[32:35], v[120:123], v[164:167], v[32:35]
    v_mfma_f32_16x16x32_bf16 v[36:39], v[120:123], v[168:171], v[36:39]
    v_mfma_f32_16x16x32_bf16 v[40:43], v[124:127], v[164:167], v[40:43]
    v_mfma_f32_16x16x32_bf16 v[44:47], v[124:127], v[168:171], v[44:47]
    v_mfma_f32_16x16x32_bf16 v[48:51], v[128:131], v[164:167], v[48:51]
    v_mfma_f32_16x16x32_bf16 v[52:55], v[128:131], v[168:171], v[52:55]
    v_mfma_f32_16x16x32_bf16 v[56:59], v[132:135], v[164:167], v[56:59]
    v_mfma_f32_16x16x32_bf16 v[60:63], v[132:135], v[168:171], v[60:63]
    s_barrier
    ds_read_b128 v[80:83], v249 offset:0
    ds_read_b128 v[84:87], v249 offset:64
    ds_read_b128 v[88:91], v249 offset:128
    ds_read_b128 v[92:95], v249 offset:192
    ds_read_b128 v[96:99], v249 offset:256
    ds_read_b128 v[100:103], v249 offset:320
    ds_read_b128 v[104:107], v249 offset:384
    s_waitcnt lgkmcnt(0)
    v_pk_fma_f32 v[8:9], v[80:81], v[236:237], v[8:9] op_sel_hi:[1,0,1]
    v_pk_fma_f32 v[10:11], v[82:83], v[236:237], v[10:11] op_sel_hi:[1,0,1]
    v_pk_fma_f32 v[16:17], v[84:85], v[236:237], v[16:17] op_sel_hi:[1,0,1]
    v_pk_fma_f32 v[18:19], v[86:87], v[236:237], v[18:19] op_sel_hi:[1,0,1]
    v_pk_fma_f32 v[12:13], v[80:81], v[240:241], v[12:13] op_sel_hi:[1,0,1]
    v_pk_fma_f32 v[14:15], v[82:83], v[240:241], v[14:15] op_sel_hi:[1,0,1]
    v_pk_fma_f32 v[20:21], v[84:85], v[240:241], v[20:21] op_sel_hi:[1,0,1]
    v_pk_fma_f32 v[22:23], v[86:87], v[240:241], v[22:23] op_sel_hi:[1,0,1]
    v_pk_mul_f32 v[140:141], v[8:9], v[244:245] op_sel_hi:[1,0]
    v_pk_mul_f32 v[142:143], v[10:11], v[244:245] op_sel_hi:[1,0]
    v_pk_mul_f32 v[144:145], v[16:17], v[244:245] op_sel_hi:[1,0]
    v_pk_mul_f32 v[146:147], v[18:19], v[244:245] op_sel_hi:[1,0]
    v_pk_mul_f32 v[148:149], v[12:13], v[246:247] op_sel_hi:[1,0]
    v_pk_mul_f32 v[150:151], v[14:15], v[246:247] op_sel_hi:[1,0]
    v_pk_mul_f32 v[152:153], v[20:21], v[246:247] op_sel_hi:[1,0]
    v_pk_mul_f32 v[154:155], v[22:23], v[246:247] op_sel_hi:[1,0]
    v_exp_f32 v140, v140
    v_exp_f32 v141, v141
    v_exp_f32 v142, v142
    v_exp_f32 v143, v143
    v_exp_f32 v144, v144
    v_exp_f32 v145, v145
    v_exp_f32 v146, v146
    v_exp_f32 v147, v147
    v_exp_f32 v148, v148
    v_exp_f32 v149, v149
    v_exp_f32 v150, v150
    v_exp_f32 v151, v151
    v_exp_f32 v152, v152
    v_exp_f32 v153, v153
    v_exp_f32 v154, v154
    v_exp_f32 v155, v155
    v_pk_fma_f32 v[140:141], v[140:141], v[238:239], v[238:239] op_sel_hi:[1,0,0]
    v_pk_fma_f32 v[142:143], v[142:143], v[238:239], v[238:239] op_sel_hi:[1,0,0]
    v_pk_fma_f32 v[144:145], v[144:145], v[238:239], v[238:239] op_sel_hi:[1,0,0]
    v_pk_fma_f32 v[146:147], v[146:147], v[238:239], v[238:239] op_sel_hi:[1,0,0]
    v_pk_fma_f32 v[148:149], v[148:149], v[242:243], v[242:243] op_sel_hi:[1,0,0]
    v_pk_fma_f32 v[150:151], v[150:151], v[242:243], v[242:243] op_sel_hi:[1,0,0]
    v_pk_fma_f32 v[152:153], v[152:153], v[242:243], v[242:243] op_sel_hi:[1,0,0]
    v_pk_fma_f32 v[154:155], v[154:155], v[242:243], v[242:243] op_sel_hi:[1,0,0]
    v_rcp_f32 v140, v140
    v_rcp_f32 v141, v141
    v_rcp_f32 v142, v142
    v_rcp_f32 v143, v143
    v_rcp_f32 v144, v144
    v_rcp_f32 v145, v145
    v_rcp_f32 v146, v146
    v_rcp_f32 v147, v147
    v_rcp_f32 v148, v148
    v_rcp_f32 v149, v149
    v_rcp_f32 v150, v150
    v_rcp_f32 v151, v151
    v_rcp_f32 v152, v152
    v_rcp_f32 v153, v153
    v_rcp_f32 v154, v154
    v_rcp_f32 v155, v155
    v_pk_mul_f32 v[8:9], v[8:9], v[140:141]
    v_pk_mul_f32 v[10:11], v[10:11], v[142:143]
    v_pk_mul_f32 v[16:17], v[16:17], v[144:145]
    v_pk_mul_f32 v[18:19], v[18:19], v[146:147]
    v_pk_mul_f32 v[12:13], v[12:13], v[148:149]
    v_pk_mul_f32 v[14:15], v[14:15], v[150:151]
    v_pk_mul_f32 v[20:21], v[20:21], v[152:153]
    v_pk_mul_f32 v[22:23], v[22:23], v[154:155]
    v_cvt_pk_bf16_f32 v156, v8, v9
    v_cvt_pk_bf16_f32 v157, v10, v11
    v_cvt_pk_bf16_f32 v158, v16, v17
    v_cvt_pk_bf16_f32 v159, v18, v19
    v_cvt_pk_bf16_f32 v160, v12, v13
    v_cvt_pk_bf16_f32 v161, v14, v15
    v_cvt_pk_bf16_f32 v162, v20, v21
    v_cvt_pk_bf16_f32 v163, v22, v23
    buffer_store_dwordx4 v[156:159], v3, s[80:83], s67 offen
    buffer_store_dwordx4 v[160:163], v250, s[80:83], s67 offen
    v_pk_fma_f32 v[24:25], v[88:89], v[236:237], v[24:25] op_sel_hi:[1,0,1]
    v_pk_fma_f32 v[26:27], v[90:91], v[236:237], v[26:27] op_sel_hi:[1,0,1]
    v_pk_fma_f32 v[32:33], v[92:93], v[236:237], v[32:33] op_sel_hi:[1,0,1]
    v_pk_fma_f32 v[34:35], v[94:95], v[236:237], v[34:35] op_sel_hi:[1,0,1]
    v_pk_fma_f32 v[28:29], v[88:89], v[240:241], v[28:29] op_sel_hi:[1,0,1]
    v_pk_fma_f32 v[30:31], v[90:91], v[240:241], v[30:31] op_sel_hi:[1,0,1]
    v_pk_fma_f32 v[36:37], v[92:93], v[240:241], v[36:37] op_sel_hi:[1,0,1]
    v_pk_fma_f32 v[38:39], v[94:95], v[240:241], v[38:39] op_sel_hi:[1,0,1]
    v_pk_mul_f32 v[140:141], v[24:25], v[244:245] op_sel_hi:[1,0]
    v_pk_mul_f32 v[142:143], v[26:27], v[244:245] op_sel_hi:[1,0]
    v_pk_mul_f32 v[144:145], v[32:33], v[244:245] op_sel_hi:[1,0]
    v_pk_mul_f32 v[146:147], v[34:35], v[244:245] op_sel_hi:[1,0]
    v_pk_mul_f32 v[148:149], v[28:29], v[246:247] op_sel_hi:[1,0]
    v_pk_mul_f32 v[150:151], v[30:31], v[246:247] op_sel_hi:[1,0]
    v_pk_mul_f32 v[152:153], v[36:37], v[246:247] op_sel_hi:[1,0]
    v_pk_mul_f32 v[154:155], v[38:39], v[246:247] op_sel_hi:[1,0]
    v_exp_f32 v140, v140
    v_exp_f32 v141, v141
    v_exp_f32 v142, v142
    v_exp_f32 v143, v143
    v_exp_f32 v144, v144
    v_exp_f32 v145, v145
    v_exp_f32 v146, v146
    v_exp_f32 v147, v147
    v_exp_f32 v148, v148
    v_exp_f32 v149, v149
    v_exp_f32 v150, v150
    v_exp_f32 v151, v151
    v_exp_f32 v152, v152
    v_exp_f32 v153, v153
    v_exp_f32 v154, v154
    v_exp_f32 v155, v155
    v_pk_fma_f32 v[140:141], v[140:141], v[238:239], v[238:239] op_sel_hi:[1,0,0]
    v_pk_fma_f32 v[142:143], v[142:143], v[238:239], v[238:239] op_sel_hi:[1,0,0]
    v_pk_fma_f32 v[144:145], v[144:145], v[238:239], v[238:239] op_sel_hi:[1,0,0]
    v_pk_fma_f32 v[146:147], v[146:147], v[238:239], v[238:239] op_sel_hi:[1,0,0]
    v_pk_fma_f32 v[148:149], v[148:149], v[242:243], v[242:243] op_sel_hi:[1,0,0]
    v_pk_fma_f32 v[150:151], v[150:151], v[242:243], v[242:243] op_sel_hi:[1,0,0]
    v_pk_fma_f32 v[152:153], v[152:153], v[242:243], v[242:243] op_sel_hi:[1,0,0]
    v_pk_fma_f32 v[154:155], v[154:155], v[242:243], v[242:243] op_sel_hi:[1,0,0]
    v_rcp_f32 v140, v140
    v_rcp_f32 v141, v141
    v_rcp_f32 v142, v142
    v_rcp_f32 v143, v143
    v_rcp_f32 v144, v144
    v_rcp_f32 v145, v145
    v_rcp_f32 v146, v146
    v_rcp_f32 v147, v147
    v_rcp_f32 v148, v148
    v_rcp_f32 v149, v149
    v_rcp_f32 v150, v150
    v_rcp_f32 v151, v151
    v_rcp_f32 v152, v152
    v_rcp_f32 v153, v153
    v_rcp_f32 v154, v154
    v_rcp_f32 v155, v155
    v_pk_mul_f32 v[24:25], v[24:25], v[140:141]
    v_pk_mul_f32 v[26:27], v[26:27], v[142:143]
    v_pk_mul_f32 v[32:33], v[32:33], v[144:145]
    v_pk_mul_f32 v[34:35], v[34:35], v[146:147]
    v_pk_mul_f32 v[28:29], v[28:29], v[148:149]
    v_pk_mul_f32 v[30:31], v[30:31], v[150:151]
    v_pk_mul_f32 v[36:37], v[36:37], v[152:153]
    v_pk_mul_f32 v[38:39], v[38:39], v[154:155]
    v_cvt_pk_bf16_f32 v164, v24, v25
    v_cvt_pk_bf16_f32 v165, v26, v27
    v_cvt_pk_bf16_f32 v166, v32, v33
    v_cvt_pk_bf16_f32 v167, v34, v35
    v_cvt_pk_bf16_f32 v168, v28, v29
    v_cvt_pk_bf16_f32 v169, v30, v31
    v_cvt_pk_bf16_f32 v170, v36, v37
    v_cvt_pk_bf16_f32 v171, v38, v39
    buffer_store_dwordx4 v[164:167], v3, s[80:83], s68 offen
    buffer_store_dwordx4 v[168:171], v250, s[80:83], s68 offen
    v_pk_fma_f32 v[40:41], v[96:97], v[236:237], v[40:41] op_sel_hi:[1,0,1]
    v_pk_fma_f32 v[42:43], v[98:99], v[236:237], v[42:43] op_sel_hi:[1,0,1]
    v_pk_fma_f32 v[48:49], v[100:101], v[236:237], v[48:49] op_sel_hi:[1,0,1]
    v_pk_fma_f32 v[50:51], v[102:103], v[236:237], v[50:51] op_sel_hi:[1,0,1]
    v_pk_fma_f32 v[44:45], v[96:97], v[240:241], v[44:45] op_sel_hi:[1,0,1]
    v_pk_fma_f32 v[46:47], v[98:99], v[240:241], v[46:47] op_sel_hi:[1,0,1]
    v_pk_fma_f32 v[52:53], v[100:101], v[240:241], v[52:53] op_sel_hi:[1,0,1]
    v_pk_fma_f32 v[54:55], v[102:103], v[240:241], v[54:55] op_sel_hi:[1,0,1]
    v_pk_mul_f32 v[140:141], v[40:41], v[244:245] op_sel_hi:[1,0]
    v_pk_mul_f32 v[142:143], v[42:43], v[244:245] op_sel_hi:[1,0]
    v_pk_mul_f32 v[144:145], v[48:49], v[244:245] op_sel_hi:[1,0]
    v_pk_mul_f32 v[146:147], v[50:51], v[244:245] op_sel_hi:[1,0]
    v_pk_mul_f32 v[148:149], v[44:45], v[246:247] op_sel_hi:[1,0]
    v_pk_mul_f32 v[150:151], v[46:47], v[246:247] op_sel_hi:[1,0]
    v_pk_mul_f32 v[152:153], v[52:53], v[246:247] op_sel_hi:[1,0]
    v_pk_mul_f32 v[154:155], v[54:55], v[246:247] op_sel_hi:[1,0]
    v_exp_f32 v140, v140
    v_exp_f32 v141, v141
    v_exp_f32 v142, v142
    v_exp_f32 v143, v143
    v_exp_f32 v144, v144
    v_exp_f32 v145, v145
    v_exp_f32 v146, v146
    v_exp_f32 v147, v147
    v_exp_f32 v148, v148
    v_exp_f32 v149, v149
    v_exp_f32 v150, v150
    v_exp_f32 v151, v151
    v_exp_f32 v152, v152
    v_exp_f32 v153, v153
    v_exp_f32 v154, v154
    v_exp_f32 v155, v155
    v_pk_fma_f32 v[140:141], v[140:141], v[238:239], v[238:239] op_sel_hi:[1,0,0]
    v_pk_fma_f32 v[142:143], v[142:143], v[238:239], v[238:239] op_sel_hi:[1,0,0]
    v_pk_fma_f32 v[144:145], v[144:145], v[238:239], v[238:239] op_sel_hi:[1,0,0]
    v_pk_fma_f32 v[146:147], v[146:147], v[238:239], v[238:239] op_sel_hi:[1,0,0]
    v_pk_fma_f32 v[148:149], v[148:149], v[242:243], v[242:243] op_sel_hi:[1,0,0]
    v_pk_fma_f32 v[150:151], v[150:151], v[242:243], v[242:243] op_sel_hi:[1,0,0]
    v_pk_fma_f32 v[152:153], v[152:153], v[242:243], v[242:243] op_sel_hi:[1,0,0]
    v_pk_fma_f32 v[154:155], v[154:155], v[242:243], v[242:243] op_sel_hi:[1,0,0]
    v_rcp_f32 v140, v140
    v_rcp_f32 v141, v141
    v_rcp_f32 v142, v142
    v_rcp_f32 v143, v143
    v_rcp_f32 v144, v144
    v_rcp_f32 v145, v145
    v_rcp_f32 v146, v146
    v_rcp_f32 v147, v147
    v_rcp_f32 v148, v148
    v_rcp_f32 v149, v149
    v_rcp_f32 v150, v150
    v_rcp_f32 v151, v151
    v_rcp_f32 v152, v152
    v_rcp_f32 v153, v153
    v_rcp_f32 v154, v154
    v_rcp_f32 v155, v155
    v_pk_mul_f32 v[40:41], v[40:41], v[140:141]
    v_pk_mul_f32 v[42:43], v[42:43], v[142:143]
    v_pk_mul_f32 v[48:49], v[48:49], v[144:145]
    v_pk_mul_f32 v[50:51], v[50:51], v[146:147]
    v_pk_mul_f32 v[44:45], v[44:45], v[148:149]
    v_pk_mul_f32 v[46:47], v[46:47], v[150:151]
    v_pk_mul_f32 v[52:53], v[52:53], v[152:153]
    v_pk_mul_f32 v[54:55], v[54:55], v[154:155]
    v_cvt_pk_bf16_f32 v156, v40, v41
    v_cvt_pk_bf16_f32 v157, v42, v43
    v_cvt_pk_bf16_f32 v158, v48, v49
    v_cvt_pk_bf16_f32 v159, v50, v51
    v_cvt_pk_bf16_f32 v160, v44, v45
    v_cvt_pk_bf16_f32 v161, v46, v47
    v_cvt_pk_bf16_f32 v162, v52, v53
    v_cvt_pk_bf16_f32 v163, v54, v55
    buffer_store_dwordx4 v[156:159], v3, s[80:83], s69 offen
    buffer_store_dwordx4 v[160:163], v250, s[80:83], s69 offen
    s_cmp_ge_u32 s59, 12
    s_cbranch_scc1 L4_no6
    v_pk_fma_f32 v[56:57], v[104:105], v[236:237], v[56:57] op_sel_hi:[1,0,1]
    v_pk_fma_f32 v[58:59], v[106:107], v[236:237], v[58:59] op_sel_hi:[1,0,1]
    v_pk_fma_f32 v[60:61], v[104:105], v[240:241], v[60:61] op_sel_hi:[1,0,1]
    v_pk_fma_f32 v[62:63], v[106:107], v[240:241], v[62:63] op_sel_hi:[1,0,1]
    v_pk_mul_f32 v[140:141], v[56:57], v[244:245] op_sel_hi:[1,0]
    v_pk_mul_f32 v[142:143], v[58:59], v[244:245] op_sel_hi:[1,0]
    v_pk_mul_f32 v[144:145], v[60:61], v[246:247] op_sel_hi:[1,0]
    v_pk_mul_f32 v[146:147], v[62:63], v[246:247] op_sel_hi:[1,0]
    v_exp_f32 v140, v140
    v_exp_f32 v141, v141
    v_exp_f32 v142, v142
    v_exp_f32 v143, v143
    v_exp_f32 v144, v144
    v_exp_f32 v145, v145
    v_exp_f32 v146, v146
    v_exp_f32 v147, v147
    v_pk_fma_f32 v[140:141], v[140:141], v[238:239], v[238:239] op_sel_hi:[1,0,0]
    v_pk_fma_f32 v[142:143], v[142:143], v[238:239], v[238:239] op_sel_hi:[1,0,0]
    v_pk_fma_f32 v[144:145], v[144:145], v[242:243], v[242:243] op_sel_hi:[1,0,0]
    v_pk_fma_f32 v[146:147], v[146:147], v[242:243], v[242:243] op_sel_hi:[1,0,0]
    v_rcp_f32 v140, v140
    v_rcp_f32 v141, v141
    v_rcp_f32 v142, v142
    v_rcp_f32 v143, v143
    v_rcp_f32 v144, v144
    v_rcp_f32 v145, v145
    v_rcp_f32 v146, v146
    v_rcp_f32 v147, v147
    v_pk_mul_f32 v[56:57], v[56:57], v[140:141]
    v_pk_mul_f32 v[58:59], v[58:59], v[142:143]
    v_pk_mul_f32 v[60:61], v[60:61], v[144:145]
    v_pk_mul_f32 v[62:63], v[62:63], v[146:147]
    v_cvt_pk_bf16_f32 v164, v56, v57
    v_cvt_pk_bf16_f32 v165, v58, v59
    v_cvt_pk_bf16_f32 v166, v60, v61
    v_cvt_pk_bf16_f32 v167, v62, v63
    buffer_store_dwordx2 v[164:165], v3, s[80:83], s76 offen
    buffer_store_dwordx2 v[166:167], v250, s[80:83], s76 offen
L4_no6:
    v_mov_b32 v1, 1
    s_mov_b64 exec, 1
    s_cmp_eq_u32 s25, 0
    s_waitcnt vmcnt(0)
    s_cbranch_scc1 Lsg9
    buffer_store_dword v1, off, s[44:47], s78
Lsg9_e:
    s_mov_b64 exec, -1
    s_mul_i32 s56, s48, 20480
    s_mov_b32 s32, s16
    s_mov_b32 s33, s17
    s_mov_b32 s34, 2621440
    s_mov_b32 s35, 0x00020000
    s_add_u32 s28, s10, s56
    s_addc_u32 s29, s11, 0
    s_mov_b32 s30, 7884800
    s_mov_b32 s31, 0x00020000
    s_barrier
    ds_read_b128 v[80:83], v76 offset:21504
    ds_read_b128 v[84:87], v76 offset:22528
    ds_read_b128 v[88:91], v76 offset:23552
    ds_read_b128 v[92:95], v76 offset:24576
    ds_read_b128 v[96:99], v76 offset:25600
    ds_read_b128 v[100:103], v77 offset:21504
    ds_read_b128 v[104:107], v77 offset:22528
    ds_read_b128 v[108:111], v77 offset:23552
    ds_read_b128 v[112:115], v77 offset:24576
    ds_read_b128 v[116:119], v77 offset:25600
    s_add_u32 s55, s50, 32768
    v_lshlrev_b32 v1, 2, v2
    s_mov_b64 s[70:71], 0xffff
    s_mov_b32 s3, 400000
Lp10:
    buffer_load_dword v5, v1, s[44:47], s55 offen sc1
Lp10_c:
    s_waitcnt vmcnt(0)
    v_cmp_eq_u32 vcc, 0, v5
    s_and_b64 s[72:73], vcc, s[70:71]
    s_sub_u32 s3, s3, 1
    s_cselect_b64 s[72:73], 0, s[72:73]
    s_cmp_lg_u64 s[72:73], 0
    s_cbranch_scc1 Lp10
    s_cmp_eq_u32 s25, 0
    s_cbranch_scc1 Laq11
Laq11_e:
    s_mov_b32 s52, 2621440
    buffer_load_dwordx4 v[140:143], v3, s[28:31], s52 offen offset:0 sc1
    buffer_load_dwordx4 v[144:147], v3, s[28:31], s52 offen offset:1024 sc1
    buffer_load_dwordx4 v[148:151], v3, s[28:31], s52 offen offset:2048 sc1
    buffer_load_dwordx4 v[152:155], v3, s[28:31], s52 offen offset:3072 sc1
    s_mov_b32 s52, 2625536
    buffer_load_dwordx4 v[156:159], v3, s[28:31], s52 offen offset:0 sc1
    buffer_load_dwordx4 v[160:163], v3, s[28:31], s52 offen offset:1024 sc1
    buffer_load_dwordx4 v[164:167], v3, s[28:31], s52 offen offset:2048 sc1
    buffer_load_dwordx4 v[168:171], v3, s[28:31], s52 offen offset:3072 sc1
    s_waitcnt vmcnt(7) lgkmcnt(5)
    v_mfma_f32_16x16x32_bf16 v[8:11], v[80:83], v[140:143], 0
    ds_read_b128 v[120:123], v78 offset:21504
    v_mfma_f32_16x16x32_bf16 v[12:15], v[84:87], v[140:143], 0
    ds_read_b128 v[124:127], v78 offset:22528
    v_mfma_f32_16x16x32_bf16 v[16:19], v[88:91], v[140:143], 0
    s_mov_b32 s52, 2629632
    buffer_load_dwordx4 v[172:175], v3, s[28:31], s52 offen offset:0 sc1
    ds_read_b128 v[128:131], v78 offset:23552
    v_mfma_f32_16x16x32_bf16 v[20:23], v[92:95], v[140:143], 0
    ds_read_b128 v[132:135], v78 offset:24576
    v_mfma_f32_16x16x32_bf16 v[24:27], v[96:99], v[140:143], 0
    ds_read_b128 v[136:139], v78 offset:25600
    buffer_load_dwordx4 v[176:179], v3, s[28:31], s52 offen offset:1024 sc1
    s_waitcnt vmcnt(8) lgkmcnt(5)
    v_mfma_f32_16x16x32_bf16 v[8:11], v[100:103], v[144:147], v[8:11]
    ds_read_b128 v[80:83], v79 offset:21504
    v_mfma_f32_16x16x32_bf16 v[12:15], v[104:107], v[144:147], v[12:15]
    ds_read_b128 v[84:87], v79 offset:22528
    v_mfma_f32_16x16x32_bf16 v[16:19], v[108:111], v[144:147], v[16:19]
    buffer_load_dwordx4 v[180:183], v3, s[28:31], s52 offen offset:2048 sc1
    ds_read_b128 v[88:91], v79 offset:23552
    v_mfma_f32_16x16x32_bf16 v[20:23], v[112:115], v[144:147], v[20:23]
    ds_read_b128 v[92:95], v79 offset:24576
    v_mfma_f32_16x16x32_bf16 v[24:27], v[116:119], v[144:147], v[24:27]
    ds_read_b128 v[96:99], v79 offset:25600
    buffer_load_dwordx4 v[184:187], v3, s[28:31], s52 offen offset:3072 sc1
    s_waitcnt vmcnt(9) lgkmcnt(5)
    s_barrier
    v_mfma_f32_16x16x32_bf16 v[8:11], v[120:123], v[148:151], v[8:11]
    ds_read_b128 v[100:103], v76 offset:26624
    v_mfma_f32_16x16x32_bf16 v[12:15], v[124:127], v[148:151], v[12:15]
    ds_read_b128 v[104:107], v76 offset:27648
    v_mfma_f32_16x16x32_bf16 v[16:19], v[128:131], v[148:151], v[16:19]
    s_mov_b32 s52, 2633728
    buffer_load_dwordx4 v[140:143], v3, s[28:31], s52 offen offset:0 sc1
    ds_read_b128 v[108:111], v76 offset:28672
    v_mfma_f32_16x16x32_bf16 v[20:23], v[132:135], v[148:151], v[20:23]
    ds_read_b128 v[112:115], v76 offset:29696
    v_mfma_f32_16x16x32_bf16 v[24:27], v[136:139], v[148:151], v[24:27]
    ds_read_b128 v[116:119], v76 offset:30720
    buffer_load_dwordx4 v[144:147], v3, s[28:31], s52 offen offset:1024 sc1
    s_waitcnt vmcnt(10) lgkmcnt(5)
    v_mfma_f32_16x16x32_bf16 v[8:11], v[80:83], v[152:155], v[8:11]
    ds_read_b128 v[120:123], v77 offset:26624
    v_mfma_f32_16x16x32_bf16 v[12:15], v[84:87], v[152:155], v[12:15]
    ds_read_b128 v[124:127], v77 offset:27648
    v_mfma_f32_16x16x32_bf16 v[16:19], v[88:91], v[152:155], v[16:19]
    buffer_load_dwordx4 v[148:151], v3, s[28:31], s52 offen offset:2048 sc1
    ds_read_b128 v[128:131], v77 offset:28672
    v_mfma_f32_16x16x32_bf16 v[20:23], v[92:95], v[152:155], v[20:23]
    ds_read_b128 v[132:135], v77 offset:29696
    v_mfma_f32_16x16x32_bf16 v[24:27], v[96:99], v[152:155], v[24:27]
    ds_read_b128 v[136:139], v77 offset:30720
    buffer_load_dwordx4 v[152:155], v3, s[28:31], s52 offen offset:3072 sc1
    s_waitcnt vmcnt(11) lgkmcnt(5)
    v_mfma_f32_16x16x32_bf16 v[8:11], v[100:103], v[156:159], v[8:11]
    ds_read_b128 v[80:83], v78 offset:26624
    v_mfma_f32_16x16x32_bf16 v[12:15], v[104:107], v[156:159], v[12:15]
    ds_read_b128 v[84:87], v78 offset:27648
    v_mfma_f32_16x16x32_bf16 v[16:19], v[108:111], v[156:159], v[16:19]
    ds_read_b128 v[88:91], v78 offset:28672
    v_mfma_f32_16x16x32_bf16 v[20:23], v[112:115], v[156:159], v[20:23]
    ds_read_b128 v[92:95], v78 offset:29696
    v_mfma_f32_16x16x32_bf16 v[24:27], v[116:119], v[156:159], v[24:27]
    ds_read_b128 v[96:99], v78 offset:30720
    s_mov_b32 s52, 2637824
    buffer_load_dwordx4 v[156:159], v3, s[28:31], s52 offen offset:0 sc1
    s_waitcnt vmcnt(11) lgkmcnt(5)
    v_mfma_f32_16x16x32_bf16 v[8:11], v[120:123], v[160:163], v[8:11]
    ds_read_b128 v[100:103], v79 offset:26624
    v_mfma_f32_16x16x32_bf16 v[12:15], v[124:127], v[160:163], v[12:15]
    ds_read_b128 v[104:107], v79 offset:27648
    v_mfma_f32_16x16x32_bf16 v[16:19], v[128:131], v[160:163], v[16:19]
    ds_read_b128 v[108:111], v79 offset:28672
    v_mfma_f32_16x16x32_bf16 v[20:23], v[132:135], v[160:163], v[20:23]
    ds_read_b128 v[112:115], v79 offset:29696
    v_mfma_f32_16x16x32_bf16 v[24:27], v[136:139], v[160:163], v[24:27]
    ds_read_b128 v[116:119], v79 offset:30720
    buffer_load_dwordx4 v[160:163], v3, s[28:31], s52 offen offset:1024 sc1
    s_waitcnt vmcnt(11) lgkmcnt(5)
    s_barrier
    v_mfma_f32_16x16x32_bf16 v[8:11], v[80:83], v[164:167], v[8:11]
    ds_read_b128 v[120:123], v76 offset:31744
    v_mfma_f32_16x16x32_bf16 v[12:15], v[84:87], v[164:167], v[12:15]
    ds_read_b128 v[124:127], v76 offset:32768
    v_mfma_f32_16x16x32_bf16 v[16:19], v[88:91], v[164:167], v[16:19]
    ds_read_b128 v[128:131], v76 offset:33792
    v_mfma_f32_16x16x32_bf16 v[20:23], v[92:95], v[164:167], v[20:23]
    ds_read_b128 v[132:135], v76 offset:34816
    v_mfma_f32_16x16x32_bf16 v[24:27], v[96:99], v[164:167], v[24:27]
    ds_read_b128 v[136:139], v76 offset:35840
    buffer_load_dwordx4 v[164:167], v3, s[28:31], s52 offen offset:2048 sc1
    s_waitcnt vmcnt(11) lgkmcnt(5)
    v_mfma_f32_16x16x32_bf16 v[8:11], v[100:103], v[168:171], v[8:11]
    ds_read_b128 v[80:83], v77 offset:31744
    v_mfma_f32_16x16x32_bf16 v[12:15], v[104:107], v[168:171], v[12:15]
    ds_read_b128 v[84:87], v77 offset:32768
    v_mfma_f32_16x16x32_bf16 v[16:19], v[108:111], v[168:171], v[16:19]
    ds_read_b128 v[88:91], v77 offset:33792
    v_mfma_f32_16x16x32_bf16 v[20:23], v[112:115], v[168:171], v[20:23]
    ds_read_b128 v[92:95], v77 offset:34816
    v_mfma_f32_16x16x32_bf16 v[24:27], v[116:119], v[168:171], v[24:27]
    ds_read_b128 v[96:99], v77 offset:35840
    buffer_load_dwordx4 v[168:171], v3, s[28:31], s52 offen offset:3072 sc1
    s_waitcnt vmcnt(11) lgkmcnt(5)
    v_mfma_f32_16x16x32_bf16 v[8:11], v[120:123], v[172:175], v[8:11]
    ds_read_b128 v[100:103], v78 offset:31744
    v_mfma_f32_16x16x32_bf16 v[12:15], v[124:127], v[172:175], v[12:15]
    ds_read_b128 v[104:107], v78 offset:32768
    v_mfma_f32_16x16x32_bf16 v[16:19], v[128:131], v[172:175], v[16:19]
    ds_read_b128 v[108:111], v78 offset:33792
    v_mfma_f32_16x16x32_bf16 v[20:23], v[132:135], v[172:175], v[20:23]
    ds_read_b128 v[112:115], v78 offset:34816
    v_mfma_f32_16x16x32_bf16 v[24:27], v[136:139], v[172:175], v[24:27]
    ds_read_b128 v[116:119], v78 offset:35840
    s_mov_b32 s52, 7864320
    buffer_load_dwordx4 v[172:175], v3, s[28:31], s52 offen offset:0 sc1
    s_waitcnt vmcnt(11) lgkmcnt(5)
    v_mfma_f32_16x16x32_bf16 v[8:11], v[80:83], v[176:179], v[8:11]
    ds_read_b128 v[120:123], v79 offset:31744
    v_mfma_f32_16x16x32_bf16 v[12:15], v[84:87], v[176:179], v[12:15]
    ds_read_b128 v[124:127], v79 offset:32768
    v_mfma_f32_16x16x32_bf16 v[16:19], v[88:91], v[176:179], v[16:19]
    ds_read_b128 v[128:131], v79 offset:33792
    v_mfma_f32_16x16x32_bf16 v[20:23], v[92:95], v[176:179], v[20:23]
    ds_read_b128 v[132:135], v79 offset:34816
    v_mfma_f32_16x16x32_bf16 v[24:27], v[96:99], v[176:179], v[24:27]
    ds_read_b128 v[136:139], v79 offset:35840
    buffer_load_dwordx4 v[176:179], v3, s[28:31], s52 offen offset:1024 sc1
    s_waitcnt vmcnt(11) lgkmcnt(5)
    s_barrier
    v_mfma_f32_16x16x32_bf16 v[8:11], v[100:103], v[180:183], v[8:11]
    ds_read_b128 v[80:83], v76 offset:0
    v_mfma_f32_16x16x32_bf16 v[12:15], v[104:107], v[180:183], v[12:15]
    ds_read_b128 v[84:87], v76 offset:1024
    v_mfma_f32_16x16x32_bf16 v[16:19], v[108:111], v[180:183], v[16:19]
    ds_read_b128 v[88:91], v76 offset:2048
    v_mfma_f32_16x16x32_bf16 v[20:23], v[112:115], v[180:183], v[20:23]
    ds_read_b128 v[92:95], v76 offset:3072
    v_mfma_f32_16x16x32_bf16 v[24:27], v[116:119], v[180:183], v[24:27]
    ds_read_b128 v[96:99], v76 offset:4096
    buffer_load_dwordx4 v[180:183], v3, s[28:31], s52 offen offset:2048 sc1
    s_waitcnt vmcnt(11) lgkmcnt(5)
    v_mfma_f32_16x16x32_bf16 v[8:11], v[120:123], v[184:187], v[8:11]
    ds_read_b128 v[100:103], v77 offset:0
    v_mfma_f32_16x16x32_bf16 v[12:15], v[124:127], v[184:187], v[12:15]
    ds_read_b128 v[104:107], v77 offset:1024
    v_mfma_f32_16x16x32_bf16 v[16:19], v[128:131], v[184:187], v[16:19]
    ds_read_b128 v[108:111], v77 offset:2048
    v_mfma_f32_16x16x32_bf16 v[20:23], v[132:135], v[184:187], v[20:23]
    ds_read_b128 v[112:115], v77 offset:3072
    v_mfma_f32_16x16x32_bf16 v[24:27], v[136:139], v[184:187], v[24:27]
    ds_read_b128 v[116:119], v77 offset:4096
    buffer_load_dwordx4 v[184:187], v3, s[28:31], s52 offen offset:3072 sc1
    s_waitcnt vmcnt(11) lgkmcnt(5)
    v_mfma_f32_16x16x32_bf16 v[8:11], v[80:83], v[140:143], v[8:11]
    ds_read_b128 v[120:123], v78 offset:0
    v_mfma_f32_16x16x32_bf16 v[12:15], v[84:87], v[140:143], v[12:15]
    ds_read_b128 v[124:127], v78 offset:1024
    v_mfma_f32_16x16x32_bf16 v[16:19], v[88:91], v[140:143], v[16:19]
    ds_read_b128 v[128:131], v78 offset:2048
    v_mfma_f32_16x16x32_bf16 v[20:23], v[92:95], v[140:143], v[20:23]
    ds_read_b128 v[132:135], v78 offset:3072
    v_mfma_f32_16x16x32_bf16 v[24:27], v[96:99], v[140:143], v[24:27]
    ds_read_b128 v[136:139], v78 offset:4096
    s_mov_b32 s52, 7868416
    buffer_load_dwordx4 v[140:143], v3, s[28:31], s52 offen offset:0 sc1
    s_waitcnt vmcnt(11) lgkmcnt(5)
    v_mfma_f32_16x16x32_bf16 v[8:11], v[100:103], v[144:147], v[8:11]
    ds_read_b128 v[80:83], v79 offset:0
    v_mfma_f32_16x16x32_bf16 v[12:15], v[104:107], v[144:147], v[12:15]
    ds_read_b128 v[84:87], v79 offset:1024
    v_mfma_f32_16x16x32_bf16 v[16:19], v[108:111], v[144:147], v[16:19]
    ds_read_b128 v[88:91], v79 offset:2048
    v_mfma_f32_16x16x32_bf16 v[20:23], v[112:115], v[144:147], v[20:23]
    ds_read_b128 v[92:95], v79 offset:3072
    v_mfma_f32_16x16x32_bf16 v[24:27], v[116:119], v[144:147], v[24:27]
    ds_read_b128 v[96:99], v79 offset:4096
    buffer_load_dwordx4 v[144:147], v3, s[28:31], s52 offen offset:1024 sc1
    v_lshlrev_b32 v28, 16, v64
    v_and_b32 v29, s61, v64
    v_lshlrev_b32 v30, 16, v65
    v_and_b32 v31, s61, v65
    s_waitcnt vmcnt(11) lgkmcnt(5)
    s_barrier
    v_mfma_f32_16x16x32_bf16 v[8:11], v[120:123], v[148:151], v[8:11]
    ds_read_b128 v[100:103], v76 offset:5120
    v_mfma_f32_16x16x32_bf16 v[12:15], v[124:127], v[148:151], v[12:15]
    ds_read_b128 v[104:107], v76 offset:6144
    v_mfma_f32_16x16x32_bf16 v[16:19], v[128:131], v[148:151], v[16:19]
    ds_read_b128 v[108:111], v76 offset:7168
    v_mfma_f32_16x16x32_bf16 v[20:23], v[132:135], v[148:151], v[20:23]
    ds_read_b128 v[112:115], v76 offset:8192
    v_mfma_f32_16x16x32_bf16 v[24:27], v[136:139], v[148:151], v[24:27]
    ds_read_b128 v[116:119], v76 offset:9216
    buffer_load_dwordx4 v[148:151], v3, s[28:31], s52 offen offset:2048 sc1
    v_lshlrev_b32 v32, 16, v66
    v_and_b32 v33, s61, v66
    v_lshlrev_b32 v34, 16, v67
    v_and_b32 v35, s61, v67
    s_waitcnt vmcnt(11) lgkmcnt(5)
    v_mfma_f32_16x16x32_bf16 v[8:11], v[80:83], v[152:155], v[8:11]
    ds_read_b128 v[120:123], v77 offset:5120
    v_mfma_f32_16x16x32_bf16 v[12:15], v[84:87], v[152:155], v[12:15]
    ds_read_b128 v[124:127], v77 offset:6144
    v_mfma_f32_16x16x32_bf16 v[16:19], v[88:91], v[152:155], v[16:19]
    ds_read_b128 v[128:131], v77 offset:7168
    v_mfma_f32_16x16x32_bf16 v[20:23], v[92:95], v[152:155], v[20:23]
    ds_read_b128 v[132:135], v77 offset:8192
    v_mfma_f32_16x16x32_bf16 v[24:27], v[96:99], v[152:155], v[24:27]
    ds_read_b128 v[136:139], v77 offset:9216
    buffer_load_dwordx4 v[152:155], v3, s[28:31], s52 offen offset:3072 sc1
    v_lshlrev_b32 v36, 16, v68
    v_and_b32 v37, s61, v68
    v_lshlrev_b32 v38, 16, v69
    v_and_b32 v39, s61, v69
    s_waitcnt vmcnt(11) lgkmcnt(5)
    v_mfma_f32_16x16x32_bf16 v[8:11], v[100:103], v[156:159], v[8:11]
    ds_read_b128 v[80:83], v78 offset:5120
    v_mfma_f32_16x16x32_bf16 v[12:15], v[104:107], v[156:159], v[12:15]
    ds_read_b128 v[84:87], v78 offset:6144
    v_mfma_f32_16x16x32_bf16 v[16:19], v[108:111], v[156:159], v[16:19]
    ds_read_b128 v[88:91], v78 offset:7168
    v_mfma_f32_16x16x32_bf16 v[20:23], v[112:115], v[156:159], v[20:23]
    ds_read_b128 v[92:95], v78 offset:8192
    v_mfma_f32_16x16x32_bf16 v[24:27], v[116:119], v[156:159], v[24:27]
    ds_read_b128 v[96:99], v78 offset:9216
    s_mov_b32 s52, 7872512
    buffer_load_dwordx4 v[156:159], v3, s[28:31], s52 offen offset:0 sc1
    v_lshlrev_b32 v40, 16, v70
    v_and_b32 v41, s61, v70
    v_lshlrev_b32 v42, 16, v71
    v_and_b32 v43, s61, v71
    s_waitcnt vmcnt(11) lgkmcnt(5)
    v_mfma_f32_16x16x32_bf16 v[8:11], v[120:123], v[160:163], v[8:11]
    ds_read_b128 v[100:103], v79 offset:5120
    v_mfma_f32_16x16x32_bf16 v[12:15], v[124:127], v[160:163], v[12:15]
    ds_read_b128 v[104:107], v79 offset:6144
    v_mfma_f32_16x16x32_bf16 v[16:19], v[128:131], v[160:163], v[16:19]
    ds_read_b128 v[108:111], v79 offset:7168
    v_mfma_f32_16x16x32_bf16 v[20:23], v[132:135], v[160:163], v[20:23]
    ds_read_b128 v[112:115], v79 offset:8192
    v_mfma_f32_16x16x32_bf16 v[24:27], v[136:139], v[160:163], v[24:27]
    ds_read_b128 v[116:119], v79 offset:9216
    buffer_load_dwordx4 v[160:163], v3, s[28:31], s52 offen offset:1024 sc1
    v_lshlrev_b32 v44, 16, v72
    v_and_b32 v45, s61, v72
    v_lshlrev_b32 v46, 16, v73
    v_and_b32 v47, s61, v73
    s_waitcnt vmcnt(11) lgkmcnt(5)
    s_barrier
    v_mfma_f32_16x16x32_bf16 v[8:11], v[80:83], v[164:167], v[8:11]
    ds_read_b128 v[120:123], v76 offset:10240
    v_mfma_f32_16x16x32_bf16 v[12:15], v[84:87], v[164:167], v[12:15]
    ds_read_b128 v[124:127], v76 offset:11264
    v_mfma_f32_16x16x32_bf16 v[16:19], v[88:91], v[164:167], v[16:19]
    ds_read_b128 v[128:131], v76 offset:12288
    v_mfma_f32_16x16x32_bf16 v[20:23], v[92:95], v[164:167], v[20:23]
    ds_read_b128 v[132:135], v76 offset:13312
    v_mfma_f32_16x16x32_bf16 v[24:27], v[96:99], v[164:167], v[24:27]
    ds_read_b128 v[136:139], v76 offset:14336
    buffer_load_dwordx4 v[164:167], v3, s[28:31], s52 offen offset:2048 sc1
    s_waitcnt vmcnt(11) lgkmcnt(5)
    v_mfma_f32_16x16x32_bf16 v[8:11], v[100:103], v[168:171], v[8:11]
    ds_read_b128 v[80:83], v77 offset:10240
    v_mfma_f32_16x16x32_bf16 v[12:15], v[104:107], v[168:171], v[12:15]
    ds_read_b128 v[84:87], v77 offset:11264
    v_mfma_f32_16x16x32_bf16 v[16:19], v[108:111], v[168:171], v[16:19]
    ds_read_b128 v[88:91], v77 offset:12288
    v_mfma_f32_16x16x32_bf16 v[20:23], v[112:115], v[168:171], v[20:23]
    ds_read_b128 v[92:95], v77 offset:13312
    v_mfma_f32_16x16x32_bf16 v[24:27], v[116:119], v[168:171], v[24:27]
    ds_read_b128 v[96:99], v77 offset:14336
    buffer_load_dwordx4 v[168:171], v3, s[28:31], s52 offen offset:3072 sc1
    s_waitcnt vmcnt(11) lgkmcnt(5)
    v_mfma_f32_16x16x32_bf16 v[8:11], v[120:123], v[172:175], v[8:11]
    ds_read_b128 v[100:103], v78 offset:10240
    v_mfma_f32_16x16x32_bf16 v[12:15], v[124:127], v[172:175], v[12:15]
    ds_read_b128 v[104:107], v78 offset:11264
    v_mfma_f32_16x16x32_bf16 v[16:19], v[128:131], v[172:175], v[16:19]
    ds_read_b128 v[108:111], v78 offset:12288
    v_mfma_f32_16x16x32_bf16 v[20:23], v[132:135], v[172:175], v[20:23]
    ds_read_b128 v[112:115], v78 offset:13312
    v_mfma_f32_16x16x32_bf16 v[24:27], v[136:139], v[172:175], v[24:27]
    ds_read_b128 v[116:119], v78 offset:14336
    s_mov_b32 s52, 7876608
    buffer_load_dwordx4 v[172:175], v3, s[28:31], s52 offen offset:0 sc1
    s_mov_b32 s56, 176
    s_mov_b32 s57, 1280
    s_mul_i32 s55, s23, 39936
    s_waitcnt vmcnt(11) lgkmcnt(5)
    v_mfma_f32_16x16x32_bf16 v[8:11], v[80:83], v[176:179], v[8:11]
    ds_read_b128 v[120:123], v79 offset:10240
    v_mfma_f32_16x16x32_bf16 v[12:15], v[84:87], v[176:179], v[12:15]
    ds_read_b128 v[124:127], v79 offset:11264
    v_mfma_f32_16x16x32_bf16 v[16:19], v[88:91], v[176:179], v[16:19]
    ds_read_b128 v[128:131], v79 offset:12288
    v_mfma_f32_16x16x32_bf16 v[20:23], v[92:95], v[176:179], v[20:23]
    ds_read_b128 v[132:135], v79 offset:13312
    v_mfma_f32_16x16x32_bf16 v[24:27], v[96:99], v[176:179], v[24:27]
    ds_read_b128 v[136:139], v79 offset:14336
    buffer_load_dwordx4 v[176:179], v3, s[28:31], s52 offen offset:1024 sc1
    s_add_u32 s55, s55, 5120
    v_mul_u32_u24 v48, 176, v4
    v_lshl_add_u32 v48, v7, 3, v48
    s_waitcnt vmcnt(11) lgkmcnt(5)
    s_barrier
    v_mfma_f32_16x16x32_bf16 v[8:11], v[100:103], v[180:183], v[8:11]
    ds_read_b128 v[80:83], v76 offset:15360
    v_mfma_f32_16x16x32_bf16 v[12:15], v[104:107], v[180:183], v[12:15]
    ds_read_b128 v[84:87], v76 offset:16384
    v_mfma_f32_16x16x32_bf16 v[16:19], v[108:111], v[180:183], v[16:19]
    ds_read_b128 v[88:91], v76 offset:17408
    v_mfma_f32_16x16x32_bf16 v[20:23], v[112:115], v[180:183], v[20:23]
    ds_read_b128 v[92:95], v76 offset:18432
    v_mfma_f32_16x16x32_bf16 v[24:27], v[116:119], v[180:183], v[24:27]
    ds_read_b128 v[96:99], v76 offset:19456
    buffer_load_dwordx4 v[180:183], v3, s[28:31], s52 offen offset:2048 sc1
    v_add_u32 v48, s55, v48
    v_add_u32 v1, 0, v2
    v_mul_u32_u24 v5, 6554, v1
    s_waitcnt vmcnt(11) lgkmcnt(5)
    v_mfma_f32_16x16x32_bf16 v[8:11], v[120:123], v[184:187], v[8:11]
    ds_read_b128 v[100:103], v77 offset:15360
    v_mfma_f32_16x16x32_bf16 v[12:15], v[124:127], v[184:187], v[12:15]
    ds_read_b128 v[104:107], v77 offset:16384
    v_mfma_f32_16x16x32_bf16 v[16:19], v[128:131], v[184:187], v[16:19]
    ds_read_b128 v[108:111], v77 offset:17408
    v_mfma_f32_16x16x32_bf16 v[20:23], v[132:135], v[184:187], v[20:23]
    ds_read_b128 v[112:115], v77 offset:18432
    v_mfma_f32_16x16x32_bf16 v[24:27], v[136:139], v[184:187], v[24:27]
    ds_read_b128 v[116:119], v77 offset:19456
    buffer_load_dwordx4 v[184:187], v3, s[28:31], s52 offen offset:3072 sc1
    v_lshrrev_b32 v5, 16, v5
    v_mul_u32_u24 v49, 10, v5
    v_sub_u32 v1, v1, v49
    s_waitcnt vmcnt(11) lgkmcnt(5)
    v_mfma_f32_16x16x32_bf16 v[8:11], v[80:83], v[140:143], v[8:11]
    ds_read_b128 v[120:123], v78 offset:15360
    v_mfma_f32_16x16x32_bf16 v[12:15], v[84:87], v[140:143], v[12:15]
    ds_read_b128 v[124:127], v78 offset:16384
    v_mfma_f32_16x16x32_bf16 v[16:19], v[88:91], v[140:143], v[16:19]
    ds_read_b128 v[128:131], v78 offset:17408
    v_mfma_f32_16x16x32_bf16 v[20:23], v[92:95], v[140:143], v[20:23]
    ds_read_b128 v[132:135], v78 offset:18432
    v_mfma_f32_16x16x32_bf16 v[24:27], v[96:99], v[140:143], v[24:27]
    ds_read_b128 v[136:139], v78 offset:19456
    s_mov_b32 s52, 7880704
    buffer_load_dwordx4 v[140:143], v3, s[28:31], s52 offen offset:0 sc1
    v_lshlrev_b32 v1, 4, v1
    v_mad_u32_u24 v50, v5, s56, v1
    v_add_u32 v50, s55, v50
    s_waitcnt vmcnt(11) lgkmcnt(5)
    v_mfma_f32_16x16x32_bf16 v[8:11], v[100:103], v[144:147], v[8:11]
    ds_read_b128 v[80:83], v79 offset:15360
    v_mfma_f32_16x16x32_bf16 v[12:15], v[104:107], v[144:147], v[12:15]
    ds_read_b128 v[84:87], v79 offset:16384
    v_mfma_f32_16x16x32_bf16 v[16:19], v[108:111], v[144:147], v[16:19]
    ds_read_b128 v[88:91], v79 offset:17408
    v_mfma_f32_16x16x32_bf16 v[20:23], v[112:115], v[144:147], v[20:23]
    ds_read_b128 v[92:95], v79 offset:18432
    v_mfma_f32_16x16x32_bf16 v[24:27], v[116:119], v[144:147], v[24:27]
    ds_read_b128 v[96:99], v79 offset:19456
    buffer_load_dwordx4 v[144:147], v3, s[28:31], s52 offen offset:1024 sc1
    v_mad_u32_u24 v53, v5, s57, v1
    v_add_u32 v1, 64, v2
    v_mul_u32_u24 v5, 6554, v1
    s_waitcnt vmcnt(11) lgkmcnt(5)
    s_barrier
    v_mfma_f32_16x16x32_bf16 v[8:11], v[120:123], v[148:151], v[8:11]
    ds_read_b128 v[100:103], v76 offset:20480
    v_mfma_f32_16x16x32_bf16 v[12:15], v[124:127], v[148:151], v[12:15]
    ds_read_b128 v[104:107], v76 offset:21504
    v_mfma_f32_16x16x32_bf16 v[16:19], v[128:131], v[148:151], v[16:19]
    ds_read_b128 v[108:111], v76 offset:22528
    v_mfma_f32_16x16x32_bf16 v[20:23], v[132:135], v[148:151], v[20:23]
    ds_read_b128 v[112:115], v76 offset:23552
    v_mfma_f32_16x16x32_bf16 v[24:27], v[136:139], v[148:151], v[24:27]
    ds_read_b128 v[116:119], v76 offset:24576
    buffer_load_dwordx4 v[148:151], v3, s[28:31], s52 offen offset:2048 sc1
    v_lshrrev_b32 v5, 16, v5
    v_mul_u32_u24 v49, 10, v5
    v_sub_u32 v1, v1, v49
    s_waitcnt vmcnt(11) lgkmcnt(5)
    v_mfma_f32_16x16x32_bf16 v[8:11], v[80:83], v[152:155], v[8:11]
    ds_read_b128 v[120:123], v77 offset:20480
    v_mfma_f32_16x16x32_bf16 v[12:15], v[84:87], v[152:155], v[12:15]
    ds_read_b128 v[124:127], v77 offset:21504
    v_mfma_f32_16x16x32_bf16 v[16:19], v[88:91], v[152:155], v[16:19]
    ds_read_b128 v[128:131], v77 offset:22528
    v_mfma_f32_16x16x32_bf16 v[20:23], v[92:95], v[152:155], v[20:23]
    ds_read_b128 v[132:135], v77 offset:23552
    v_mfma_f32_16x16x32_bf16 v[24:27], v[96:99], v[152:155], v[24:27]
    ds_read_b128 v[136:139], v77 offset:24576
    buffer_load_dwordx4 v[152:155], v3, s[28:31], s52 offen offset:3072 sc1
    v_lshlrev_b32 v1, 4, v1
    v_mad_u32_u24 v51, v5, s56, v1
    v_add_u32 v51, s55, v51
    s_waitcnt vmcnt(11) lgkmcnt(5)
    v_mfma_f32_16x16x32_bf16 v[8:11], v[100:103], v[156:159], v[8:11]
    ds_read_b128 v[80:83], v78 offset:20480
    v_mfma_f32_16x16x32_bf16 v[12:15], v[104:107], v[156:159], v[12:15]
    ds_read_b128 v[84:87], v78 offset:21504
    v_mfma_f32_16x16x32_bf16 v[16:19], v[108:111], v[156:159], v[16:19]
    ds_read_b128 v[88:91], v78 offset:22528
    v_mfma_f32_16x16x32_bf16 v[20:23], v[112:115], v[156:159], v[20:23]
    ds_read_b128 v[92:95], v78 offset:23552
    v_mfma_f32_16x16x32_bf16 v[24:27], v[116:119], v[156:159], v[24:27]
    ds_read_b128 v[96:99], v78 offset:24576
    s_mov_b32 s52, 5242880
    buffer_load_dwordx4 v[156:159], v3, s[28:31], s52 offen offset:0 sc1
    v_mad_u32_u24 v54, v5, s57, v1
    v_add_u32 v1, 128, v2
    v_mul_u32_u24 v5, 6554, v1
    s_waitcnt vmcnt(11) lgkmcnt(5)
    v_mfma_f32_16x16x32_bf16 v[8:11], v[120:123], v[160:163], v[8:11]
    ds_read_b128 v[100:103], v79 offset:20480
    v_mfma_f32_16x16x32_bf16 v[12:15], v[124:127], v[160:163], v[12:15]
    ds_read_b128 v[104:107], v79 offset:21504
    v_mfma_f32_16x16x32_bf16 v[16:19], v[128:131], v[160:163], v[16:19]
    ds_read_b128 v[108:111], v79 offset:22528
    v_mfma_f32_16x16x32_bf16 v[20:23], v[132:135], v[160:163], v[20:23]
    ds_read_b128 v[112:115], v79 offset:23552
    v_mfma_f32_16x16x32_bf16 v[24:27], v[136:139], v[160:163], v[24:27]
    ds_read_b128 v[116:119], v79 offset:24576
    buffer_load_dwordx4 v[160:163], v3, s[28:31], s52 offen offset:1024 sc1
    v_lshrrev_b32 v5, 16, v5
    v_mul_u32_u24 v49, 10, v5
    v_sub_u32 v1, v1, v49
    s_waitcnt vmcnt(11) lgkmcnt(5)
    s_barrier
    v_mfma_f32_16x16x32_bf16 v[8:11], v[80:83], v[164:167], v[8:11]
    ds_read_b128 v[120:123], v76 offset:25600
    v_mfma_f32_16x16x32_bf16 v[12:15], v[84:87], v[164:167], v[12:15]
    ds_read_b128 v[124:127], v76 offset:26624
    v_mfma_f32_16x16x32_bf16 v[16:19], v[88:91], v[164:167], v[16:19]
    ds_read_b128 v[128:131], v76 offset:27648
    v_mfma_f32_16x16x32_bf16 v[20:23], v[92:95], v[164:167], v[20:23]
    ds_read_b128 v[132:135], v76 offset:28672
    v_mfma_f32_16x16x32_bf16 v[24:27], v[96:99], v[164:167], v[24:27]
    ds_read_b128 v[136:139], v76 offset:29696
    buffer_load_dwordx4 v[164:167], v3, s[28:31], s52 offen offset:2048 sc1
    v_lshlrev_b32 v1, 4, v1
    v_mad_u32_u24 v52, v5, s56, v1
    v_add_u32 v52, s55, v52
    s_waitcnt vmcnt(11) lgkmcnt(5)
    v_mfma_f32_16x16x32_bf16 v[8:11], v[100:103], v[168:171], v[8:11]
    ds_read_b128 v[80:83], v77 offset:25600
    v_mfma_f32_16x16x32_bf16 v[12:15], v[104:107], v[168:171], v[12:15]
    ds_read_b128 v[84:87], v77 offset:26624
    v_mfma_f32_16x16x32_bf16 v[16:19], v[108:111], v[168:171], v[16:19]
    ds_read_b128 v[88:91], v77 offset:27648
    v_mfma_f32_16x16x32_bf16 v[20:23], v[112:115], v[168:171], v[20:23]
    ds_read_b128 v[92:95], v77 offset:28672
    v_mfma_f32_16x16x32_bf16 v[24:27], v[116:119], v[168:171], v[24:27]
    ds_read_b128 v[96:99], v77 offset:29696
    buffer_load_dwordx4 v[168:171], v3, s[28:31], s52 offen offset:3072 sc1
    v_mad_u32_u24 v55, v5, s57, v1
    s_waitcnt vmcnt(11) lgkmcnt(5)
    v_mfma_f32_16x16x32_bf16 v[8:11], v[120:123], v[172:175], v[8:11]
    ds_read_b128 v[100:103], v78 offset:25600
    v_mfma_f32_16x16x32_bf16 v[12:15], v[124:127], v[172:175], v[12:15]
    ds_read_b128 v[104:107], v78 offset:26624
    v_mfma_f32_16x16x32_bf16 v[16:19], v[128:131], v[172:175], v[16:19]
    ds_read_b128 v[108:111], v78 offset:27648
    v_mfma_f32_16x16x32_bf16 v[20:23], v[132:135], v[172:175], v[20:23]
    ds_read_b128 v[112:115], v78 offset:28672
    v_mfma_f32_16x16x32_bf16 v[24:27], v[136:139], v[172:175], v[24:27]
    ds_read_b128 v[116:119], v78 offset:29696
    s_mov_b32 s52, 5246976
    buffer_load_dwordx4 v[172:175], v3, s[28:31], s52 offen offset:0 sc1
    s_waitcnt vmcnt(11) lgkmcnt(5)
    v_mfma_f32_16x16x32_bf16 v[8:11], v[80:83], v[176:179], v[8:11]
    ds_read_b128 v[120:123], v79 offset:25600
    v_mfma_f32_16x16x32_bf16 v[12:15], v[84:87], v[176:179], v[12:15]
    ds_read_b128 v[124:127], v79 offset:26624
    v_mfma_f32_16x16x32_bf16 v[16:19], v[88:91], v[176:179], v[16:19]
    ds_read_b128 v[128:131], v79 offset:27648
    v_mfma_f32_16x16x32_bf16 v[20:23], v[92:95], v[176:179], v[20:23]
    ds_read_b128 v[132:135], v79 offset:28672
    v_mfma_f32_16x16x32_bf16 v[24:27], v[96:99], v[176:179], v[24:27]
    ds_read_b128 v[136:139], v79 offset:29696
    buffer_load_dwordx4 v[176:179], v3, s[28:31], s52 offen offset:1024 sc1
    s_waitcnt vmcnt(11) lgkmcnt(5)
    s_barrier
    v_mfma_f32_16x16x32_bf16 v[8:11], v[100:103], v[180:183], v[8:11]
    ds_read_b128 v[80:83], v76 offset:30720
    v_mfma_f32_16x16x32_bf16 v[12:15], v[104:107], v[180:183], v[12:15]
    ds_read_b128 v[84:87], v76 offset:31744
    v_mfma_f32_16x16x32_bf16 v[16:19], v[108:111], v[180:183], v[16:19]
    ds_read_b128 v[88:91], v76 offset:32768
    v_mfma_f32_16x16x32_bf16 v[20:23], v[112:115], v[180:183], v[20:23]
    ds_read_b128 v[92:95], v76 offset:33792
    v_mfma_f32_16x16x32_bf16 v[24:27], v[116:119], v[180:183], v[24:27]
    ds_read_b128 v[96:99], v76 offset:34816
    buffer_load_dwordx4 v[180:183], v3, s[28:31], s52 offen offset:2048 sc1
    s_waitcnt vmcnt(11) lgkmcnt(5)
    v_mfma_f32_16x16x32_bf16 v[8:11], v[120:123], v[184:187], v[8:11]
    ds_read_b128 v[100:103], v77 offset:30720
    v_mfma_f32_16x16x32_bf16 v[12:15], v[124:127], v[184:187], v[12:15]
    ds_read_b128 v[104:107], v77 offset:31744
    v_mfma_f32_16x16x32_bf16 v[16:19], v[128:131], v[184:187], v[16:19]
    ds_read_b128 v[108:111], v77 offset:32768
    v_mfma_f32_16x16x32_bf16 v[20:23], v[132:135], v[184:187], v[20:23]
    ds_read_b128 v[112:115], v77 offset:33792
    v_mfma_f32_16x16x32_bf16 v[24:27], v[136:139], v[184:187], v[24:27]
    ds_read_b128 v[116:119], v77 offset:34816
    buffer_load_dwordx4 v[184:187], v3, s[28:31], s52 offen offset:3072 sc1
    s_waitcnt vmcnt(11) lgkmcnt(5)
    v_mfma_f32_16x16x32_bf16 v[8:11], v[80:83], v[140:143], v[8:11]
    ds_read_b128 v[120:123], v78 offset:30720
    v_mfma_f32_16x16x32_bf16 v[12:15], v[84:87], v[140:143], v[12:15]
    ds_read_b128 v[124:127], v78 offset:31744
    v_mfma_f32_16x16x32_bf16 v[16:19], v[88:91], v[140:143], v[16:19]
    ds_read_b128 v[128:131], v78 offset:32768
    v_mfma_f32_16x16x32_bf16 v[20:23], v[92:95], v[140:143], v[20:23]
    ds_read_b128 v[132:135], v78 offset:33792
    v_mfma_f32_16x16x32_bf16 v[24:27], v[96:99], v[140:143], v[24:27]
    ds_read_b128 v[136:139], v78 offset:34816
    s_mov_b32 s52, 5251072
    buffer_load_dwordx4 v[140:143], v3, s[28:31], s52 offen offset:0 sc1
    s_waitcnt vmcnt(11) lgkmcnt(5)
    v_mfma_f32_16x16x32_bf16 v[8:11], v[100:103], v[144:147], v[8:11]
    ds_read_b128 v[80:83], v79 offset:30720
    v_mfma_f32_16x16x32_bf16 v[12:15], v[104:107], v[144:147], v[12:15]
    ds_read_b128 v[84:87], v79 offset:31744
    v_mfma_f32_16x16x32_bf16 v[16:19], v[108:111], v[144:147], v[16:19]
    ds_read_b128 v[88:91], v79 offset:32768
    v_mfma_f32_16x16x32_bf16 v[20:23], v[112:115], v[144:147], v[20:23]
    ds_read_b128 v[92:95], v79 offset:33792
    v_mfma_f32_16x16x32_bf16 v[24:27], v[116:119], v[144:147], v[24:27]
    ds_read_b128 v[96:99], v79 offset:34816
    buffer_load_dwordx4 v[144:147], v3, s[28:31], s52 offen offset:1024 sc1
    s_waitcnt vmcnt(11) lgkmcnt(5)
    s_barrier
    v_mfma_f32_16x16x32_bf16 v[8:11], v[120:123], v[148:151], v[8:11]
    ds_read_b128 v[100:103], v76 offset:0
    v_mfma_f32_16x16x32_bf16 v[12:15], v[124:127], v[148:151], v[12:15]
    ds_read_b128 v[104:107], v76 offset:1024
    v_mfma_f32_16x16x32_bf16 v[16:19], v[128:131], v[148:151], v[16:19]
    ds_read_b128 v[108:111], v76 offset:2048
    v_mfma_f32_16x16x32_bf16 v[20:23], v[132:135], v[148:151], v[20:23]
    ds_read_b128 v[112:115], v76 offset:3072
    v_mfma_f32_16x16x32_bf16 v[24:27], v[136:139], v[148:151], v[24:27]
    ds_read_b128 v[116:119], v76 offset:4096
    buffer_load_dwordx4 v[148:151], v3, s[28:31], s52 offen offset:2048 sc1
    s_waitcnt vmcnt(11) lgkmcnt(5)
    v_mfma_f32_16x16x32_bf16 v[8:11], v[80:83], v[152:155], v[8:11]
    ds_read_b128 v[120:123], v77 offset:0
    v_mfma_f32_16x16x32_bf16 v[12:15], v[84:87], v[152:155], v[12:15]
    ds_read_b128 v[124:127], v77 offset:1024
    v_mfma_f32_16x16x32_bf16 v[16:19], v[88:91], v[152:155], v[16:19]
    ds_read_b128 v[128:131], v77 offset:2048
    v_mfma_f32_16x16x32_bf16 v[20:23], v[92:95], v[152:155], v[20:23]
    ds_read_b128 v[132:135], v77 offset:3072
    v_mfma_f32_16x16x32_bf16 v[24:27], v[96:99], v[152:155], v[24:27]
    ds_read_b128 v[136:139], v77 offset:4096
    buffer_load_dwordx4 v[152:155], v3, s[28:31], s52 offen offset:3072 sc1
    s_waitcnt vmcnt(11) lgkmcnt(5)
    v_mfma_f32_16x16x32_bf16 v[8:11], v[100:103], v[156:159], v[8:11]
    ds_read_b128 v[80:83], v78 offset:0
    v_mfma_f32_16x16x32_bf16 v[12:15], v[104:107], v[156:159], v[12:15]
    ds_read_b128 v[84:87], v78 offset:1024
    v_mfma_f32_16x16x32_bf16 v[16:19], v[108:111], v[156:159], v[16:19]
    ds_read_b128 v[88:91], v78 offset:2048
    v_mfma_f32_16x16x32_bf16 v[20:23], v[112:115], v[156:159], v[20:23]
    ds_read_b128 v[92:95], v78 offset:3072
    v_mfma_f32_16x16x32_bf16 v[24:27], v[116:119], v[156:159], v[24:27]
    ds_read_b128 v[96:99], v78 offset:4096
    s_mov_b32 s52, 5255168
    buffer_load_dwordx4 v[156:159], v3, s[28:31], s52 offen offset:0 sc1
    s_waitcnt vmcnt(11) lgkmcnt(5)
    v_mfma_f32_16x16x32_bf16 v[8:11], v[120:123], v[160:163], v[8:11]
    ds_read_b128 v[100:103], v79 offset:0
    v_mfma_f32_16x16x32_bf16 v[12:15], v[124:127], v[160:163], v[12:15]
    ds_read_b128 v[104:107], v79 offset:1024
    v_mfma_f32_16x16x32_bf16 v[16:19], v[128:131], v[160:163], v[16:19]
    ds_read_b128 v[108:111], v79 offset:2048
    v_mfma_f32_16x16x32_bf16 v[20:23], v[132:135], v[160:163], v[20:23]
    ds_read_b128 v[112:115], v79 offset:3072
    v_mfma_f32_16x16x32_bf16 v[24:27], v[136:139], v[160:163], v[24:27]
    ds_read_b128 v[116:119], v79 offset:4096
    buffer_load_dwordx4 v[160:163], v3, s[28:31], s52 offen offset:1024 sc1
    s_waitcnt vmcnt(11) lgkmcnt(5)
    s_barrier
    v_mfma_f32_16x16x32_bf16 v[8:11], v[80:83], v[164:167], v[8:11]
    ds_read_b128 v[120:123], v76 offset:5120
    v_mfma_f32_16x16x32_bf16 v[12:15], v[84:87], v[164:167], v[12:15]
    ds_read_b128 v[124:127], v76 offset:6144
    v_mfma_f32_16x16x32_bf16 v[16:19], v[88:91], v[164:167], v[16:19]
    ds_read_b128 v[128:131], v76 offset:7168
    v_mfma_f32_16x16x32_bf16 v[20:23], v[92:95], v[164:167], v[20:23]
    ds_read_b128 v[132:135], v76 offset:8192
    v_mfma_f32_16x16x32_bf16 v[24:27], v[96:99], v[164:167], v[24:27]
    ds_read_b128 v[136:139], v76 offset:9216
    s_waitcnt vmcnt(10) lgkmcnt(5)
    v_mfma_f32_16x16x32_bf16 v[8:11], v[100:103], v[168:171], v[8:11]
    ds_read_b128 v[80:83], v77 offset:5120
    v_mfma_f32_16x16x32_bf16 v[12:15], v[104:107], v[168:171], v[12:15]
    ds_read_b128 v[84:87], v77 offset:6144
    v_mfma_f32_16x16x32_bf16 v[16:19], v[108:111], v[168:171], v[16:19]
    ds_read_b128 v[88:91], v77 offset:7168
    v_mfma_f32_16x16x32_bf16 v[20:23], v[112:115], v[168:171], v[20:23]
    ds_read_b128 v[92:95], v77 offset:8192
    v_mfma_f32_16x16x32_bf16 v[24:27], v[116:119], v[168:171], v[24:27]
    ds_read_b128 v[96:99], v77 offset:9216
    s_waitcnt vmcnt(9) lgkmcnt(5)
    v_mfma_f32_16x16x32_bf16 v[8:11], v[120:123], v[172:175], v[8:11]
    ds_read_b128 v[100:103], v78 offset:5120
    v_mfma_f32_16x16x32_bf16 v[12:15], v[124:127], v[172:175], v[12:15]
    ds_read_b128 v[104:107], v78 offset:6144
    v_mfma_f32_16x16x32_bf16 v[16:19], v[128:131], v[172:175], v[16:19]
    ds_read_b128 v[108:111], v78 offset:7168
    v_mfma_f32_16x16x32_bf16 v[20:23], v[132:135], v[172:175], v[20:23]
    ds_read_b128 v[112:115], v78 offset:8192
    v_mfma_f32_16x16x32_bf16 v[24:27], v[136:139], v[172:175], v[24:27]
    ds_read_b128 v[116:119], v78 offset:9216
    s_waitcnt vmcnt(8) lgkmcnt(5)
    v_mfma_f32_16x16x32_bf16 v[8:11], v[80:83], v[176:179], v[8:11]
    ds_read_b128 v[120:123], v79 offset:5120
    v_mfma_f32_16x16x32_bf16 v[12:15], v[84:87], v[176:179], v[12:15]
    ds_read_b128 v[124:127], v79 offset:6144
    v_mfma_f32_16x16x32_bf16 v[16:19], v[88:91], v[176:179], v[16:19]
    ds_read_b128 v[128:131], v79 offset:7168
    v_mfma_f32_16x16x32_bf16 v[20:23], v[92:95], v[176:179], v[20:23]
    ds_read_b128 v[132:135], v79 offset:8192
    v_mfma_f32_16x16x32_bf16 v[24:27], v[96:99], v[176:179], v[24:27]
    ds_read_b128 v[136:139], v79 offset:9216
    s_waitcnt vmcnt(7) lgkmcnt(5)
    s_barrier
    v_mfma_f32_16x16x32_bf16 v[8:11], v[100:103], v[180:183], v[8:11]
    ds_read_b128 v[80:83], v76 offset:10240
    v_mfma_f32_16x16x32_bf16 v[12:15], v[104:107], v[180:183], v[12:15]
    ds_read_b128 v[84:87], v76 offset:11264
    v_mfma_f32_16x16x32_bf16 v[16:19], v[108:111], v[180:183], v[16:19]
    ds_read_b128 v[88:91], v76 offset:12288
    v_mfma_f32_16x16x32_bf16 v[20:23], v[112:115], v[180:183], v[20:23]
    ds_read_b128 v[92:95], v76 offset:13312
    v_mfma_f32_16x16x32_bf16 v[24:27], v[116:119], v[180:183], v[24:27]
    ds_read_b128 v[96:99], v76 offset:14336
    s_waitcnt vmcnt(6) lgkmcnt(5)
    v_mfma_f32_16x16x32_bf16 v[8:11], v[120:123], v[184:187], v[8:11]
    ds_read_b128 v[100:103], v77 offset:10240
    v_mfma_f32_16x16x32_bf16 v[12:15], v[124:127], v[184:187], v[12:15]
    ds_read_b128 v[104:107], v77 offset:11264
    v_mfma_f32_16x16x32_bf16 v[16:19], v[128:131], v[184:187], v[16:19]
    ds_read_b128 v[108:111], v77 offset:12288
    v_mfma_f32_16x16x32_bf16 v[20:23], v[132:135], v[184:187], v[20:23]
    ds_read_b128 v[112:115], v77 offset:13312
    v_mfma_f32_16x16x32_bf16 v[24:27], v[136:139], v[184:187], v[24:27]
    ds_read_b128 v[116:119], v77 offset:14336
    s_waitcnt vmcnt(5) lgkmcnt(5)
    v_mfma_f32_16x16x32_bf16 v[8:11], v[80:83], v[140:143], v[8:11]
    ds_read_b128 v[120:123], v78 offset:10240
    v_mfma_f32_16x16x32_bf16 v[12:15], v[84:87], v[140:143], v[12:15]
    ds_read_b128 v[124:127], v78 offset:11264
    v_mfma_f32_16x16x32_bf16 v[16:19], v[88:91], v[140:143], v[16:19]
    ds_read_b128 v[128:131], v78 offset:12288
    v_mfma_f32_16x16x32_bf16 v[20:23], v[92:95], v[140:143], v[20:23]
    ds_read_b128 v[132:135], v78 offset:13312
    v_mfma_f32_16x16x32_bf16 v[24:27], v[96:99], v[140:143], v[24:27]
    ds_read_b128 v[136:139], v78 offset:14336
    s_waitcnt vmcnt(4) lgkmcnt(5)
    v_mfma_f32_16x16x32_bf16 v[8:11], v[100:103], v[144:147], v[8:11]
    ds_read_b128 v[80:83], v79 offset:10240
    v_mfma_f32_16x16x32_bf16 v[12:15], v[104:107], v[144:147], v[12:15]
    ds_read_b128 v[84:87], v79 offset:11264
    v_mfma_f32_16x16x32_bf16 v[16:19], v[108:111], v[144:147], v[16:19]
    ds_read_b128 v[88:91], v79 offset:12288
    v_mfma_f32_16x16x32_bf16 v[20:23], v[112:115], v[144:147], v[20:23]
    ds_read_b128 v[92:95], v79 offset:13312
    v_mfma_f32_16x16x32_bf16 v[24:27], v[116:119], v[144:147], v[24:27]
    ds_read_b128 v[96:99], v79 offset:14336
    s_waitcnt vmcnt(3) lgkmcnt(5)
    s_barrier
    v_mfma_f32_16x16x32_bf16 v[8:11], v[120:123], v[148:151], v[8:11]
    ds_read_b128 v[100:103], v76 offset:15360
    v_mfma_f32_16x16x32_bf16 v[12:15], v[124:127], v[148:151], v[12:15]
    ds_read_b128 v[104:107], v76 offset:16384
    v_mfma_f32_16x16x32_bf16 v[16:19], v[128:131], v[148:151], v[16:19]
    ds_read_b128 v[108:111], v76 offset:17408
    v_mfma_f32_16x16x32_bf16 v[20:23], v[132:135], v[148:151], v[20:23]
    ds_read_b128 v[112:115], v76 offset:18432
    v_mfma_f32_16x16x32_bf16 v[24:27], v[136:139], v[148:151], v[24:27]
    ds_read_b128 v[116:119], v76 offset:19456
    s_waitcnt vmcnt(2) lgkmcnt(5)
    v_mfma_f32_16x16x32_bf16 v[8:11], v[80:83], v[152:155], v[8:11]
    ds_read_b128 v[120:123], v77 offset:15360
    v_mfma_f32_16x16x32_bf16 v[12:15], v[84:87], v[152:155], v[12:15]
    ds_read_b128 v[124:127], v77 offset:16384
    v_mfma_f32_16x16x32_bf16 v[16:19], v[88:91], v[152:155], v[16:19]
    ds_read_b128 v[128:131], v77 offset:17408
    v_mfma_f32_16x16x32_bf16 v[20:23], v[92:95], v[152:155], v[20:23]
    ds_read_b128 v[132:135], v77 offset:18432
    v_mfma_f32_16x16x32_bf16 v[24:27], v[96:99], v[152:155], v[24:27]
    ds_read_b128 v[136:139], v77 offset:19456
    s_waitcnt vmcnt(1) lgkmcnt(5)
    v_mfma_f32_16x16x32_bf16 v[8:11], v[100:103], v[156:159], v[8:11]
    v_mfma_f32_16x16x32_bf16 v[12:15], v[104:107], v[156:159], v[12:15]
    v_mfma_f32_16x16x32_bf16 v[16:19], v[108:111], v[156:159], v[16:19]
    v_mfma_f32_16x16x32_bf16 v[20:23], v[112:115], v[156:159], v[20:23]
    v_mfma_f32_16x16x32_bf16 v[24:27], v[116:119], v[156:159], v[24:27]
    s_waitcnt vmcnt(0) lgkmcnt(0)
    v_mfma_f32_16x16x32_bf16 v[8:11], v[120:123], v[160:163], v[8:11]
    v_mfma_f32_16x16x32_bf16 v[12:15], v[124:127], v[160:163], v[12:15]
    v_mfma_f32_16x16x32_bf16 v[16:19], v[128:131], v[160:163], v[16:19]
    v_mfma_f32_16x16x32_bf16 v[20:23], v[132:135], v[160:163], v[20:23]
    v_mfma_f32_16x16x32_bf16 v[24:27], v[136:139], v[160:163], v[24:27]
    s_nop 5
    v_pk_add_f32 v[8:9], v[8:9], v[28:29]
    v_cvt_pk_bf16_f32 v64, v8, v9
    v_pk_add_f32 v[10:11], v[10:11], v[30:31]
    v_cvt_pk_bf16_f32 v65, v10, v11
    ds_write_b64 v48, v[64:65] offset:0
    v_pk_add_f32 v[12:13], v[12:13], v[32:33]
    v_cvt_pk_bf16_f32 v66, v12, v13
    v_pk_add_f32 v[14:15], v[14:15], v[34:35]
    v_cvt_pk_bf16_f32 v67, v14, v15
    ds_write_b64 v48, v[66:67] offset:32
    v_pk_add_f32 v[16:17], v[16:17], v[36:37]
    v_cvt_pk_bf16_f32 v68, v16, v17
    v_pk_add_f32 v[18:19], v[18:19], v[38:39]
    v_cvt_pk_bf16_f32 v69, v18, v19
    ds_write_b64 v48, v[68:69] offset:64
    v_pk_add_f32 v[20:21], v[20:21], v[40:41]
    v_cvt_pk_bf16_f32 v70, v20, v21
    v_pk_add_f32 v[22:23], v[22:23], v[42:43]
    v_cvt_pk_bf16_f32 v71, v22, v23
    ds_write_b64 v48, v[70:71] offset:96
    v_pk_add_f32 v[24:25], v[24:25], v[44:45]
    v_cvt_pk_bf16_f32 v72, v24, v25
    v_pk_add_f32 v[26:27], v[26:27], v[46:47]
    v_cvt_pk_bf16_f32 v73, v26, v27
    ds_write_b64 v48, v[72:73] offset:128
    s_waitcnt lgkmcnt(0)
    ds_read_b128 v[80:83], v50
    ds_read_b128 v[84:87], v51
    ds_read_b128 v[88:91], v52
    s_waitcnt lgkmcnt(2)
    buffer_store_dwordx4 v[80:83], v53, s[32:35], s51 offen
    s_waitcnt lgkmcnt(1)
    buffer_store_dwordx4 v[84:87], v54, s[32:35], s51 offen
    s_waitcnt lgkmcnt(0)
    s_mov_b32 exec_hi, 0
    buffer_store_dwordx4 v[88:91], v55, s[32:35], s51 offen
    s_endpgm
L3_loader:
    v_lshlrev_b32 v3, 4, v2
    v_add_u32 v4, 4096, v3
    s_mul_i32 s48, s23, 39936
    s_and_b32 s55, s21, 15
    s_mul_i32 s56, s55, 7
    s_mul_i32 s57, s55, 6
    s_add_u32 s57, s57, 12
    s_min_u32 s56, s56, s57
    s_lshl_b32 s49, s56, 6
    s_lshl_b32 s55, s55, 2
    s_add_u32 s55, s55, s23
    s_mul_i32 s55, s55, 35840
    s_add_u32 s55, s55, 23330816
    s_and_b32 s56, s21, 7
    s_lshl_b32 s56, s56, 2
    s_add_u32 s56, s56, s23
    s_mul_i32 s56, s56, 71680
    s_add_u32 s56, s56, 21037056
    v_lshlrev_b32 v5, 3, v2
    s_add_u32 s28, s10, s55
    s_addc_u32 s29, s11, 0
    s_mov_b32 s30, 35840
    s_mov_b32 s31, 0x00020000
    s_add_u32 s32, s10, s56
    s_addc_u32 s33, s11, 0
    s_mov_b32 s34, 71680
    s_mov_b32 s35, 0x00020000
    s_add_u32 s36, s10, 25755648
    s_addc_u32 s37, s11, 0
    s_mov_b32 s38, 143360
    s_mov_b32 s39, 0x00020000
    v_add_u32 v6, s48, v3
    s_waitcnt vmcnt(4)
    s_barrier
    s_mul_i32 s55, s23, 35840
    s_add_u32 s49, s49, s55
    buffer_load_dwordx2 v[208:209], v5, s[36:39], s49 offen sc1
    s_add_u32 s49, s49, 7168
    buffer_load_dwordx2 v[210:211], v5, s[36:39], s49 offen sc1
    s_add_u32 s49, s49, 7168
    buffer_load_dwordx2 v[212:213], v5, s[36:39], s49 offen sc1
    s_add_u32 s49, s49, 7168
    buffer_load_dwordx2 v[214:215], v5, s[36:39], s49 offen sc1
    s_add_u32 s49, s49, 7168
    buffer_load_dwordx2 v[216:217], v5, s[36:39], s49 offen sc1
    s_add_u32 s49, s49, 7168
    s_add_u32 m0, s48, 25600
    s_mov_b32 s50, 0
    buffer_load_dwordx4 v3, s[28:31], s50 offen offset:0 sc1 lds
    buffer_load_dwordx4 v3, s[28:31], s50 offen offset:1024 sc1 lds
    buffer_load_dwordx4 v3, s[28:31], s50 offen offset:2048 sc1 lds
    buffer_load_dwordx4 v3, s[28:31], s50 offen offset:3072 sc1 lds
    s_add_u32 m0, s48, 29696
    s_nop 0
    buffer_load_dwordx4 v4, s[28:31], s50 offen offset:0 sc1 lds
    buffer_load_dwordx4 v4, s[28:31], s50 offen offset:1024 sc1 lds
    buffer_load_dwordx4 v4, s[28:31], s50 offen offset:2048 sc1 lds
    s_add_u32 m0, s48, 32768
    s_mov_b32 s50, 7168
    buffer_load_dwordx4 v3, s[28:31], s50 offen offset:0 sc1 lds
    buffer_load_dwordx4 v3, s[28:31], s50 offen offset:1024 sc1 lds
    buffer_load_dwordx4 v3, s[28:31], s50 offen offset:2048 sc1 lds
    buffer_load_dwordx4 v3, s[28:31], s50 offen offset:3072 sc1 lds
    s_add_u32 m0, s48, 36864
    s_nop 0
    s_barrier
    buffer_load_dwordx4 v4, s[28:31], s50 offen offset:0 sc1 lds
    buffer_load_dwordx4 v4, s[28:31], s50 offen offset:1024 sc1 lds
    buffer_load_dwordx4 v4, s[28:31], s50 offen offset:2048 sc1 lds
    s_waitcnt lgkmcnt(0)
    s_barrier
    s_waitcnt lgkmcnt(0)
    s_barrier
    s_waitcnt lgkmcnt(0)
    s_barrier
    s_add_u32 m0, s48, 0
    s_mov_b32 s50, 14336
    buffer_load_dwordx4 v3, s[28:31], s50 offen offset:0 sc1 lds
    buffer_load_dwordx4 v3, s[28:31], s50 offen offset:1024 sc1 lds
    buffer_load_dwordx4 v3, s[28:31], s50 offen offset:2048 sc1 lds
    buffer_load_dwordx4 v3, s[28:31], s50 offen offset:3072 sc1 lds
    s_add_u32 m0, s48, 4096
    s_nop 0
    buffer_load_dwordx4 v4, s[28:31], s50 offen offset:0 sc1 lds
    buffer_load_dwordx4 v4, s[28:31], s50 offen offset:1024 sc1 lds
    buffer_load_dwordx4 v4, s[28:31], s50 offen offset:2048 sc1 lds
    s_waitcnt vmcnt(21)
    v_pk_add_f32 v[208:209], v[208:209], v[210:211]
    v_pk_add_f32 v[208:209], v[208:209], v[212:213]
    v_pk_add_f32 v[208:209], v[208:209], v[214:215]
    v_pk_add_f32 v[208:209], v[208:209], v[216:217]
    v_add_u32 v5, 159744, v5
    s_lshl_b32 s55, s23, 9
    v_add_u32 v1, s55, v5
    ds_write_b64 v1, v[208:209]
    s_waitcnt lgkmcnt(0)
    s_barrier
    s_add_u32 m0, s48, 7168
    s_mov_b32 s50, 21504
    buffer_load_dwordx4 v3, s[28:31], s50 offen offset:0 sc1 lds
    buffer_load_dwordx4 v3, s[28:31], s50 offen offset:1024 sc1 lds
    buffer_load_dwordx4 v3, s[28:31], s50 offen offset:2048 sc1 lds
    buffer_load_dwordx4 v3, s[28:31], s50 offen offset:3072 sc1 lds
    s_add_u32 m0, s48, 11264
    s_nop 0
    buffer_load_dwordx4 v4, s[28:31], s50 offen offset:0 sc1 lds
    buffer_load_dwordx4 v4, s[28:31], s50 offen offset:1024 sc1 lds
    buffer_load_dwordx4 v4, s[28:31], s50 offen offset:2048 sc1 lds
    ds_read_b64 v[208:209], v5 offset:0
    ds_read_b64 v[210:211], v5 offset:512
    ds_read_b64 v[212:213], v5 offset:1024
    ds_read_b64 v[214:215], v5 offset:1536
    s_waitcnt lgkmcnt(0)
    v_pk_add_f32 v[208:209], v[208:209], v[210:211]
    v_pk_add_f32 v[208:209], v[208:209], v[212:213]
    v_pk_add_f32 v[208:209], v[208:209], v[214:215]
    s_mov_b32 exec_hi, 0x00ffffff
    ds_write_b64 v5, v[208:209] offset:3200
    s_mov_b64 exec, -1
    s_waitcnt lgkmcnt(0)
    s_barrier
    s_add_u32 m0, s48, 14336
    s_mov_b32 s50, 28672
    buffer_load_dwordx4 v3, s[28:31], s50 offen offset:0 sc1 lds
    buffer_load_dwordx4 v3, s[28:31], s50 offen offset:1024 sc1 lds
    buffer_load_dwordx4 v3, s[28:31], s50 offen offset:2048 sc1 lds
    buffer_load_dwordx4 v3, s[28:31], s50 offen offset:3072 sc1 lds
    s_add_u32 m0, s48, 18432
    s_nop 0
    buffer_load_dwordx4 v4, s[28:31], s50 offen offset:0 sc1 lds
    buffer_load_dwordx4 v4, s[28:31], s50 offen offset:1024 sc1 lds
    buffer_load_dwordx4 v4, s[28:31], s50 offen offset:2048 sc1 lds
    s_waitcnt vmcnt(28)
    s_waitcnt lgkmcnt(0)
    s_barrier
    s_waitcnt vmcnt(21)
    s_waitcnt lgkmcnt(0)
    s_barrier
    s_add_u32 m0, s48, 21504
    s_mov_b32 s50, 0
    buffer_load_dwordx4 v3, s[32:35], s50 offen offset:0 sc1 lds
    buffer_load_dwordx4 v3, s[32:35], s50 offen offset:1024 sc1 lds
    buffer_load_dwordx4 v3, s[32:35], s50 offen offset:2048 sc1 lds
    buffer_load_dwordx4 v3, s[32:35], s50 offen offset:3072 sc1 lds
    s_add_u32 m0, s48, 25600
    s_nop 0
    buffer_load_dwordx4 v4, s[32:35], s50 offen offset:0 sc1 lds
    s_waitcnt vmcnt(19)
    s_waitcnt lgkmcnt(0)
    s_barrier
    s_add_u32 m0, s48, 26624
    s_mov_b32 s50, 5120
    buffer_load_dwordx4 v3, s[32:35], s50 offen offset:0 sc1 lds
    buffer_load_dwordx4 v3, s[32:35], s50 offen offset:1024 sc1 lds
    buffer_load_dwordx4 v3, s[32:35], s50 offen offset:2048 sc1 lds
    buffer_load_dwordx4 v3, s[32:35], s50 offen offset:3072 sc1 lds
    s_add_u32 m0, s48, 30720
    s_nop 0
    buffer_load_dwordx4 v4, s[32:35], s50 offen offset:0 sc1 lds
    s_waitcnt vmcnt(17)
    s_waitcnt lgkmcnt(0)
    s_barrier
    s_add_u32 m0, s48, 31744
    s_mov_b32 s50, 10240
    buffer_load_dwordx4 v3, s[32:35], s50 offen offset:0 sc1 lds
    buffer_load_dwordx4 v3, s[32:35], s50 offen offset:1024 sc1 lds
    buffer_load_dwordx4 v3, s[32:35], s50 offen offset:2048 sc1 lds
    buffer_load_dwordx4 v3, s[32:35], s50 offen offset:3072 sc1 lds
    s_add_u32 m0, s48, 35840
    s_nop 0
    buffer_load_dwordx4 v4, s[32:35], s50 offen offset:0 sc1 lds
    s_waitcnt vmcnt(15)
    s_waitcnt lgkmcnt(0)
    s_barrier
    s_add_u32 m0, s48, 0
    s_mov_b32 s50, 15360
    buffer_load_dwordx4 v3, s[32:35], s50 offen offset:0 sc1 lds
    buffer_load_dwordx4 v3, s[32:35], s50 offen offset:1024 sc1 lds
    buffer_load_dwordx4 v3, s[32:35], s50 offen offset:2048 sc1 lds
    buffer_load_dwordx4 v3, s[32:35], s50 offen offset:3072 sc1 lds
    s_add_u32 m0, s48, 4096
    s_nop 0
    buffer_load_dwordx4 v4, s[32:35], s50 offen offset:0 sc1 lds
    s_waitcnt lgkmcnt(0)
    s_barrier
    s_add_u32 m0, s48, 5120
    s_mov_b32 s50, 20480
    buffer_load_dwordx4 v3, s[32:35], s50 offen offset:0 sc1 lds
    buffer_load_dwordx4 v3, s[32:35], s50 offen offset:1024 sc1 lds
    buffer_load_dwordx4 v3, s[32:35], s50 offen offset:2048 sc1 lds
    buffer_load_dwordx4 v3, s[32:35], s50 offen offset:3072 sc1 lds
    s_add_u32 m0, s48, 9216
    s_nop 0
    buffer_load_dwordx4 v4, s[32:35], s50 offen offset:0 sc1 lds
    s_add_u32 m0, s48, 10240
    s_mov_b32 s50, 25600
    buffer_load_dwordx4 v3, s[32:35], s50 offen offset:0 sc1 lds
    buffer_load_dwordx4 v3, s[32:35], s50 offen offset:1024 sc1 lds
    buffer_load_dwordx4 v3, s[32:35], s50 offen offset:2048 sc1 lds
    buffer_load_dwordx4 v3, s[32:35], s50 offen offset:3072 sc1 lds
    s_add_u32 m0, s48, 14336
    s_nop 0
    buffer_load_dwordx4 v4, s[32:35], s50 offen offset:0 sc1 lds
    s_add_u32 m0, s48, 15360
    s_mov_b32 s50, 30720
    buffer_load_dwordx4 v3, s[32:35], s50 offen offset:0 sc1 lds
    buffer_load_dwordx4 v3, s[32:35], s50 offen offset:1024 sc1 lds
    buffer_load_dwordx4 v3, s[32:35], s50 offen offset:2048 sc1 lds
    buffer_load_dwordx4 v3, s[32:35], s50 offen offset:3072 sc1 lds
    s_add_u32 m0, s48, 19456
    s_nop 0
    buffer_load_dwordx4 v4, s[32:35], s50 offen offset:0 sc1 lds
    s_waitcnt vmcnt(30)
    s_waitcnt lgkmcnt(0)
    s_barrier
    s_waitcnt vmcnt(25)
    s_waitcnt lgkmcnt(0)
    s_barrier
    s_waitcnt vmcnt(20)
    s_waitcnt lgkmcnt(0)
    s_barrier
    s_waitcnt vmcnt(15)
    s_waitcnt lgkmcnt(0)
    s_barrier
    s_add_u32 m0, s48, 20480
    s_mov_b32 s50, 35840
    buffer_load_dwordx4 v3, s[32:35], s50 offen offset:0 sc1 lds
    buffer_load_dwordx4 v3, s[32:35], s50 offen offset:1024 sc1 lds
    buffer_load_dwordx4 v3, s[32:35], s50 offen offset:2048 sc1 lds
    buffer_load_dwordx4 v3, s[32:35], s50 offen offset:3072 sc1 lds
    s_add_u32 m0, s48, 24576
    s_nop 0
    buffer_load_dwordx4 v4, s[32:35], s50 offen offset:0 sc1 lds
    s_waitcnt vmcnt(15)
    s_waitcnt lgkmcnt(0)
    s_barrier
    s_add_u32 m0, s48, 25600
    s_mov_b32 s50, 40960
    buffer_load_dwordx4 v3, s[32:35], s50 offen offset:0 sc1 lds
    buffer_load_dwordx4 v3, s[32:35], s50 offen offset:1024 sc1 lds
    buffer_load_dwordx4 v3, s[32:35], s50 offen offset:2048 sc1 lds
    buffer_load_dwordx4 v3, s[32:35], s50 offen offset:3072 sc1 lds
    s_add_u32 m0, s48, 29696
    s_nop 0
    buffer_load_dwordx4 v4, s[32:35], s50 offen offset:0 sc1 lds
    s_waitcnt vmcnt(15)
    s_waitcnt lgkmcnt(0)
    s_barrier
    s_add_u32 m0, s48, 30720
    s_mov_b32 s50, 46080
    buffer_load_dwordx4 v3, s[32:35], s50 offen offset:0 sc1 lds
    buffer_load_dwordx4 v3, s[32:35], s50 offen offset:1024 sc1 lds
    buffer_load_dwordx4 v3, s[32:35], s50 offen offset:2048 sc1 lds
    buffer_load_dwordx4 v3, s[32:35], s50 offen offset:3072 sc1 lds
    s_add_u32 m0, s48, 34816
    s_nop 0
    buffer_load_dwordx4 v4, s[32:35], s50 offen offset:0 sc1 lds
    s_waitcnt vmcnt(15)
    s_waitcnt lgkmcnt(0)
    s_barrier
    s_add_u32 m0, s48, 0
    s_mov_b32 s50, 51200
    buffer_load_dwordx4 v3, s[32:35], s50 offen offset:0 sc1 lds
    buffer_load_dwordx4 v3, s[32:35], s50 offen offset:1024 sc1 lds
    buffer_load_dwordx4 v3, s[32:35], s50 offen offset:2048 sc1 lds
    buffer_load_dwordx4 v3, s[32:35], s50 offen offset:3072 sc1 lds
    s_add_u32 m0, s48, 4096
    s_nop 0
    buffer_load_dwordx4 v4, s[32:35], s50 offen offset:0 sc1 lds
    s_waitcnt vmcnt(15)
    s_waitcnt lgkmcnt(0)
    s_barrier
    s_add_u32 m0, s48, 5120
    s_mov_b32 s50, 56320
    buffer_load_dwordx4 v3, s[32:35], s50 offen offset:0 sc1 lds
    buffer_load_dwordx4 v3, s[32:35], s50 offen offset:1024 sc1 lds
    buffer_load_dwordx4 v3, s[32:35], s50 offen offset:2048 sc1 lds
    buffer_load_dwordx4 v3, s[32:35], s50 offen offset:3072 sc1 lds
    s_add_u32 m0, s48, 9216
    s_nop 0
    buffer_load_dwordx4 v4, s[32:35], s50 offen offset:0 sc1 lds
    s_waitcnt vmcnt(15)
    s_waitcnt lgkmcnt(0)
    s_barrier
    s_add_u32 m0, s48, 10240
    s_mov_b32 s50, 61440
    buffer_load_dwordx4 v3, s[32:35], s50 offen offset:0 sc1 lds
    buffer_load_dwordx4 v3, s[32:35], s50 offen offset:1024 sc1 lds
    buffer_load_dwordx4 v3, s[32:35], s50 offen offset:2048 sc1 lds
    buffer_load_dwordx4 v3, s[32:35], s50 offen offset:3072 sc1 lds
    s_add_u32 m0, s48, 14336
    s_nop 0
    buffer_load_dwordx4 v4, s[32:35], s50 offen offset:0 sc1 lds
    s_waitcnt vmcnt(15)
    s_waitcnt lgkmcnt(0)
    s_barrier
    s_add_u32 m0, s48, 15360
    s_mov_b32 s50, 66560
    buffer_load_dwordx4 v3, s[32:35], s50 offen offset:0 sc1 lds
    buffer_load_dwordx4 v3, s[32:35], s50 offen offset:1024 sc1 lds
    buffer_load_dwordx4 v3, s[32:35], s50 offen offset:2048 sc1 lds
    buffer_load_dwordx4 v3, s[32:35], s50 offen offset:3072 sc1 lds
    s_add_u32 m0, s48, 19456
    s_nop 0
    buffer_load_dwordx4 v4, s[32:35], s50 offen offset:0 sc1 lds
    s_waitcnt vmcnt(15)
    s_waitcnt lgkmcnt(0)
    s_barrier
    s_waitcnt vmcnt(10)
    s_waitcnt lgkmcnt(0)
    s_barrier
    s_waitcnt vmcnt(5)
    s_waitcnt lgkmcnt(0)
    s_barrier
    s_waitcnt vmcnt(0)
    s_waitcnt lgkmcnt(0)
    s_barrier
    s_endpgm
L1_stats:
    s_getpc_b64 s[56:57]
L1_pc:
    s_sub_u32 s56, s56, L1_pc-sequential_preLN__mha_block__dense_activation_silu__prompt_kernel
    s_subb_u32 s57, s57, 0
    s_mov_b32 s58, L_end-sequential_preLN__mha_block__dense_activation_silu__prompt_kernel
    s_mov_b32 s59, 0x00020000
    v_lshlrev_b32 v5, 7, v0
    buffer_load_dword v239, v5, s[56:59], 0 offen
    s_lshl_b32 s55, s26, 7
    s_lshl_b32 s56, s22, 4
    s_add_u32 s55, s55, s56
    v_lshrrev_b32 v5, 4, v2
    v_add_u32 v13, s55, v5
    v_mul_u32_u24 v5, 1280, v13
    v_and_b32 v6, 15, v2
    v_lshl_add_u32 v5, v6, 4, v5
    v_lshlrev_b32 v13, 3, v13
    v_lshlrev_b32 v12, 2, v3
    s_waitcnt lgkmcnt(0)
    s_add_u32 s44, s10, 25952256
    s_addc_u32 s45, s11, 0
    s_mov_b32 s46, 131072
    s_mov_b32 s47, 0x00020000
    s_mov_b32 s40, s18
    s_mov_b32 s41, s19
    s_mov_b32 s42, 256
    s_mov_b32 s43, 0x00020000
    s_mov_b32 s36, s4
    s_mov_b32 s37, s5
    s_mov_b32 s38, 2621440
    s_mov_b32 s39, 0x00020000
    s_mov_b32 s55, 0
    buffer_load_dwordx4 v[48:51], v5, s[36:39], s55 offen offset:0
    buffer_load_dwordx4 v[52:55], v5, s[36:39], s55 offen offset:256
    buffer_load_dwordx4 v[56:59], v5, s[36:39], s55 offen offset:512
    buffer_load_dwordx4 v[60:63], v5, s[36:39], s55 offen offset:768
    buffer_load_dwordx4 v[64:67], v5, s[36:39], s55 offen offset:1024
    s_mov_b32 s55, 5120
    buffer_load_dwordx4 v[68:71], v5, s[36:39], s55 offen offset:0
    buffer_load_dwordx4 v[72:75], v5, s[36:39], s55 offen offset:256
    buffer_load_dwordx4 v[76:79], v5, s[36:39], s55 offen offset:512
    buffer_load_dwordx4 v[80:83], v5, s[36:39], s55 offen offset:768
    buffer_load_dwordx4 v[84:87], v5, s[36:39], s55 offen offset:1024
    s_mov_b32 s55, 10240
    buffer_load_dwordx4 v[88:91], v5, s[36:39], s55 offen offset:0
    buffer_load_dwordx4 v[92:95], v5, s[36:39], s55 offen offset:256
    buffer_load_dwordx4 v[96:99], v5, s[36:39], s55 offen offset:512
    buffer_load_dwordx4 v[100:103], v5, s[36:39], s55 offen offset:768
    buffer_load_dwordx4 v[104:107], v5, s[36:39], s55 offen offset:1024
    s_mov_b32 s55, 15360
    buffer_load_dwordx4 v[108:111], v5, s[36:39], s55 offen offset:0
    buffer_load_dwordx4 v[112:115], v5, s[36:39], s55 offen offset:256
    buffer_load_dwordx4 v[116:119], v5, s[36:39], s55 offen offset:512
    buffer_load_dwordx4 v[120:123], v5, s[36:39], s55 offen offset:768
    buffer_load_dwordx4 v[124:127], v5, s[36:39], s55 offen offset:1024
    v_mov_b32 v6, 0x3f803f80
    s_waitcnt vmcnt(15)
    v_mov_b32 v24, 0
    v_mov_b32 v25, 0
    v_dot2_f32_bf16 v24, v48, v6, v24
    v_dot2_f32_bf16 v25, v48, v48, v25
    v_dot2_f32_bf16 v24, v49, v6, v24
    v_dot2_f32_bf16 v25, v49, v49, v25
    v_dot2_f32_bf16 v24, v50, v6, v24
    v_dot2_f32_bf16 v25, v50, v50, v25
    v_dot2_f32_bf16 v24, v51, v6, v24
    v_dot2_f32_bf16 v25, v51, v51, v25
    v_dot2_f32_bf16 v24, v52, v6, v24
    v_dot2_f32_bf16 v25, v52, v52, v25
    v_dot2_f32_bf16 v24, v53, v6, v24
    v_dot2_f32_bf16 v25, v53, v53, v25
    v_dot2_f32_bf16 v24, v54, v6, v24
    v_dot2_f32_bf16 v25, v54, v54, v25
    v_dot2_f32_bf16 v24, v55, v6, v24
    v_dot2_f32_bf16 v25, v55, v55, v25
    v_dot2_f32_bf16 v24, v56, v6, v24
    v_dot2_f32_bf16 v25, v56, v56, v25
    v_dot2_f32_bf16 v24, v57, v6, v24
    v_dot2_f32_bf16 v25, v57, v57, v25
    v_dot2_f32_bf16 v24, v58, v6, v24
    v_dot2_f32_bf16 v25, v58, v58, v25
    v_dot2_f32_bf16 v24, v59, v6, v24
    v_dot2_f32_bf16 v25, v59, v59, v25
    v_dot2_f32_bf16 v24, v60, v6, v24
    v_dot2_f32_bf16 v25, v60, v60, v25
    v_dot2_f32_bf16 v24, v61, v6, v24
    v_dot2_f32_bf16 v25, v61, v61, v25
    v_dot2_f32_bf16 v24, v62, v6, v24
    v_dot2_f32_bf16 v25, v62, v62, v25
    v_dot2_f32_bf16 v24, v63, v6, v24
    v_dot2_f32_bf16 v25, v63, v63, v25
    v_dot2_f32_bf16 v24, v64, v6, v24
    v_dot2_f32_bf16 v25, v64, v64, v25
    v_dot2_f32_bf16 v24, v65, v6, v24
    v_dot2_f32_bf16 v25, v65, v65, v25
    v_dot2_f32_bf16 v24, v66, v6, v24
    v_dot2_f32_bf16 v25, v66, v66, v25
    v_dot2_f32_bf16 v24, v67, v6, v24
    v_dot2_f32_bf16 v25, v67, v67, v25
    s_nop 2
    v_add_f32_dpp v24, v24, v24 row_ror:1 row_mask:0xf bank_mask:0xf
    v_add_f32_dpp v25, v25, v25 row_ror:1 row_mask:0xf bank_mask:0xf
    s_nop 0
    v_add_f32_dpp v24, v24, v24 row_ror:2 row_mask:0xf bank_mask:0xf
    v_add_f32_dpp v25, v25, v25 row_ror:2 row_mask:0xf bank_mask:0xf
    s_nop 0
    v_add_f32_dpp v24, v24, v24 row_ror:4 row_mask:0xf bank_mask:0xf
    v_add_f32_dpp v25, v25, v25 row_ror:4 row_mask:0xf bank_mask:0xf
    s_nop 0
    v_add_f32_dpp v24, v24, v24 row_ror:8 row_mask:0xf bank_mask:0xf
    v_add_f32_dpp v25, v25, v25 row_ror:8 row_mask:0xf bank_mask:0xf
    s_nop 0
    v_mul_f32 v24, 0xbacccccd, v24
    v_mul_f32 v25, 0x3acccccd, v25
    v_fma_f32 v25, -v24, v24, v25
    v_max_f32 v25, 0, v25
    v_add_f32 v25, 0x3727c5ac, v25
    v_rsq_f32 v25, v25
    s_nop 0
    v_or_b32 v25, 1, v25
    s_waitcnt vmcnt(10)
    v_mov_b32 v26, 0
    v_mov_b32 v27, 0
    v_dot2_f32_bf16 v26, v68, v6, v26
    v_dot2_f32_bf16 v27, v68, v68, v27
    v_dot2_f32_bf16 v26, v69, v6, v26
    v_dot2_f32_bf16 v27, v69, v69, v27
    v_dot2_f32_bf16 v26, v70, v6, v26
    v_dot2_f32_bf16 v27, v70, v70, v27
    v_dot2_f32_bf16 v26, v71, v6, v26
    v_dot2_f32_bf16 v27, v71, v71, v27
    v_dot2_f32_bf16 v26, v72, v6, v26
    v_dot2_f32_bf16 v27, v72, v72, v27
    v_dot2_f32_bf16 v26, v73, v6, v26
    v_dot2_f32_bf16 v27, v73, v73, v27
    v_dot2_f32_bf16 v26, v74, v6, v26
    v_dot2_f32_bf16 v27, v74, v74, v27
    v_dot2_f32_bf16 v26, v75, v6, v26
    v_dot2_f32_bf16 v27, v75, v75, v27
    v_dot2_f32_bf16 v26, v76, v6, v26
    v_dot2_f32_bf16 v27, v76, v76, v27
    v_dot2_f32_bf16 v26, v77, v6, v26
    v_dot2_f32_bf16 v27, v77, v77, v27
    v_dot2_f32_bf16 v26, v78, v6, v26
    v_dot2_f32_bf16 v27, v78, v78, v27
    v_dot2_f32_bf16 v26, v79, v6, v26
    v_dot2_f32_bf16 v27, v79, v79, v27
    v_dot2_f32_bf16 v26, v80, v6, v26
    v_dot2_f32_bf16 v27, v80, v80, v27
    v_dot2_f32_bf16 v26, v81, v6, v26
    v_dot2_f32_bf16 v27, v81, v81, v27
    v_dot2_f32_bf16 v26, v82, v6, v26
    v_dot2_f32_bf16 v27, v82, v82, v27
    v_dot2_f32_bf16 v26, v83, v6, v26
    v_dot2_f32_bf16 v27, v83, v83, v27
    v_dot2_f32_bf16 v26, v84, v6, v26
    v_dot2_f32_bf16 v27, v84, v84, v27
    v_dot2_f32_bf16 v26, v85, v6, v26
    v_dot2_f32_bf16 v27, v85, v85, v27
    v_dot2_f32_bf16 v26, v86, v6, v26
    v_dot2_f32_bf16 v27, v86, v86, v27
    v_dot2_f32_bf16 v26, v87, v6, v26
    v_dot2_f32_bf16 v27, v87, v87, v27
    s_nop 2
    v_add_f32_dpp v26, v26, v26 row_ror:1 row_mask:0xf bank_mask:0xf
    v_add_f32_dpp v27, v27, v27 row_ror:1 row_mask:0xf bank_mask:0xf
    s_nop 0
    v_add_f32_dpp v26, v26, v26 row_ror:2 row_mask:0xf bank_mask:0xf
    v_add_f32_dpp v27, v27, v27 row_ror:2 row_mask:0xf bank_mask:0xf
    s_nop 0
    v_add_f32_dpp v26, v26, v26 row_ror:4 row_mask:0xf bank_mask:0xf
    v_add_f32_dpp v27, v27, v27 row_ror:4 row_mask:0xf bank_mask:0xf
    s_nop 0
    v_add_f32_dpp v26, v26, v26 row_ror:8 row_mask:0xf bank_mask:0xf
    v_add_f32_dpp v27, v27, v27 row_ror:8 row_mask:0xf bank_mask:0xf
    s_nop 0
    v_mul_f32 v26, 0xbacccccd, v26
    v_mul_f32 v27, 0x3acccccd, v27
    v_fma_f32 v27, -v26, v26, v27
    v_max_f32 v27, 0, v27
    v_add_f32 v27, 0x3727c5ac, v27
    v_rsq_f32 v27, v27
    s_nop 0
    v_or_b32 v27, 1, v27
    s_waitcnt vmcnt(5)
    v_mov_b32 v28, 0
    v_mov_b32 v29, 0
    buffer_load_dword v15, v12, s[40:43], 0 offen offset:128 sc1
    v_dot2_f32_bf16 v28, v88, v6, v28
    v_dot2_f32_bf16 v29, v88, v88, v29
    v_dot2_f32_bf16 v28, v89, v6, v28
    v_dot2_f32_bf16 v29, v89, v89, v29
    v_dot2_f32_bf16 v28, v90, v6, v28
    v_dot2_f32_bf16 v29, v90, v90, v29
    v_dot2_f32_bf16 v28, v91, v6, v28
    v_dot2_f32_bf16 v29, v91, v91, v29
    v_dot2_f32_bf16 v28, v92, v6, v28
    v_dot2_f32_bf16 v29, v92, v92, v29
    v_dot2_f32_bf16 v28, v93, v6, v28
    v_dot2_f32_bf16 v29, v93, v93, v29
    v_dot2_f32_bf16 v28, v94, v6, v28
    v_dot2_f32_bf16 v29, v94, v94, v29
    v_dot2_f32_bf16 v28, v95, v6, v28
    v_dot2_f32_bf16 v29, v95, v95, v29
    v_dot2_f32_bf16 v28, v96, v6, v28
    v_dot2_f32_bf16 v29, v96, v96, v29
    v_dot2_f32_bf16 v28, v97, v6, v28
    v_dot2_f32_bf16 v29, v97, v97, v29
    v_dot2_f32_bf16 v28, v98, v6, v28
    v_dot2_f32_bf16 v29, v98, v98, v29
    v_dot2_f32_bf16 v28, v99, v6, v28
    v_dot2_f32_bf16 v29, v99, v99, v29
    v_dot2_f32_bf16 v28, v100, v6, v28
    v_dot2_f32_bf16 v29, v100, v100, v29
    v_dot2_f32_bf16 v28, v101, v6, v28
    v_dot2_f32_bf16 v29, v101, v101, v29
    v_dot2_f32_bf16 v28, v102, v6, v28
    v_dot2_f32_bf16 v29, v102, v102, v29
    v_dot2_f32_bf16 v28, v103, v6, v28
    v_dot2_f32_bf16 v29, v103, v103, v29
    v_dot2_f32_bf16 v28, v104, v6, v28
    v_dot2_f32_bf16 v29, v104, v104, v29
    v_dot2_f32_bf16 v28, v105, v6, v28
    v_dot2_f32_bf16 v29, v105, v105, v29
    v_dot2_f32_bf16 v28, v106, v6, v28
    v_dot2_f32_bf16 v29, v106, v106, v29
    v_dot2_f32_bf16 v28, v107, v6, v28
    v_dot2_f32_bf16 v29, v107, v107, v29
    s_nop 2
    v_add_f32_dpp v28, v28, v28 row_ror:1 row_mask:0xf bank_mask:0xf
    v_add_f32_dpp v29, v29, v29 row_ror:1 row_mask:0xf bank_mask:0xf
    s_nop 0
    v_add_f32_dpp v28, v28, v28 row_ror:2 row_mask:0xf bank_mask:0xf
    v_add_f32_dpp v29, v29, v29 row_ror:2 row_mask:0xf bank_mask:0xf
    s_nop 0
    v_add_f32_dpp v28, v28, v28 row_ror:4 row_mask:0xf bank_mask:0xf
    v_add_f32_dpp v29, v29, v29 row_ror:4 row_mask:0xf bank_mask:0xf
    s_nop 0
    v_add_f32_dpp v28, v28, v28 row_ror:8 row_mask:0xf bank_mask:0xf
    v_add_f32_dpp v29, v29, v29 row_ror:8 row_mask:0xf bank_mask:0xf
    s_nop 0
    v_mul_f32 v28, 0xbacccccd, v28
    v_mul_f32 v29, 0x3acccccd, v29
    v_fma_f32 v29, -v28, v28, v29
    v_max_f32 v29, 0, v29
    v_add_f32 v29, 0x3727c5ac, v29
    v_rsq_f32 v29, v29
    s_nop 0
    v_or_b32 v29, 1, v29
    s_waitcnt vmcnt(0)
    v_mov_b32 v30, 0
    v_mov_b32 v31, 0
    s_waitcnt vmcnt(1)
    v_dot2_f32_bf16 v30, v108, v6, v30
    v_dot2_f32_bf16 v31, v108, v108, v31
    v_dot2_f32_bf16 v30, v109, v6, v30
    v_dot2_f32_bf16 v31, v109, v109, v31
    v_dot2_f32_bf16 v30, v110, v6, v30
    v_dot2_f32_bf16 v31, v110, v110, v31
    v_dot2_f32_bf16 v30, v111, v6, v30
    v_dot2_f32_bf16 v31, v111, v111, v31
    v_dot2_f32_bf16 v30, v112, v6, v30
    v_dot2_f32_bf16 v31, v112, v112, v31
    v_dot2_f32_bf16 v30, v113, v6, v30
    v_dot2_f32_bf16 v31, v113, v113, v31
    v_dot2_f32_bf16 v30, v114, v6, v30
    v_dot2_f32_bf16 v31, v114, v114, v31
    v_dot2_f32_bf16 v30, v115, v6, v30
    v_dot2_f32_bf16 v31, v115, v115, v31
    v_dot2_f32_bf16 v30, v116, v6, v30
    v_dot2_f32_bf16 v31, v116, v116, v31
    v_dot2_f32_bf16 v30, v117, v6, v30
    v_dot2_f32_bf16 v31, v117, v117, v31
    v_dot2_f32_bf16 v30, v118, v6, v30
    v_dot2_f32_bf16 v31, v118, v118, v31
    v_dot2_f32_bf16 v30, v119, v6, v30
    v_dot2_f32_bf16 v31, v119, v119, v31
    v_dot2_f32_bf16 v30, v120, v6, v30
    v_dot2_f32_bf16 v31, v120, v120, v31
    v_dot2_f32_bf16 v30, v121, v6, v30
    v_dot2_f32_bf16 v31, v121, v121, v31
    v_dot2_f32_bf16 v30, v122, v6, v30
    v_dot2_f32_bf16 v31, v122, v122, v31
    v_dot2_f32_bf16 v30, v123, v6, v30
    v_dot2_f32_bf16 v31, v123, v123, v31
    v_dot2_f32_bf16 v30, v124, v6, v30
    v_dot2_f32_bf16 v31, v124, v124, v31
    v_dot2_f32_bf16 v30, v125, v6, v30
    v_dot2_f32_bf16 v31, v125, v125, v31
    v_dot2_f32_bf16 v30, v126, v6, v30
    v_dot2_f32_bf16 v31, v126, v126, v31
    v_dot2_f32_bf16 v30, v127, v6, v30
    v_dot2_f32_bf16 v31, v127, v127, v31
    s_nop 2
    v_add_f32_dpp v30, v30, v30 row_ror:1 row_mask:0xf bank_mask:0xf
    v_add_f32_dpp v31, v31, v31 row_ror:1 row_mask:0xf bank_mask:0xf
    s_nop 0
    v_add_f32_dpp v30, v30, v30 row_ror:2 row_mask:0xf bank_mask:0xf
    v_add_f32_dpp v31, v31, v31 row_ror:2 row_mask:0xf bank_mask:0xf
    s_nop 0
    v_add_f32_dpp v30, v30, v30 row_ror:4 row_mask:0xf bank_mask:0xf
    v_add_f32_dpp v31, v31, v31 row_ror:4 row_mask:0xf bank_mask:0xf
    s_nop 0
    v_add_f32_dpp v30, v30, v30 row_ror:8 row_mask:0xf bank_mask:0xf
    v_add_f32_dpp v31, v31, v31 row_ror:8 row_mask:0xf bank_mask:0xf
    s_nop 0
    v_mul_f32 v30, 0xbacccccd, v30
    v_mul_f32 v31, 0x3acccccd, v31
    v_fma_f32 v31, -v30, v30, v31
    v_max_f32 v31, 0, v31
    v_add_f32 v31, 0x3727c5ac, v31
    v_rsq_f32 v31, v31
    s_nop 0
    v_or_b32 v31, 1, v31
    s_mov_b64 s[70:71], -1
    s_mov_b32 s3, 400000
    s_branch Lp3_c
Lp3:
    buffer_load_dword v15, v12, s[40:43], 0 offen offset:128 sc1
Lp3_c:
    s_waitcnt vmcnt(0)
    v_cmp_eq_u32 vcc, 0, v15
    s_and_b64 s[72:73], vcc, s[70:71]
    s_sub_u32 s3, s3, 1
    s_cselect_b64 s[72:73], 0, s[72:73]
    s_cmp_lg_u64 s[72:73], 0
    s_cbranch_scc1 Lp3
    s_mov_b32 s55, 49152
    s_mov_b32 exec_lo, 0x00010001
    s_mov_b32 exec_hi, 0x00010001
    buffer_store_dwordx2 v[24:25], v13, s[44:47], s55 offen offset:0 sc1
    buffer_store_dwordx2 v[26:27], v13, s[44:47], s55 offen offset:32 sc1
    buffer_store_dwordx2 v[28:29], v13, s[44:47], s55 offen offset:64 sc1
    buffer_store_dwordx2 v[30:31], v13, s[44:47], s55 offen offset:96 sc1
    s_mov_b64 exec, -1
    s_and_b32 s55, s21, 1
    s_lshl_b32 s55, s55, 9
    v_add_u32 v5, s55, v0
    v_lshlrev_b32 v5, 20, v5
    s_mov_b32 s36, s10
    s_mov_b32 s37, s11
    s_mov_b32 s38, 26083328
    s_mov_b32 s39, 0x00020000
    s_mov_b32 s55, 0
    buffer_load_dword v239, v5, s[36:39], s55 offen sc1
    s_mov_b32 s36, s8
    s_mov_b32 s37, s9
    s_mov_b32 s38, 819200
    s_mov_b32 s39, 0x00020000
    buffer_load_dword v239, v5, s[36:39], 0 offen
    s_mov_b32 s36, s12
    s_mov_b32 s37, s13
    s_mov_b32 s38, 2211840
    s_mov_b32 s39, 0x00020000
    buffer_load_dword v239, v5, s[36:39], 0 offen
    s_mov_b32 s36, s14
    s_mov_b32 s37, s15
    s_mov_b32 s38, 2211840
    s_mov_b32 s39, 0x00020000
    buffer_load_dword v239, v5, s[36:39], 0 offen
    s_mov_b32 s36, s16
    s_mov_b32 s37, s17
    s_mov_b32 s38, 2621440
    s_mov_b32 s39, 0x00020000
    buffer_load_dword v239, v5, s[36:39], 0 offen
    s_mov_b32 s85, 0
    s_cmp_lt_u32 s22, 4
    s_cbranch_scc1 L1_done
    s_branch L1_ljob
L2_late:
    s_mov_b64 s[70:71], -1
    s_mov_b32 s3, 400000
Lp12:
    s_sleep 8
    buffer_load_dwordx4 v[188:191], v234, s[44:47], s68 offen sc1
Lp12_c:
    s_waitcnt vmcnt(0)
    v_cmp_eq_u32 vcc, 0, v188
    s_and_b64 s[72:73], vcc, s[70:71]
    v_cmp_eq_u32 vcc, 0, v189
    s_and_b64 vcc, vcc, s[70:71]
    s_or_b64 s[72:73], s[72:73], vcc
    v_cmp_eq_u32 vcc, 0, v190
    s_and_b64 vcc, vcc, s[70:71]
    s_or_b64 s[72:73], s[72:73], vcc
    v_cmp_eq_u32 vcc, 0, v191
    s_and_b64 vcc, vcc, s[70:71]
    s_or_b64 s[72:73], s[72:73], vcc
    s_sub_u32 s3, s3, 1
    s_cselect_b64 s[72:73], 0, s[72:73]
    s_cmp_lg_u64 s[72:73], 0
    s_cbranch_scc1 Lp12
    s_mov_b32 s71, 0
    s_mov_b32 s3, 400000
Lp13:
    buffer_load_dword v232, v235, s[44:47], s67 offen sc1
Lp13_c:
    s_waitcnt vmcnt(0)
    v_cmp_eq_u32 vcc, 0, v232
    s_and_b64 s[72:73], vcc, s[70:71]
    s_sub_u32 s3, s3, 1
    s_cselect_b64 s[72:73], 0, s[72:73]
    s_cmp_lg_u64 s[72:73], 0
    s_cbranch_scc1 Lp13
    s_branch L2_late_ret
L2_redo:
    s_mov_b32 s64, 1
    s_lshl_b32 s52, s24, 14
    s_mov_b32 s53, 8
    v_mov_b32 v96, 0xff800000
    v_mov_b32 v97, 0xff800000
L2_mx:
    s_waitcnt vmcnt(0) lgkmcnt(0)
    s_barrier
    s_mov_b32 m0, s49
    s_nop 0
    buffer_load_dwordx4 v24, s[28:31], s52 offen sc1 lds
    s_mov_b32 m0, s50
    s_nop 0
    buffer_load_dword v25, s[28:31], s52 offen sc1 lds
    s_add_u32 s52, s52, 2048
    s_waitcnt vmcnt(0)
    s_barrier
    ds_read_b128 v[160:163], v30 offset:0
    ds_read_b64 v[168:169], v31 offset:4096
    s_waitcnt lgkmcnt(0)
    v_mfma_f32_32x32x16_bf16 v[32:47], v[160:163], v[8:11], 0
    v_mfma_f32_32x32x8_bf16 v[32:47], v[168:169], v[16:17], v[32:47]
    v_mfma_f32_32x32x16_bf16 v[48:63], v[160:163], v[12:15], 0
    v_mfma_f32_32x32x8_bf16 v[48:63], v[168:169], v[20:21], v[48:63]
    s_nop 11
    v_max3_f32 v96, v96, v32, v33
    v_max3_f32 v96, v96, v34, v35
    v_max3_f32 v96, v96, v36, v37
    v_max3_f32 v96, v96, v38, v39
    v_max3_f32 v96, v96, v40, v41
    v_max3_f32 v96, v96, v42, v43
    v_max3_f32 v96, v96, v44, v45
    v_max3_f32 v96, v96, v46, v47
    v_max3_f32 v97, v97, v48, v49
    v_max3_f32 v97, v97, v50, v51
    v_max3_f32 v97, v97, v52, v53
    v_max3_f32 v97, v97, v54, v55
    v_max3_f32 v97, v97, v56, v57
    v_max3_f32 v97, v97, v58, v59
    v_max3_f32 v97, v97, v60, v61
    v_max3_f32 v97, v97, v62, v63
    ds_read_b128 v[160:163], v30 offset:1024
    ds_read_b64 v[168:169], v31 offset:4096
    s_waitcnt lgkmcnt(0)
    v_mfma_f32_32x32x16_bf16 v[32:47], v[160:163], v[8:11], 0
    v_mfma_f32_32x32x8_bf16 v[32:47], v[168:169], v[18:19], v[32:47]
    v_mfma_f32_32x32x16_bf16 v[48:63], v[160:163], v[12:15], 0
    v_mfma_f32_32x32x8_bf16 v[48:63], v[168:169], v[22:23], v[48:63]
    s_nop 11
    v_max3_f32 v96, v96, v32, v33
    v_max3_f32 v96, v96, v34, v35
    v_max3_f32 v96, v96, v36, v37
    v_max3_f32 v96, v96, v38, v39
    v_max3_f32 v96, v96, v40, v41
    v_max3_f32 v96, v96, v42, v43
    v_max3_f32 v96, v96, v44, v45
    v_max3_f32 v96, v96, v46, v47
    v_max3_f32 v97, v97, v48, v49
    v_max3_f32 v97, v97, v50, v51
    v_max3_f32 v97, v97, v52, v53
    v_max3_f32 v97, v97, v54, v55
    v_max3_f32 v97, v97, v56, v57
    v_max3_f32 v97, v97, v58, v59
    v_max3_f32 v97, v97, v60, v61
    v_max3_f32 v97, v97, v62, v63
    ds_read_b128 v[160:163], v30 offset:2048
    ds_read_b64 v[168:169], v31 offset:4608
    s_waitcnt lgkmcnt(0)
    v_mfma_f32_32x32x16_bf16 v[32:47], v[160:163], v[8:11], 0
    v_mfma_f32_32x32x8_bf16 v[32:47], v[168:169], v[16:17], v[32:47]
    v_mfma_f32_32x32x16_bf16 v[48:63], v[160:163], v[12:15], 0
    v_mfma_f32_32x32x8_bf16 v[48:63], v[168:169], v[20:21], v[48:63]
    s_nop 11
    v_max3_f32 v96, v96, v32, v33
    v_max3_f32 v96, v96, v34, v35
    v_max3_f32 v96, v96, v36, v37
    v_max3_f32 v96, v96, v38, v39
    v_max3_f32 v96, v96, v40, v41
    v_max3_f32 v96, v96, v42, v43
    v_max3_f32 v96, v96, v44, v45
    v_max3_f32 v96, v96, v46, v47
    v_max3_f32 v97, v97, v48, v49
    v_max3_f32 v97, v97, v50, v51
    v_max3_f32 v97, v97, v52, v53
    v_max3_f32 v97, v97, v54, v55
    v_max3_f32 v97, v97, v56, v57
    v_max3_f32 v97, v97, v58, v59
    v_max3_f32 v97, v97, v60, v61
    v_max3_f32 v97, v97, v62, v63
    ds_read_b128 v[160:163], v30 offset:3072
    ds_read_b64 v[168:169], v31 offset:4608
    s_waitcnt lgkmcnt(0)
    v_mfma_f32_32x32x16_bf16 v[32:47], v[160:163], v[8:11], 0
    v_mfma_f32_32x32x8_bf16 v[32:47], v[168:169], v[18:19], v[32:47]
    v_mfma_f32_32x32x16_bf16 v[48:63], v[160:163], v[12:15], 0
    v_mfma_f32_32x32x8_bf16 v[48:63], v[168:169], v[22:23], v[48:63]
    s_nop 11
    v_max3_f32 v96, v96, v32, v33
    v_max3_f32 v96, v96, v34, v35
    v_max3_f32 v96, v96, v36, v37
    v_max3_f32 v96, v96, v38, v39
    v_max3_f32 v96, v96, v40, v41
    v_max3_f32 v96, v96, v42, v43
    v_max3_f32 v96, v96, v44, v45
    v_max3_f32 v96, v96, v46, v47
    v_max3_f32 v97, v97, v48, v49
    v_max3_f32 v97, v97, v50, v51
    v_max3_f32 v97, v97, v52, v53
    v_max3_f32 v97, v97, v54, v55
    v_max3_f32 v97, v97, v56, v57
    v_max3_f32 v97, v97, v58, v59
    v_max3_f32 v97, v97, v60, v61
    v_max3_f32 v97, v97, v62, v63
    s_sub_u32 s53, s53, 1
    s_cmp_lg_u32 s53, 0
    s_cbranch_scc1 L2_mx
    v_mov_b32 v44, v96
    v_mov_b32 v45, v97
    s_lshl_b32 s55, s22, 8
    s_add_u32 s55, s55, 159744
    v_permlane32_swap_b32 v96, v44
    v_permlane32_swap_b32 v97, v45
    v_lshl_add_u32 v7, v3, 2, s55
    v_max_f32 v44, v44, v96
    v_max_f32 v45, v45, v97
    ds_write_b32 v7, v44
    ds_write_b32 v7, v45 offset:128
    s_xor_b32 s55, s22, 4
    s_lshl_b32 s55, s55, 8
    s_add_u32 s55, s55, 159744
    v_lshl_add_u32 v7, v3, 2, s55
    s_waitcnt lgkmcnt(0)
    s_barrier
    ds_read_b32 v46, v7 offset:128
    ds_read_b32 v47, v7
    s_waitcnt lgkmcnt(0)
    v_max_f32 v44, v44, v46
    v_max_f32 v45, v45, v47
    v_sub_f32 v128, 0, v44
    v_sub_f32 v144, 0, v45
    v_sub_f32 v129, 0, v44
    v_sub_f32 v145, 0, v45
    v_sub_f32 v130, 0, v44
    v_sub_f32 v146, 0, v45
    v_sub_f32 v131, 0, v44
    v_sub_f32 v147, 0, v45
    v_sub_f32 v132, 0, v44
    v_sub_f32 v148, 0, v45
    v_sub_f32 v133, 0, v44
    v_sub_f32 v149, 0, v45
    v_sub_f32 v134, 0, v44
    v_sub_f32 v150, 0, v45
    v_sub_f32 v135, 0, v44
    v_sub_f32 v151, 0, v45
    v_sub_f32 v136, 0, v44
    v_sub_f32 v152, 0, v45
    v_sub_f32 v137, 0, v44
    v_sub_f32 v153, 0, v45
    v_sub_f32 v138, 0, v44
    v_sub_f32 v154, 0, v45
    v_sub_f32 v139, 0, v44
    v_sub_f32 v155, 0, v45
    v_sub_f32 v140, 0, v44
    v_sub_f32 v156, 0, v45
    v_sub_f32 v141, 0, v44
    v_sub_f32 v157, 0, v45
    v_sub_f32 v142, 0, v44
    v_sub_f32 v158, 0, v45
    v_sub_f32 v143, 0, v44
    v_sub_f32 v159, 0, v45
    v_lshrrev_b32 v38, 4, v2
    v_mul_u32_u24 v38, 39936, v38
    v_and_b32 v6, 15, v2
    v_lshl_add_u32 v38, v6, 9, v38
    v_mov_b32 v32, 0x3f803f80
    v_mov_b32 v33, v32
    v_mov_b32 v34, v32
    v_mov_b32 v35, v32
    v_mov_b32 v36, 0
    v_mov_b32 v37, 162816
    v_mov_b32 v1, 0xdddddddd
    v_mov_b32 v96, 0
    v_mov_b32 v97, 0
    v_mov_b32 v98, 0
    v_mov_b32 v99, 0
    v_mov_b32 v100, 0
    v_mov_b32 v101, 0
    v_mov_b32 v102, 0
    v_mov_b32 v103, 0
    v_mov_b32 v104, 0
    v_mov_b32 v105, 0
    v_mov_b32 v106, 0
    v_mov_b32 v107, 0
    v_mov_b32 v108, 0
    v_mov_b32 v109, 0
    v_mov_b32 v110, 0
    v_mov_b32 v111, 0
    v_mov_b32 v112, 0
    v_mov_b32 v113, 0
    v_mov_b32 v114, 0
    v_mov_b32 v115, 0
    v_mov_b32 v116, 0
    v_mov_b32 v117, 0
    v_mov_b32 v118, 0
    v_mov_b32 v119, 0
    v_mov_b32 v120, 0
    v_mov_b32 v121, 0
    v_mov_b32 v122, 0
    v_mov_b32 v123, 0
    v_mov_b32 v124, 0
    v_mov_b32 v125, 0
    v_mov_b32 v126, 0
    v_mov_b32 v127, 0
    v_mov_b32 v88, 0
    v_mov_b32 v89, 0
    v_mov_b32 v90, 0
    v_mov_b32 v91, 0
    v_mov_b32 v92, 0
    v_mov_b32 v93, 0
    v_mov_b32 v94, 0
    v_mov_b32 v95, 0
    v_mov_b32 v184, 0
    v_mov_b32 v185, 0
    v_mov_b32 v186, 0
    v_mov_b32 v187, 0
    s_mov_b32 s38, 0
    s_branch L2_main
L2_jdec:
    s_lshl_b32 s0, s23, 8
    s_add_u32 s0, s0, s2
    s_cmp_ge_u32 s0, 370
    s_cbranch_scc1 L1_jw1a
    s_mul_i32 s1, s0, 209716
    s_lshr_b32 s1, s1, 20
    s_mul_i32 s4, s1, 5
    s_sub_u32 s4, s0, s4
    s_mov_b32 s3, 1280
    s_mov_b32 s78, 5
    s_mov_b32 s81, 1
    s_mov_b32 s82, 8
    s_cmp_ge_u32 s1, 20
    s_cbranch_scc1 L1_jw2a
    s_mul_i32 s5, s1, 209716
    s_lshr_b32 s5, s5, 20
    s_mul_i32 s6, s5, 5
    s_sub_u32 s6, s1, s6
    s_mul_i32 s5, s5, 160
    s_mul_i32 s7, s6, 40
    s_cmp_eq_u32 s6, 4
    s_cselect_b32 s7, 16, s7
    s_cselect_b32 s18, 80, 20
    s_cselect_b32 s19, 40, 4
    s_cselect_b32 s70, 20, 8
    s_add_u32 s5, s5, s7
    s_mov_b32 s86, s8
    s_mov_b32 s87, s9
    s_mov_b32 s88, 819200
    s_mov_b32 s80, 102400
    s_mov_b32 s71, 25600
    s_mov_b32 s72, 5120
    s_mov_b32 s83, 20185088
    s_branch L1_jca
L1_jw2a:
    s_sub_u32 s1, s1, 20
    s_mul_i32 s5, s1, 349526
    s_lshr_b32 s5, s5, 20
    s_mul_i32 s6, s5, 3
    s_sub_u32 s6, s1, s6
    s_mul_i32 s7, s5, 7
    s_mul_i32 s18, s5, 6
    s_add_u32 s18, s18, 12
    s_min_u32 s7, s7, s18
    s_lshl_b32 s7, s7, 4
    s_lshl_b32 s6, s6, 5
    s_add_u32 s5, s7, s6
    s_sub_u32 s6, s1, 48
    s_mul_i32 s6, s6, 224
    s_add_u32 s6, s6, 96
    s_cmp_ge_u32 s1, 48
    s_cselect_b32 s5, s6, s5
    s_cselect_b32 s70, 112, 16
    s_mov_b32 s18, 8
    s_mov_b32 s19, 4
    s_mov_b32 s86, s14
    s_mov_b32 s87, s15
    s_mov_b32 s88, 2211840
    s_mov_b32 s80, 286720
    s_mov_b32 s71, 71680
    s_mov_b32 s72, 5120
    s_mov_b32 s83, 21037056
    s_branch L1_jca
L1_jw1a:
    s_sub_u32 s0, s0, 370
    s_mul_i32 s1, s0, 74899
    s_lshr_b32 s1, s1, 20
    s_mul_i32 s4, s1, 14
    s_sub_u32 s4, s0, s4
    s_lshr_b32 s5, s1, 1
    s_mul_i32 s5, s5, 80
    s_and_b32 s6, s1, 1
    s_lshl_b32 s6, s6, 5
    s_add_u32 s5, s5, s6
    s_sub_u32 s6, s1, 16
    s_mul_i32 s6, s6, 160
    s_add_u32 s6, s6, 64
    s_cmp_ge_u32 s1, 16
    s_cselect_b32 s5, s6, s5
    s_cselect_b32 s70, 80, 16
    s_mov_b32 s18, 8
    s_mov_b32 s19, 4
    s_mov_b32 s3, 3456
    s_mov_b32 s78, 7
    s_mov_b32 s86, s12
    s_mov_b32 s87, s13
    s_mov_b32 s88, 2211840
    s_mov_b32 s80, 143360
    s_mov_b32 s71, 35840
    s_mov_b32 s72, 7168
    s_mov_b32 s83, 23330816
    s_cmp_eq_u32 s4, 13
    s_cselect_b32 s82, 4, 8
    s_cmp_lt_u32 s0, 280
    s_cselect_b32 s81, 2, 0
L1_jca:
    s_and_b32 s6, s1, 3
    s_mul_i32 s6, s6, s71
    s_lshr_b32 s7, s1, 2
    s_mul_i32 s7, s7, s72
    s_add_u32 s83, s83, s6
    s_add_u32 s83, s83, s7
    s_lshl_b32 s6, s4, 3
    s_mul_i32 s79, s6, 209716
    s_lshr_b32 s79, s79, 20
    s_mul_i32 s77, s79, 5
    s_cmp_eq_u32 s78, 5
    s_cbranch_scc1 L1_jda
    s_mul_i32 s79, s6, 149797
    s_lshr_b32 s79, s79, 20
    s_mul_i32 s77, s79, 7
    s_cmp_lt_u32 s6, 84
    s_cbranch_scc1 L1_jda
    s_sub_u32 s7, s6, 12
    s_mul_i32 s79, s7, 174763
    s_lshr_b32 s79, s79, 20
    s_mul_i32 s77, s79, 6
    s_add_u32 s77, s77, 12
    s_mov_b32 s78, 6
L1_jda:
    s_sub_u32 s77, s6, s77
    s_mul_i32 s84, s1, 7168
    s_lshl_b32 s6, s4, 9
    s_add_u32 s84, s84, s6
    s_lshl_b32 s6, s4, 8
    s_add_u32 s86, s86, s6
    s_addc_u32 s87, s87, 0
    s_sub_u32 s88, s88, s6
    s_cmp_eq_u32 s81, 0
    s_cselect_b32 s88, 0, s88
    v_lshrrev_b32 v5, 4, v2
    v_mul_lo_u32 v5, v5, s3
    v_lshrrev_b32 v6, 3, v2
    v_and_b32 v6, 6, v6
    v_xor_b32 v6, v6, v2
    v_and_b32 v6, 15, v6
    v_xor_b32 v7, 8, v6
    v_lshl_add_u32 v7, v7, 4, v5
    v_lshl_add_u32 v5, v6, 4, v5
    s_mov_b32 s6, s5
    s_mul_i32 s6, s6, s3
    s_sub_u32 s6, s6, 0
    v_add_u32 v224, s6, v5
    s_mov_b32 s6, s5
    s_add_u32 s6, s6, s70
    s_mul_i32 s6, s6, s3
    s_sub_u32 s6, s6, 1024
    v_add_u32 v225, s6, v5
    s_mov_b32 s6, s5
    s_add_u32 s6, s6, s19
    s_mul_i32 s6, s6, s3
    s_sub_u32 s6, s6, 2048
    v_add_u32 v226, s6, v7
    s_mov_b32 s6, s5
    s_add_u32 s6, s6, s19
    s_add_u32 s6, s6, s70
    s_mul_i32 s6, s6, s3
    s_sub_u32 s6, s6, 3072
    v_add_u32 v227, s6, v7
    s_mov_b32 s6, s5
    s_add_u32 s6, s6, s18
    s_mul_i32 s6, s6, s3
    s_sub_u32 s6, s6, 0
    v_add_u32 v228, s6, v5
    s_mov_b32 s6, s5
    s_add_u32 s6, s6, s18
    s_add_u32 s6, s6, s70
    s_mul_i32 s6, s6, s3
    s_sub_u32 s6, s6, 1024
    v_add_u32 v229, s6, v5
    s_mov_b32 s6, s5
    s_add_u32 s6, s6, s18
    s_add_u32 s6, s6, s19
    s_mul_i32 s6, s6, s3
    s_sub_u32 s6, s6, 2048
    v_add_u32 v230, s6, v7
    s_mov_b32 s6, s5
    s_add_u32 s6, s6, s18
    s_add_u32 s6, s6, s19
    s_add_u32 s6, s6, s70
    s_mul_i32 s6, s6, s3
    s_sub_u32 s6, s6, 3072
    v_add_u32 v231, s6, v7
    s_mov_b32 s36, s86
    s_mov_b32 s37, s87
    s_mov_b32 s38, s88
    s_mov_b32 s39, 0x00020000
    s_mul_i32 s90, s23, 39936
    s_mul_i32 s0, s79, s80
    s_lshl_b32 s1, s77, 10
    s_add_u32 s0, s0, s1
    s_add_u32 s0, s0, s83
    s_mov_b32 s4, s77
    s_mov_b32 s5, s78
    s_mov_b32 s6, s79
    s_mov_b32 s7, s80
    s_mov_b32 s86, 26083328
    s_cmp_eq_u32 s81, 0
    s_cselect_b32 s86, 0, s86
    s_cmp_eq_u32 s82, 4
    s_cselect_b32 s87, 0, s86
    s_cmp_eq_u32 s81, 2
    s_cselect_b32 s88, s86, 0
    s_add_u32 s84, s84, 25755648
    s_mov_b32 s76, s0
    s_add_u32 s0, s0, 1024
    s_add_u32 s4, s4, 1
    s_lshl_b32 s1, s5, 10
    s_sub_u32 s1, s7, s1
    s_cmp_eq_u32 s4, s5
    s_cselect_b32 s1, s1, 0
    s_cselect_b32 s4, 0, s4
    s_addc_u32 s6, s6, 0
    s_add_u32 s0, s0, s1
    s_cmp_eq_u32 s6, 12
    s_cselect_b32 s5, 6, s5
    s_mov_b32 s77, s0
    s_add_u32 s0, s0, 1024
    s_add_u32 s4, s4, 1
    s_lshl_b32 s1, s5, 10
    s_sub_u32 s1, s7, s1
    s_cmp_eq_u32 s4, s5
    s_cselect_b32 s1, s1, 0
    s_cselect_b32 s4, 0, s4
    s_addc_u32 s6, s6, 0
    s_add_u32 s0, s0, s1
    s_cmp_eq_u32 s6, 12
    s_cselect_b32 s5, 6, s5
    s_mov_b32 s78, s0
    s_add_u32 s0, s0, 1024
    s_add_u32 s4, s4, 1
    s_lshl_b32 s1, s5, 10
    s_sub_u32 s1, s7, s1
    s_cmp_eq_u32 s4, s5
    s_cselect_b32 s1, s1, 0
    s_cselect_b32 s4, 0, s4
    s_addc_u32 s6, s6, 0
    s_add_u32 s0, s0, s1
    s_cmp_eq_u32 s6, 12
    s_cselect_b32 s5, 6, s5
    s_mov_b32 s79, s0
    s_add_u32 s0, s0, 1024
    s_add_u32 s4, s4, 1
    s_lshl_b32 s1, s5, 10
    s_sub_u32 s1, s7, s1
    s_cmp_eq_u32 s4, s5
    s_cselect_b32 s1, s1, 0
    s_cselect_b32 s4, 0, s4
    s_addc_u32 s6, s6, 0
    s_add_u32 s0, s0, s1
    s_cmp_eq_u32 s6, 12
    s_cselect_b32 s5, 6, s5
    s_mov_b32 s80, s0
    s_add_u32 s0, s0, 1024
    s_add_u32 s4, s4, 1
    s_lshl_b32 s1, s5, 10
    s_sub_u32 s1, s7, s1
    s_cmp_eq_u32 s4, s5
    s_cselect_b32 s1, s1, 0
    s_cselect_b32 s4, 0, s4
    s_addc_u32 s6, s6, 0
    s_add_u32 s0, s0, s1
    s_cmp_eq_u32 s6, 12
    s_cselect_b32 s5, 6, s5
    s_mov_b32 s81, s0
    s_add_u32 s0, s0, 1024
    s_add_u32 s4, s4, 1
    s_lshl_b32 s1, s5, 10
    s_sub_u32 s1, s7, s1
    s_cmp_eq_u32 s4, s5
    s_cselect_b32 s1, s1, 0
    s_cselect_b32 s4, 0, s4
    s_addc_u32 s6, s6, 0
    s_add_u32 s0, s0, s1
    s_cmp_eq_u32 s6, 12
    s_cselect_b32 s5, 6, s5
    s_mov_b32 s82, s0
    s_add_u32 s0, s0, 1024
    s_add_u32 s4, s4, 1
    s_lshl_b32 s1, s5, 10
    s_sub_u32 s1, s7, s1
    s_cmp_eq_u32 s4, s5
    s_cselect_b32 s1, s1, 0
    s_cselect_b32 s4, 0, s4
    s_addc_u32 s6, s6, 0
    s_add_u32 s0, s0, s1
    s_cmp_eq_u32 s6, 12
    s_cselect_b32 s5, 6, s5
    s_mov_b32 s83, s0
    s_branch L2_npoll
L2_second:
    s_waitcnt vmcnt(0)
    s_cmp_eq_u32 s91, 0
    s_cselect_b32 s46, 131072, 0
    s_branch L2_first
L3_re0:
    s_mov_b32 s3, 400000
    s_mov_b32 s54, 0
L3_rl0:
    s_sleep 2
    buffer_load_dwordx4 v[140:143], v3, s[28:31], s54 offen offset:0 sc1
    buffer_load_dwordx4 v[144:147], v3, s[28:31], s54 offen offset:1024 sc1
    buffer_load_dwordx4 v[148:151], v3, s[28:31], s54 offen offset:2048 sc1
    buffer_load_dwordx4 v[152:155], v3, s[28:31], s54 offen offset:3072 sc1
    s_waitcnt vmcnt(0)
    v_max3_u32 v1, v140, v141, v142
    v_max3_u32 v1, v1, v143, v144
    v_max3_u32 v1, v1, v145, v146
    v_max3_u32 v1, v1, v147, v148
    v_max3_u32 v1, v1, v149, v150
    v_max3_u32 v1, v1, v151, v152
    v_max3_u32 v1, v1, v153, v154
    v_max_u32 v1, v1, v155
    v_cmp_eq_u32 vcc, -1, v1
    s_cbranch_vccz L3_ok0
    s_sub_u32 s3, s3, 1
    s_cmp_lg_u32 s3, 0
    s_cbranch_scc1 L3_rl0
    s_branch L3_ok0
L3_re4:
    s_mov_b32 s3, 400000
    s_mov_b32 s54, 4096
L3_rl4:
    s_sleep 2
    buffer_load_dwordx4 v[156:159], v3, s[28:31], s54 offen offset:0 sc1
    buffer_load_dwordx4 v[160:163], v3, s[28:31], s54 offen offset:1024 sc1
    buffer_load_dwordx4 v[164:167], v3, s[28:31], s54 offen offset:2048 sc1
    buffer_load_dwordx4 v[168:171], v3, s[28:31], s54 offen offset:3072 sc1
    s_waitcnt vmcnt(0)
    v_max3_u32 v1, v156, v157, v158
    v_max3_u32 v1, v1, v159, v160
    v_max3_u32 v1, v1, v161, v162
    v_max3_u32 v1, v1, v163, v164
    v_max3_u32 v1, v1, v165, v166
    v_max3_u32 v1, v1, v167, v168
    v_max3_u32 v1, v1, v169, v170
    v_max_u32 v1, v1, v171
    v_cmp_eq_u32 vcc, -1, v1
    s_cbranch_vccz L3_ok4
    s_sub_u32 s3, s3, 1
    s_cmp_lg_u32 s3, 0
    s_cbranch_scc1 L3_rl4
    s_branch L3_ok4
L3_re8:
    s_mov_b32 s3, 400000
    s_mov_b32 s54, 8192
L3_rl8:
    s_sleep 2
    buffer_load_dwordx4 v[172:175], v3, s[28:31], s54 offen offset:0 sc1
    buffer_load_dwordx4 v[176:179], v3, s[28:31], s54 offen offset:1024 sc1
    buffer_load_dwordx4 v[180:183], v3, s[28:31], s54 offen offset:2048 sc1
    buffer_load_dwordx4 v[184:187], v3, s[28:31], s54 offen offset:3072 sc1
    s_waitcnt vmcnt(0)
    v_max3_u32 v1, v172, v173, v174
    v_max3_u32 v1, v1, v175, v176
    v_max3_u32 v1, v1, v177, v178
    v_max3_u32 v1, v1, v179, v180
    v_max3_u32 v1, v1, v181, v182
    v_max3_u32 v1, v1, v183, v184
    v_max3_u32 v1, v1, v185, v186
    v_max_u32 v1, v1, v187
    v_cmp_eq_u32 vcc, -1, v1
    s_cbranch_vccz L3_ok8
    s_sub_u32 s3, s3, 1
    s_cmp_lg_u32 s3, 0
    s_cbranch_scc1 L3_rl8
    s_branch L3_ok8
L3_re12:
    s_mov_b32 s3, 400000
    s_mov_b32 s54, 12288
L3_rl12:
    s_sleep 2
    buffer_load_dwordx4 v[188:191], v3, s[28:31], s54 offen offset:0 sc1
    buffer_load_dwordx4 v[192:195], v3, s[28:31], s54 offen offset:1024 sc1
    buffer_load_dwordx4 v[196:199], v3, s[28:31], s54 offen offset:2048 sc1
    buffer_load_dwordx4 v[200:203], v3, s[28:31], s54 offen offset:3072 sc1
    s_waitcnt vmcnt(0)
    v_max3_u32 v1, v188, v189, v190
    v_max3_u32 v1, v1, v191, v192
    v_max3_u32 v1, v1, v193, v194
    v_max3_u32 v1, v1, v195, v196
    v_max3_u32 v1, v1, v197, v198
    v_max3_u32 v1, v1, v199, v200
    v_max3_u32 v1, v1, v201, v202
    v_max_u32 v1, v1, v203
    v_cmp_eq_u32 vcc, -1, v1
    s_cbranch_vccz L3_ok12
    s_sub_u32 s3, s3, 1
    s_cmp_lg_u32 s3, 0
    s_cbranch_scc1 L3_rl12
    s_branch L3_ok12
L3_re16:
    s_mov_b32 s3, 400000
    s_mov_b32 s54, 16384
L3_rl16:
    s_sleep 2
    buffer_load_dwordx4 v[204:207], v3, s[28:31], s54 offen offset:0 sc1
    buffer_load_dwordx4 v[208:211], v3, s[28:31], s54 offen offset:1024 sc1
    buffer_load_dwordx4 v[212:215], v3, s[28:31], s54 offen offset:2048 sc1
    buffer_load_dwordx4 v[216:219], v3, s[28:31], s54 offen offset:3072 sc1
    s_waitcnt vmcnt(0)
    v_max3_u32 v1, v204, v205, v206
    v_max3_u32 v1, v1, v207, v208
    v_max3_u32 v1, v1, v209, v210
    v_max3_u32 v1, v1, v211, v212
    v_max3_u32 v1, v1, v213, v214
    v_max3_u32 v1, v1, v215, v216
    v_max3_u32 v1, v1, v217, v218
    v_max_u32 v1, v1, v219
    v_cmp_eq_u32 vcc, -1, v1
    s_cbranch_vccz L3_ok16
    s_sub_u32 s3, s3, 1
    s_cmp_lg_u32 s3, 0
    s_cbranch_scc1 L3_rl16
    s_branch L3_ok16
L3_gd:
    s_mov_b64 s[70:71], -1
    s_mov_b32 s3, 400000
Lp14:
    s_sleep 4
    buffer_load_dword v48, v49, s[44:47], s77 offen sc1
Lp14_c:
    s_waitcnt vmcnt(0)
    v_cmp_eq_u32 vcc, 0, v48
    s_and_b64 s[72:73], vcc, s[70:71]
    s_sub_u32 s3, s3, 1
    s_cselect_b64 s[72:73], 0, s[72:73]
    s_cmp_lg_u64 s[72:73], 0
    s_cbranch_scc1 Lp14
    s_branch L3_gdr
Lsg6:
    buffer_wbl2 sc1
    s_waitcnt vmcnt(0)
    buffer_store_dword v1, off, s[44:47], s65 sc1
    s_branch Lsg6_e
Laq8:
    buffer_inv sc1
    s_branch Laq8_e
Lsg9:
    buffer_wbl2 sc1
    s_waitcnt vmcnt(0)
    buffer_store_dword v1, off, s[44:47], s78 sc1
    s_branch Lsg9_e
Laq11:
    buffer_inv sc1
    s_branch Laq11_e
L_end:
    s_endpgm
.section .rodata,"a"
.p2align 6
.amdhsa_kernel sequential_preLN__mha_block__dense_activation_silu__prompt_kernel
  .amdhsa_next_free_vgpr 252
  .amdhsa_next_free_sgpr 96
  .amdhsa_accum_offset 252
  .amdhsa_group_segment_fixed_size 0
  .amdhsa_kernarg_size 72
  .amdhsa_user_sgpr_count 2
  .amdhsa_user_sgpr_kernarg_segment_ptr 1
  .amdhsa_system_sgpr_workgroup_id_x 1
.end_amdhsa_kernel
```
